```python
import torch

def _softmax(x, axis=-1):
    return torch.softmax(x, dim=axis)

def _gelu(x):
    return torch.nn.functional.gelu(x, approximate='tanh')

def _silu(x):
    return torch.nn.functional.silu(x)

def _sigmoid(x):
    return torch.sigmoid(x)

def _layernorm(x, axis=-1, eps=1e-05):
    m = x.mean(dim=axis, keepdim=True)
    v = x.var(dim=axis, keepdim=True, unbiased=False)
    return (x - m) / torch.sqrt(v + eps)

def _scatter_add(tgt, idx, src, axis=0):
    return tgt.clone().index_add_(axis, idx, src)

def _segment_sum(src, seg, n):
    out = torch.zeros((n,) + src.shape[1:], dtype=src.dtype)
    return out.index_add_(0, seg, src)

def _pad(x, pw):
    flat = tuple((v for pair in reversed(pw) for v in pair))
    return torch.nn.functional.pad(x, flat)
kernel_name = 'interleave_layers__mha_block__mixer_gmlp__prompt'

def setup_inputs():

    _w = lambda a: (lambda t: t.to(torch.bfloat16) if t.is_floating_point() else t)(torch.as_tensor(a))

    def _A_setup():
        B, S, D, H = (1, 2048, 448, 16)
        return {'x': _w((lambda *s: torch.randn(*s, dtype=torch.bfloat16) * 0.05)(B, S, D)), 'wqkv': _w((lambda *s: torch.randn(*s, dtype=torch.bfloat16) * 0.05)(D, 3 * D)), 'wo': _w((lambda *s: torch.randn(*s, dtype=torch.bfloat16) * 0.05)(D, D))}
    _A_in = _A_setup()

    def _B_setup():
        B, S, D, F = (1, 2048, 448, 1792)
        Fh = F // 2
        return {'x': _w((lambda *s: torch.randn(*s, dtype=torch.bfloat16) * 0.05)(B, S, D)), 'w_in': _w((lambda *s: torch.randn(*s, dtype=torch.bfloat16) * 0.2)(D, 2 * Fh)), 'w_sp': _w(0.01 * (lambda *s: torch.randn(*s, dtype=torch.bfloat16) * 0.2)(S, S)), 'b_sp': _w(1.0 + 0.01 * (lambda *s: torch.randn(*s, dtype=torch.bfloat16) * 0.05)(S)), 'w_out': _w((lambda *s: torch.randn(*s, dtype=torch.bfloat16) * 0.05)(Fh, D))}
    _B_in = _B_setup()
    return {'A_x': _A_in['x'], 'A_wqkv': _A_in['wqkv'], 'A_wo': _A_in['wo'], 'B_x': _B_in['x'], 'B_w_in': _B_in['w_in'], 'B_w_sp': _B_in['w_sp'], 'B_b_sp': _B_in['b_sp'], 'B_w_out': _B_in['w_out']}

def reference(A_x, A_wqkv, A_wo, B_x, B_w_in, B_w_sp, B_b_sp, B_w_out):

    def _A_ref(x, wqkv, wo):
        B, S, D = x.shape
        H = 16
        Dh = D // H
        qkv = (lambda x, *d: x.permute(*d))((x @ wqkv).reshape(B, S, 3, H, Dh), 2, 0, 3, 1, 4)
        q, k, v = (qkv[0], qkv[1], qkv[2])
        scores = torch.einsum('bhqd,bhkd->bhqk', q, k) * Dh ** (-0.5)
        p = _softmax(scores, axis=-1)
        o = torch.einsum('bhqk,bhkd->bhqd', p, v)
        return (lambda x, *d: x.permute(*d))(o, 0, 2, 1, 3).reshape(B, S, D) @ wo

    def _B_ref(x, w_in, w_sp, b_sp, w_out):
        B, S, D = x.shape
        F = w_in.shape[-1]
        Fh = F // 2
        z = _gelu(torch.einsum('bsd,df->bsf', x, w_in))
        z1 = z[..., :Fh].clone()
        z2 = _layernorm(z[..., Fh:], axis=-1)
        g = torch.einsum('ts,bsf->btf', w_sp, z2) + b_sp[None, :, None]
        return torch.einsum('bsf,fd->bsd', z1 * g, w_out)
    x = A_x
    x = x + _A_ref(_layernorm(x, axis=-1), A_wqkv, A_wo)
    x = x + _B_ref(_layernorm(x, axis=-1), B_w_in, B_w_sp, B_b_sp, B_w_out)
    x = x + _A_ref(_layernorm(x, axis=-1), A_wqkv, A_wo)
    x = x + _B_ref(_layernorm(x, axis=-1), B_w_in, B_w_sp, B_b_sp, B_w_out)
    return x
```

```asm
; @launch grid=(256,1,1) block=(256,1,1) lds=163840
.amdgcn_target "amdgcn-amd-amdhsa--gfx950"
.text
.globl interleave_layers__mha_block__mixer_gmlp__prompt_kernel
.p2align 8
.type interleave_layers__mha_block__mixer_gmlp__prompt_kernel,@function
interleave_layers__mha_block__mixer_gmlp__prompt_kernel:
  s_cmp_ge_u32 s2, 256
  s_cbranch_scc1 L_end
  s_load_dwordx16 s[4:19], s[0:1], 0
  s_load_dwordx4 s[20:23], s[0:1], 64
  s_load_dwordx2 s[24:25], s[0:1], 80
  v_lshrrev_b32 v1, 6, v0
  v_and_b32 v0, 63, v0
  v_readfirstlane_b32 s42, v1
  v_lshlrev_b32 v1, 4, v0
  s_and_b32 s43, s2, 7
  s_lshr_b32 s44, s2, 3
  s_mov_b32 s48, 0
  s_mov_b32 s49, -1
  s_mov_b32 s50, 0xf0000000
  s_mov_b32 s51, 0xf0000000
  s_mov_b32 s45, 0
  s_mov_b32 s46, 0
  v_bfe_u32 v4, v0, 4, 1
  v_lshlrev_b32 v4, 5, v4
  v_and_b32 v5, 3, v0
  v_lshl_add_u32 v4, v5, 3, v4
  v_bfe_u32 v5, v0, 2, 2
  v_lshl_add_u32 v4, v5, 6, v4
  v_lshrrev_b32 v5, 5, v0
  v_lshl_add_u32 v2, v5, 9, v4
  v_lshl_add_u32 v3, v5, 8, v4
  s_waitcnt lgkmcnt(0)
  s_mov_b32 s28, s24
  s_mov_b32 s29, s25
  s_mov_b32 s30, 268435456
  s_mov_b32 s31, 0x20000
  s_add_u32 s52, s24, 33554176
  s_addc_u32 s53, s25, 0
  s_load_dword s40, s[52:53], 0
  s_lshr_b32 s52, s44, 4
  s_lshl_b32 s55, s43, 1
  s_add_u32 s52, s52, s55
  s_and_b32 s53, s44, 15
  s_lshl_b32 s54, s52, 2
  s_add_u32 s54, s54, s42
  s_mov_b32 s32, s4
  s_mov_b32 s33, s5
  s_mov_b32 s34, 1835008
  s_mov_b32 s35, 0x20000
  v_lshrrev_b32 v192, 2, v0
  v_mul_u32_u24 v192, 896, v192
  v_and_b32 v194, 3, v0
  v_bfe_u32 v195, v0, 4, 2
  v_xor_b32 v194, v194, v195
  v_lshl_add_u32 v192, v194, 4, v192
  s_lshl_b32 s55, s42, 14
  s_add_u32 s55, s55, 86016
  s_mul_i32 s56, s54, 28672
  s_add_u32 m0, s55, 0
  s_add_u32 s60, s56, 0
  buffer_load_dwordx4 v192, s[32:35], s60 offen lds
  s_add_u32 m0, s55, 1024
  s_add_u32 s60, s56, 14336
  buffer_load_dwordx4 v192, s[32:35], s60 offen lds
  s_add_u32 m0, s55, 2048
  s_add_u32 s60, s56, 64
  buffer_load_dwordx4 v192, s[32:35], s60 offen lds
  s_add_u32 m0, s55, 3072
  s_add_u32 s60, s56, 14400
  buffer_load_dwordx4 v192, s[32:35], s60 offen lds
  s_add_u32 m0, s55, 4096
  s_add_u32 s60, s56, 128
  buffer_load_dwordx4 v192, s[32:35], s60 offen lds
  s_add_u32 m0, s55, 5120
  s_add_u32 s60, s56, 14464
  buffer_load_dwordx4 v192, s[32:35], s60 offen lds
  s_add_u32 m0, s55, 6144
  s_add_u32 s60, s56, 192
  buffer_load_dwordx4 v192, s[32:35], s60 offen lds
  s_add_u32 m0, s55, 7168
  s_add_u32 s60, s56, 14528
  buffer_load_dwordx4 v192, s[32:35], s60 offen lds
  s_add_u32 m0, s55, 8192
  s_add_u32 s60, s56, 256
  buffer_load_dwordx4 v192, s[32:35], s60 offen lds
  s_add_u32 m0, s55, 9216
  s_add_u32 s60, s56, 14592
  buffer_load_dwordx4 v192, s[32:35], s60 offen lds
  s_add_u32 m0, s55, 10240
  s_add_u32 s60, s56, 320
  buffer_load_dwordx4 v192, s[32:35], s60 offen lds
  s_add_u32 m0, s55, 11264
  s_add_u32 s60, s56, 14656
  buffer_load_dwordx4 v192, s[32:35], s60 offen lds
  s_add_u32 m0, s55, 12288
  s_add_u32 s60, s56, 384
  buffer_load_dwordx4 v192, s[32:35], s60 offen lds
  s_add_u32 m0, s55, 13312
  s_add_u32 s60, s56, 14720
  buffer_load_dwordx4 v192, s[32:35], s60 offen lds
  s_add_u32 m0, s55, 14336
  s_add_u32 s60, s56, 448
  buffer_load_dwordx4 v192, s[32:35], s60 offen lds
  s_add_u32 m0, s55, 15360
  s_add_u32 s60, s56, 14784
  buffer_load_dwordx4 v192, s[32:35], s60 offen lds
  s_mov_b32 s36, s6
  s_mov_b32 s37, s7
  s_mov_b32 s38, 1204224
  s_mov_b32 s39, 0x20000
  v_lshrrev_b32 v4, 2, v0
  v_mul_u32_u24 v4, 2688, v4
  v_and_b32 v5, 3, v0
  v_lshl_add_u32 v4, v5, 4, v4
  s_and_b32 s68, s44, 15
  s_mul_i32 s68, s68, 56
  s_add_u32 s69, s42, 0
L_wst_1:
  s_mul_i32 s70, s69, 43008
  s_add_u32 s70, s70, s68
  s_mul_i32 s71, s69, 3072
  s_add_u32 m0, s71, 0
  s_add_u32 s72, s70, 0
  buffer_load_dwordx4 v4, s[36:39], s72 offen lds
  s_add_u32 m0, s71, 1024
  s_add_u32 s72, s70, 896
  buffer_load_dwordx4 v4, s[36:39], s72 offen lds
  s_add_u32 m0, s71, 2048
  s_add_u32 s72, s70, 1792
  buffer_load_dwordx4 v4, s[36:39], s72 offen lds
  s_add_u32 s69, s69, 4
  s_cmp_lt_u32 s69, 16
  s_cbranch_scc1 L_wst_1
L_wstd_2:
  v_bfe_u32 v194, v0, 4, 1
  v_lshlrev_b32 v198, 10, v194
  v_and_b32 v194, 15, v0
  v_lshl_add_u32 v198, v194, 6, v198
  v_bfe_u32 v194, v0, 2, 2
  v_lshrrev_b32 v195, 5, v0
  v_xor_b32 v194, v194, v195
  v_lshl_add_u32 v198, v194, 4, v198
  v_add_u32 v198, s55, v198
  v_xor_b32 v199, 32, v198
  s_waitcnt vmcnt(12)
  ds_read_b128 v[8:11], v198 offset:0
  ds_read_b128 v[12:15], v199 offset:0
  ds_read_b128 v[16:19], v198 offset:2048
  ds_read_b128 v[20:23], v199 offset:2048
  ds_read_b128 v[24:27], v198 offset:4096
  ds_read_b128 v[28:31], v199 offset:4096
  ds_read_b128 v[32:35], v198 offset:6144
  ds_read_b128 v[36:39], v199 offset:6144
  ds_read_b128 v[40:43], v198 offset:8192
  ds_read_b128 v[44:47], v199 offset:8192
  ds_read_b128 v[48:51], v198 offset:10240
  ds_read_b128 v[52:55], v199 offset:10240
  ds_read_b128 v[56:59], v198 offset:12288
  ds_read_b128 v[60:63], v199 offset:12288
  ds_read_b128 v[64:67], v198 offset:14336
  ds_read_b128 v[68:71], v199 offset:14336
  s_waitcnt lgkmcnt(0)
  s_waitcnt lgkmcnt(0)
  s_add_u32 s40, s40, 1
  s_not_b32 s41, s40
  s_cmp_lg_u32 s42, 0
  s_cbranch_scc1 L_w0_3
  s_getreg_b32 s60, hwreg(HW_REG_XCC_ID, 0, 4)
  v_mov_b32 v120, s40
  v_mov_b32 v121, s60
  v_mov_b32 v122, 0
  s_lshl_b32 s60, s43, 8
  s_lshl_b32 s61, s44, 3
  s_add_u32 s60, s60, s61
  s_add_u32 s60, s60, 31502336
  s_mov_b64 exec, 1
  buffer_store_dwordx2 v[120:121], v122, s[28:31], s60 offen sc1
  s_mov_b64 exec, -1
L_w0_3:
  v_mov_b32 v204, 0
  v_mov_b32 v208, 0
  v_mov_b32 v205, 0
  v_mov_b32 v209, 0
  v_mov_b32 v206, 0
  v_mov_b32 v210, 0
  v_mov_b32 v207, 0
  v_mov_b32 v211, 0
  s_mov_b32 s66, 0x3f803f80
  s_add_u32 m0, s55, 0
  s_add_u32 s60, s56, 512
  buffer_load_dwordx4 v192, s[32:35], s60 offen lds
  v_dot2_f32_bf16 v208, v8, v8, v208
  v_dot2_f32_bf16 v204, v8, s66, v204
  v_dot2_f32_bf16 v209, v9, v9, v209
  v_dot2_f32_bf16 v205, v9, s66, v205
  v_dot2_f32_bf16 v210, v10, v10, v210
  v_dot2_f32_bf16 v206, v10, s66, v206
  s_add_u32 m0, s55, 1024
  s_add_u32 s60, s56, 14848
  buffer_load_dwordx4 v192, s[32:35], s60 offen lds
  v_dot2_f32_bf16 v211, v11, v11, v211
  v_dot2_f32_bf16 v207, v11, s66, v207
  v_dot2_f32_bf16 v208, v12, v12, v208
  v_dot2_f32_bf16 v204, v12, s66, v204
  v_dot2_f32_bf16 v209, v13, v13, v209
  v_dot2_f32_bf16 v205, v13, s66, v205
  s_add_u32 m0, s55, 2048
  s_add_u32 s60, s56, 576
  buffer_load_dwordx4 v192, s[32:35], s60 offen lds
  v_dot2_f32_bf16 v210, v14, v14, v210
  v_dot2_f32_bf16 v206, v14, s66, v206
  v_dot2_f32_bf16 v211, v15, v15, v211
  v_dot2_f32_bf16 v207, v15, s66, v207
  v_dot2_f32_bf16 v208, v16, v16, v208
  v_dot2_f32_bf16 v204, v16, s66, v204
  s_add_u32 m0, s55, 3072
  s_add_u32 s60, s56, 14912
  buffer_load_dwordx4 v192, s[32:35], s60 offen lds
  v_dot2_f32_bf16 v209, v17, v17, v209
  v_dot2_f32_bf16 v205, v17, s66, v205
  v_dot2_f32_bf16 v210, v18, v18, v210
  v_dot2_f32_bf16 v206, v18, s66, v206
  v_dot2_f32_bf16 v211, v19, v19, v211
  v_dot2_f32_bf16 v207, v19, s66, v207
  s_add_u32 m0, s55, 4096
  s_add_u32 s60, s56, 640
  buffer_load_dwordx4 v192, s[32:35], s60 offen lds
  v_dot2_f32_bf16 v208, v20, v20, v208
  v_dot2_f32_bf16 v204, v20, s66, v204
  v_dot2_f32_bf16 v209, v21, v21, v209
  v_dot2_f32_bf16 v205, v21, s66, v205
  v_dot2_f32_bf16 v210, v22, v22, v210
  v_dot2_f32_bf16 v206, v22, s66, v206
  s_add_u32 m0, s55, 5120
  s_add_u32 s60, s56, 14976
  buffer_load_dwordx4 v192, s[32:35], s60 offen lds
  v_dot2_f32_bf16 v211, v23, v23, v211
  v_dot2_f32_bf16 v207, v23, s66, v207
  v_dot2_f32_bf16 v208, v24, v24, v208
  v_dot2_f32_bf16 v204, v24, s66, v204
  v_dot2_f32_bf16 v209, v25, v25, v209
  v_dot2_f32_bf16 v205, v25, s66, v205
  s_add_u32 m0, s55, 6144
  s_add_u32 s60, s56, 704
  buffer_load_dwordx4 v192, s[32:35], s60 offen lds
  v_dot2_f32_bf16 v210, v26, v26, v210
  v_dot2_f32_bf16 v206, v26, s66, v206
  v_dot2_f32_bf16 v211, v27, v27, v211
  v_dot2_f32_bf16 v207, v27, s66, v207
  v_dot2_f32_bf16 v208, v28, v28, v208
  v_dot2_f32_bf16 v204, v28, s66, v204
  s_add_u32 m0, s55, 7168
  s_add_u32 s60, s56, 15040
  buffer_load_dwordx4 v192, s[32:35], s60 offen lds
  v_dot2_f32_bf16 v209, v29, v29, v209
  v_dot2_f32_bf16 v205, v29, s66, v205
  v_dot2_f32_bf16 v210, v30, v30, v210
  v_dot2_f32_bf16 v206, v30, s66, v206
  v_dot2_f32_bf16 v211, v31, v31, v211
  v_dot2_f32_bf16 v207, v31, s66, v207
  s_add_u32 m0, s55, 8192
  s_add_u32 s60, s56, 768
  buffer_load_dwordx4 v192, s[32:35], s60 offen lds
  v_dot2_f32_bf16 v208, v32, v32, v208
  v_dot2_f32_bf16 v204, v32, s66, v204
  v_dot2_f32_bf16 v209, v33, v33, v209
  v_dot2_f32_bf16 v205, v33, s66, v205
  v_dot2_f32_bf16 v210, v34, v34, v210
  v_dot2_f32_bf16 v206, v34, s66, v206
  s_add_u32 m0, s55, 9216
  s_add_u32 s60, s56, 15104
  buffer_load_dwordx4 v192, s[32:35], s60 offen lds
  v_dot2_f32_bf16 v211, v35, v35, v211
  v_dot2_f32_bf16 v207, v35, s66, v207
  v_dot2_f32_bf16 v208, v36, v36, v208
  v_dot2_f32_bf16 v204, v36, s66, v204
  v_dot2_f32_bf16 v209, v37, v37, v209
  v_dot2_f32_bf16 v205, v37, s66, v205
  s_add_u32 m0, s55, 10240
  s_add_u32 s60, s56, 832
  buffer_load_dwordx4 v192, s[32:35], s60 offen lds
  v_dot2_f32_bf16 v210, v38, v38, v210
  v_dot2_f32_bf16 v206, v38, s66, v206
  v_dot2_f32_bf16 v211, v39, v39, v211
  v_dot2_f32_bf16 v207, v39, s66, v207
  v_dot2_f32_bf16 v208, v40, v40, v208
  v_dot2_f32_bf16 v204, v40, s66, v204
  s_add_u32 m0, s55, 11264
  s_add_u32 s60, s56, 15168
  buffer_load_dwordx4 v192, s[32:35], s60 offen lds
  v_dot2_f32_bf16 v209, v41, v41, v209
  v_dot2_f32_bf16 v205, v41, s66, v205
  v_dot2_f32_bf16 v210, v42, v42, v210
  v_dot2_f32_bf16 v206, v42, s66, v206
  v_dot2_f32_bf16 v211, v43, v43, v211
  v_dot2_f32_bf16 v207, v43, s66, v207
  s_add_u32 s69, s42, 16
  s_mul_i32 s70, s69, 43008
  s_add_u32 s70, s70, s68
  s_mul_i32 s71, s69, 3072
  s_add_u32 m0, s71, 0
  s_add_u32 s72, s70, 0
  buffer_load_dwordx4 v4, s[36:39], s72 offen lds
  v_dot2_f32_bf16 v208, v44, v44, v208
  v_dot2_f32_bf16 v204, v44, s66, v204
  v_dot2_f32_bf16 v209, v45, v45, v209
  v_dot2_f32_bf16 v205, v45, s66, v205
  v_dot2_f32_bf16 v210, v46, v46, v210
  v_dot2_f32_bf16 v206, v46, s66, v206
  s_add_u32 m0, s71, 1024
  s_add_u32 s72, s70, 896
  buffer_load_dwordx4 v4, s[36:39], s72 offen lds
  v_dot2_f32_bf16 v211, v47, v47, v211
  v_dot2_f32_bf16 v207, v47, s66, v207
  v_dot2_f32_bf16 v208, v48, v48, v208
  v_dot2_f32_bf16 v204, v48, s66, v204
  v_dot2_f32_bf16 v209, v49, v49, v209
  v_dot2_f32_bf16 v205, v49, s66, v205
  s_add_u32 m0, s71, 2048
  s_add_u32 s72, s70, 1792
  buffer_load_dwordx4 v4, s[36:39], s72 offen lds
  v_dot2_f32_bf16 v210, v50, v50, v210
  v_dot2_f32_bf16 v206, v50, s66, v206
  v_dot2_f32_bf16 v211, v51, v51, v211
  v_dot2_f32_bf16 v207, v51, s66, v207
  v_dot2_f32_bf16 v208, v52, v52, v208
  v_dot2_f32_bf16 v204, v52, s66, v204
  s_add_u32 s69, s42, 20
  s_mul_i32 s70, s69, 43008
  s_add_u32 s70, s70, s68
  s_mul_i32 s71, s69, 3072
  s_add_u32 m0, s71, 0
  s_add_u32 s72, s70, 0
  buffer_load_dwordx4 v4, s[36:39], s72 offen lds
  v_dot2_f32_bf16 v209, v53, v53, v209
  v_dot2_f32_bf16 v205, v53, s66, v205
  v_dot2_f32_bf16 v210, v54, v54, v210
  v_dot2_f32_bf16 v206, v54, s66, v206
  v_dot2_f32_bf16 v211, v55, v55, v211
  v_dot2_f32_bf16 v207, v55, s66, v207
  s_add_u32 m0, s71, 1024
  s_add_u32 s72, s70, 896
  buffer_load_dwordx4 v4, s[36:39], s72 offen lds
  v_dot2_f32_bf16 v208, v56, v56, v208
  v_dot2_f32_bf16 v204, v56, s66, v204
  v_dot2_f32_bf16 v209, v57, v57, v209
  v_dot2_f32_bf16 v205, v57, s66, v205
  v_dot2_f32_bf16 v210, v58, v58, v210
  v_dot2_f32_bf16 v206, v58, s66, v206
  s_add_u32 m0, s71, 2048
  s_add_u32 s72, s70, 1792
  buffer_load_dwordx4 v4, s[36:39], s72 offen lds
  v_dot2_f32_bf16 v211, v59, v59, v211
  v_dot2_f32_bf16 v207, v59, s66, v207
  v_dot2_f32_bf16 v208, v60, v60, v208
  v_dot2_f32_bf16 v204, v60, s66, v204
  v_dot2_f32_bf16 v209, v61, v61, v209
  v_dot2_f32_bf16 v205, v61, s66, v205
  s_add_u32 s69, s42, 24
  s_mul_i32 s70, s69, 43008
  s_add_u32 s70, s70, s68
  s_mul_i32 s71, s69, 3072
  s_add_u32 m0, s71, 0
  s_add_u32 s72, s70, 0
  buffer_load_dwordx4 v4, s[36:39], s72 offen lds
  v_dot2_f32_bf16 v210, v62, v62, v210
  v_dot2_f32_bf16 v206, v62, s66, v206
  v_dot2_f32_bf16 v211, v63, v63, v211
  v_dot2_f32_bf16 v207, v63, s66, v207
  v_dot2_f32_bf16 v208, v64, v64, v208
  v_dot2_f32_bf16 v204, v64, s66, v204
  s_add_u32 m0, s71, 1024
  s_add_u32 s72, s70, 896
  buffer_load_dwordx4 v4, s[36:39], s72 offen lds
  v_dot2_f32_bf16 v209, v65, v65, v209
  v_dot2_f32_bf16 v205, v65, s66, v205
  v_dot2_f32_bf16 v210, v66, v66, v210
  v_dot2_f32_bf16 v206, v66, s66, v206
  v_dot2_f32_bf16 v211, v67, v67, v211
  v_dot2_f32_bf16 v207, v67, s66, v207
  s_add_u32 m0, s71, 2048
  s_add_u32 s72, s70, 1792
  buffer_load_dwordx4 v4, s[36:39], s72 offen lds
  v_dot2_f32_bf16 v208, v68, v68, v208
  v_dot2_f32_bf16 v204, v68, s66, v204
  v_dot2_f32_bf16 v209, v69, v69, v209
  v_dot2_f32_bf16 v205, v69, s66, v205
  v_dot2_f32_bf16 v210, v70, v70, v210
  v_dot2_f32_bf16 v206, v70, s66, v206
  v_dot2_f32_bf16 v211, v71, v71, v211
  v_dot2_f32_bf16 v207, v71, s66, v207
  s_waitcnt vmcnt(21)
  s_barrier
  v_mov_b32 v212, v2
  v_add_u32 v213, 61440, v2
  ds_read_b64_tr_b16 v[168:169], v212 offset:0
  ds_read_b64_tr_b16 v[170:171], v212 offset:256
  ds_read_b64_tr_b16 v[172:173], v212 offset:1024
  ds_read_b64_tr_b16 v[174:175], v212 offset:1280
  ds_read_b64_tr_b16 v[176:177], v212 offset:2048
  ds_read_b64_tr_b16 v[178:179], v212 offset:2304
  ds_read_b64_tr_b16 v[180:181], v212 offset:3072
  ds_read_b64_tr_b16 v[182:183], v212 offset:3328
  ds_read_b64_tr_b16 v[184:185], v212 offset:4096
  ds_read_b64_tr_b16 v[186:187], v212 offset:4352
  ds_read_b64_tr_b16 v[188:189], v212 offset:5120
  ds_read_b64_tr_b16 v[190:191], v212 offset:5376
  s_waitcnt lgkmcnt(8)
  v_mfma_f32_32x32x16_bf16 v[120:135], v[168:171], v[8:11], 0
  ds_read_b64_tr_b16 v[168:169], v212 offset:6144
  ds_read_b64_tr_b16 v[170:171], v212 offset:6400
  v_mfma_f32_32x32x16_bf16 v[136:151], v[172:175], v[8:11], 0
  ds_read_b64_tr_b16 v[172:173], v212 offset:7168
  ds_read_b64_tr_b16 v[174:175], v212 offset:7424
  s_waitcnt lgkmcnt(8)
  v_mfma_f32_32x32x16_bf16 v[152:167], v[8:11], v[176:179], 0
  ds_read_b64_tr_b16 v[176:177], v212 offset:8192
  ds_read_b64_tr_b16 v[178:179], v212 offset:8448
  v_mfma_f32_32x32x16_bf16 v[120:135], v[180:183], v[12:15], v[120:135]
  ds_read_b64_tr_b16 v[180:181], v212 offset:9216
  ds_read_b64_tr_b16 v[182:183], v212 offset:9472
  s_waitcnt lgkmcnt(8)
  v_mfma_f32_32x32x16_bf16 v[136:151], v[184:187], v[12:15], v[136:151]
  ds_read_b64_tr_b16 v[184:185], v212 offset:10240
  ds_read_b64_tr_b16 v[186:187], v212 offset:10496
  v_mfma_f32_32x32x16_bf16 v[152:167], v[12:15], v[188:191], v[152:167]
  ds_read_b64_tr_b16 v[188:189], v212 offset:11264
  ds_read_b64_tr_b16 v[190:191], v212 offset:11520
  s_waitcnt lgkmcnt(8)
  v_mfma_f32_32x32x16_bf16 v[120:135], v[168:171], v[16:19], v[120:135]
  ds_read_b64_tr_b16 v[168:169], v212 offset:12288
  ds_read_b64_tr_b16 v[170:171], v212 offset:12544
  v_mfma_f32_32x32x16_bf16 v[136:151], v[172:175], v[16:19], v[136:151]
  ds_read_b64_tr_b16 v[172:173], v212 offset:13312
  ds_read_b64_tr_b16 v[174:175], v212 offset:13568
  s_waitcnt lgkmcnt(8)
  v_mfma_f32_32x32x16_bf16 v[152:167], v[16:19], v[176:179], v[152:167]
  ds_read_b64_tr_b16 v[176:177], v212 offset:14336
  ds_read_b64_tr_b16 v[178:179], v212 offset:14592
  v_mfma_f32_32x32x16_bf16 v[120:135], v[180:183], v[20:23], v[120:135]
  ds_read_b64_tr_b16 v[180:181], v212 offset:15360
  ds_read_b64_tr_b16 v[182:183], v212 offset:15616
  s_waitcnt lgkmcnt(8)
  v_mfma_f32_32x32x16_bf16 v[136:151], v[184:187], v[20:23], v[136:151]
  ds_read_b64_tr_b16 v[184:185], v212 offset:16384
  ds_read_b64_tr_b16 v[186:187], v212 offset:16640
  v_mfma_f32_32x32x16_bf16 v[152:167], v[20:23], v[188:191], v[152:167]
  ds_read_b64_tr_b16 v[188:189], v212 offset:17408
  ds_read_b64_tr_b16 v[190:191], v212 offset:17664
  s_waitcnt lgkmcnt(8)
  v_mfma_f32_32x32x16_bf16 v[120:135], v[168:171], v[24:27], v[120:135]
  ds_read_b64_tr_b16 v[168:169], v212 offset:18432
  ds_read_b64_tr_b16 v[170:171], v212 offset:18688
  v_mfma_f32_32x32x16_bf16 v[136:151], v[172:175], v[24:27], v[136:151]
  ds_read_b64_tr_b16 v[172:173], v212 offset:19456
  ds_read_b64_tr_b16 v[174:175], v212 offset:19712
  s_waitcnt lgkmcnt(8)
  v_mfma_f32_32x32x16_bf16 v[152:167], v[24:27], v[176:179], v[152:167]
  ds_read_b64_tr_b16 v[176:177], v212 offset:20480
  ds_read_b64_tr_b16 v[178:179], v212 offset:20736
  v_mfma_f32_32x32x16_bf16 v[120:135], v[180:183], v[28:31], v[120:135]
  ds_read_b64_tr_b16 v[180:181], v212 offset:21504
  ds_read_b64_tr_b16 v[182:183], v212 offset:21760
  s_waitcnt lgkmcnt(8)
  v_mfma_f32_32x32x16_bf16 v[136:151], v[184:187], v[28:31], v[136:151]
  ds_read_b64_tr_b16 v[184:185], v212 offset:22528
  ds_read_b64_tr_b16 v[186:187], v212 offset:22784
  v_mfma_f32_32x32x16_bf16 v[152:167], v[28:31], v[188:191], v[152:167]
  ds_read_b64_tr_b16 v[188:189], v212 offset:23552
  ds_read_b64_tr_b16 v[190:191], v212 offset:23808
  s_waitcnt lgkmcnt(8)
  v_mfma_f32_32x32x16_bf16 v[120:135], v[168:171], v[32:35], v[120:135]
  ds_read_b64_tr_b16 v[168:169], v212 offset:24576
  ds_read_b64_tr_b16 v[170:171], v212 offset:24832
  v_mfma_f32_32x32x16_bf16 v[136:151], v[172:175], v[32:35], v[136:151]
  ds_read_b64_tr_b16 v[172:173], v212 offset:25600
  ds_read_b64_tr_b16 v[174:175], v212 offset:25856
  s_waitcnt lgkmcnt(8)
  v_mfma_f32_32x32x16_bf16 v[152:167], v[32:35], v[176:179], v[152:167]
  ds_read_b64_tr_b16 v[176:177], v212 offset:26624
  ds_read_b64_tr_b16 v[178:179], v212 offset:26880
  v_mfma_f32_32x32x16_bf16 v[120:135], v[180:183], v[36:39], v[120:135]
  ds_read_b64_tr_b16 v[180:181], v212 offset:27648
  ds_read_b64_tr_b16 v[182:183], v212 offset:27904
  s_waitcnt lgkmcnt(8)
  v_mfma_f32_32x32x16_bf16 v[136:151], v[184:187], v[36:39], v[136:151]
  ds_read_b64_tr_b16 v[184:185], v212 offset:28672
  ds_read_b64_tr_b16 v[186:187], v212 offset:28928
  v_mfma_f32_32x32x16_bf16 v[152:167], v[36:39], v[188:191], v[152:167]
  ds_read_b64_tr_b16 v[188:189], v212 offset:29696
  ds_read_b64_tr_b16 v[190:191], v212 offset:29952
  s_waitcnt lgkmcnt(8)
  v_mfma_f32_32x32x16_bf16 v[120:135], v[168:171], v[40:43], v[120:135]
  ds_read_b64_tr_b16 v[168:169], v212 offset:30720
  ds_read_b64_tr_b16 v[170:171], v212 offset:30976
  v_mfma_f32_32x32x16_bf16 v[136:151], v[172:175], v[40:43], v[136:151]
  ds_read_b64_tr_b16 v[172:173], v212 offset:31744
  ds_read_b64_tr_b16 v[174:175], v212 offset:32000
  s_waitcnt lgkmcnt(8)
  v_mfma_f32_32x32x16_bf16 v[152:167], v[40:43], v[176:179], v[152:167]
  ds_read_b64_tr_b16 v[176:177], v212 offset:32768
  ds_read_b64_tr_b16 v[178:179], v212 offset:33024
  v_mfma_f32_32x32x16_bf16 v[120:135], v[180:183], v[44:47], v[120:135]
  ds_read_b64_tr_b16 v[180:181], v212 offset:33792
  ds_read_b64_tr_b16 v[182:183], v212 offset:34048
  s_waitcnt lgkmcnt(8)
  v_mfma_f32_32x32x16_bf16 v[136:151], v[184:187], v[44:47], v[136:151]
  ds_read_b64_tr_b16 v[184:185], v212 offset:34816
  ds_read_b64_tr_b16 v[186:187], v212 offset:35072
  v_mfma_f32_32x32x16_bf16 v[152:167], v[44:47], v[188:191], v[152:167]
  ds_read_b64_tr_b16 v[188:189], v212 offset:35840
  ds_read_b64_tr_b16 v[190:191], v212 offset:36096
  s_waitcnt lgkmcnt(8)
  v_mfma_f32_32x32x16_bf16 v[120:135], v[168:171], v[48:51], v[120:135]
  ds_read_b64_tr_b16 v[168:169], v212 offset:36864
  ds_read_b64_tr_b16 v[170:171], v212 offset:37120
  v_mfma_f32_32x32x16_bf16 v[136:151], v[172:175], v[48:51], v[136:151]
  ds_read_b64_tr_b16 v[172:173], v212 offset:37888
  ds_read_b64_tr_b16 v[174:175], v212 offset:38144
  s_waitcnt lgkmcnt(8)
  v_mfma_f32_32x32x16_bf16 v[152:167], v[48:51], v[176:179], v[152:167]
  ds_read_b64_tr_b16 v[176:177], v212 offset:38912
  ds_read_b64_tr_b16 v[178:179], v212 offset:39168
  v_mfma_f32_32x32x16_bf16 v[120:135], v[180:183], v[52:55], v[120:135]
  ds_read_b64_tr_b16 v[180:181], v212 offset:39936
  ds_read_b64_tr_b16 v[182:183], v212 offset:40192
  s_waitcnt lgkmcnt(8)
  v_mfma_f32_32x32x16_bf16 v[136:151], v[184:187], v[52:55], v[136:151]
  ds_read_b64_tr_b16 v[184:185], v212 offset:40960
  ds_read_b64_tr_b16 v[186:187], v212 offset:41216
  v_mfma_f32_32x32x16_bf16 v[152:167], v[52:55], v[188:191], v[152:167]
  ds_read_b64_tr_b16 v[188:189], v212 offset:41984
  ds_read_b64_tr_b16 v[190:191], v212 offset:42240
  s_waitcnt lgkmcnt(8)
  v_mfma_f32_32x32x16_bf16 v[120:135], v[168:171], v[56:59], v[120:135]
  ds_read_b64_tr_b16 v[168:169], v212 offset:43008
  ds_read_b64_tr_b16 v[170:171], v212 offset:43264
  v_mfma_f32_32x32x16_bf16 v[136:151], v[172:175], v[56:59], v[136:151]
  ds_read_b64_tr_b16 v[172:173], v212 offset:44032
  ds_read_b64_tr_b16 v[174:175], v212 offset:44288
  s_waitcnt lgkmcnt(8)
  v_mfma_f32_32x32x16_bf16 v[152:167], v[56:59], v[176:179], v[152:167]
  ds_read_b64_tr_b16 v[176:177], v212 offset:45056
  ds_read_b64_tr_b16 v[178:179], v212 offset:45312
  v_mfma_f32_32x32x16_bf16 v[120:135], v[180:183], v[60:63], v[120:135]
  ds_read_b64_tr_b16 v[180:181], v212 offset:46080
  ds_read_b64_tr_b16 v[182:183], v212 offset:46336
  s_waitcnt lgkmcnt(8)
  v_mfma_f32_32x32x16_bf16 v[136:151], v[184:187], v[60:63], v[136:151]
  ds_read_b64_tr_b16 v[184:185], v212 offset:47104
  ds_read_b64_tr_b16 v[186:187], v212 offset:47360
  v_mfma_f32_32x32x16_bf16 v[152:167], v[60:63], v[188:191], v[152:167]
  ds_read_b64_tr_b16 v[188:189], v212 offset:48128
  ds_read_b64_tr_b16 v[190:191], v212 offset:48384
  s_waitcnt lgkmcnt(8)
  v_mfma_f32_32x32x16_bf16 v[120:135], v[168:171], v[64:67], v[120:135]
  v_mfma_f32_32x32x16_bf16 v[136:151], v[172:175], v[64:67], v[136:151]
  s_waitcnt lgkmcnt(4)
  v_mfma_f32_32x32x16_bf16 v[152:167], v[64:67], v[176:179], v[152:167]
  v_mfma_f32_32x32x16_bf16 v[120:135], v[180:183], v[68:71], v[120:135]
  s_waitcnt lgkmcnt(0)
  v_mfma_f32_32x32x16_bf16 v[136:151], v[184:187], v[68:71], v[136:151]
  v_mfma_f32_32x32x16_bf16 v[152:167], v[68:71], v[188:191], v[152:167]
  s_waitcnt vmcnt(0)
  s_barrier
  ds_read_b128 v[72:75], v198 offset:0
  ds_read_b128 v[76:79], v199 offset:0
  ds_read_b128 v[80:83], v198 offset:2048
  ds_read_b128 v[84:87], v199 offset:2048
  ds_read_b128 v[88:91], v198 offset:4096
  ds_read_b128 v[92:95], v199 offset:4096
  ds_read_b128 v[96:99], v198 offset:6144
  ds_read_b128 v[100:103], v199 offset:6144
  ds_read_b128 v[104:107], v198 offset:8192
  ds_read_b128 v[108:111], v199 offset:8192
  ds_read_b128 v[112:115], v198 offset:10240
  ds_read_b128 v[116:119], v199 offset:10240
  s_mov_b32 s36, s8
  s_mov_b32 s37, s9
  s_mov_b32 s38, 401408
  s_lshl_b32 s69, s44, 2
  s_add_u32 s69, s69, s42
  s_lshl_b32 s69, s69, 12
  v_and_b32 v194, 31, v0
  v_lshlrev_b32 v194, 7, v194
  buffer_load_dword v6, v194, s[36:39], s69 offen
  s_mov_b32 s32, s14
  s_mov_b32 s33, s15
  s_mov_b32 s34, 8388608
  s_mov_b32 s35, 0x20000
  s_lshl_b32 s60, s44, 2
  s_add_u32 s60, s60, s42
  s_lshl_b32 s61, s60, 13
  s_lshl_b32 s62, s43, 20
  s_add_u32 s61, s61, s62
  v_lshlrev_b32 v194, 7, v0
  buffer_load_dword v6, v194, s[32:35], s61 offen
  s_waitcnt lgkmcnt(0)
  v_dot2_f32_bf16 v208, v72, v72, v208
  v_dot2_f32_bf16 v204, v72, s66, v204
  v_dot2_f32_bf16 v209, v73, v73, v209
  v_dot2_f32_bf16 v205, v73, s66, v205
  v_dot2_f32_bf16 v210, v74, v74, v210
  v_dot2_f32_bf16 v206, v74, s66, v206
  v_dot2_f32_bf16 v211, v75, v75, v211
  v_dot2_f32_bf16 v207, v75, s66, v207
  v_dot2_f32_bf16 v208, v76, v76, v208
  v_dot2_f32_bf16 v204, v76, s66, v204
  v_dot2_f32_bf16 v209, v77, v77, v209
  v_dot2_f32_bf16 v205, v77, s66, v205
  v_dot2_f32_bf16 v210, v78, v78, v210
  v_dot2_f32_bf16 v206, v78, s66, v206
  v_dot2_f32_bf16 v211, v79, v79, v211
  v_dot2_f32_bf16 v207, v79, s66, v207
  v_dot2_f32_bf16 v208, v80, v80, v208
  v_dot2_f32_bf16 v204, v80, s66, v204
  v_dot2_f32_bf16 v209, v81, v81, v209
  v_dot2_f32_bf16 v205, v81, s66, v205
  v_dot2_f32_bf16 v210, v82, v82, v210
  v_dot2_f32_bf16 v206, v82, s66, v206
  v_dot2_f32_bf16 v211, v83, v83, v211
  v_dot2_f32_bf16 v207, v83, s66, v207
  v_dot2_f32_bf16 v208, v84, v84, v208
  v_dot2_f32_bf16 v204, v84, s66, v204
  v_dot2_f32_bf16 v209, v85, v85, v209
  v_dot2_f32_bf16 v205, v85, s66, v205
  v_dot2_f32_bf16 v210, v86, v86, v210
  v_dot2_f32_bf16 v206, v86, s66, v206
  v_dot2_f32_bf16 v211, v87, v87, v211
  v_dot2_f32_bf16 v207, v87, s66, v207
  v_dot2_f32_bf16 v208, v88, v88, v208
  v_dot2_f32_bf16 v204, v88, s66, v204
  v_dot2_f32_bf16 v209, v89, v89, v209
  v_dot2_f32_bf16 v205, v89, s66, v205
  v_dot2_f32_bf16 v210, v90, v90, v210
  v_dot2_f32_bf16 v206, v90, s66, v206
  v_dot2_f32_bf16 v211, v91, v91, v211
  v_dot2_f32_bf16 v207, v91, s66, v207
  v_dot2_f32_bf16 v208, v92, v92, v208
  v_dot2_f32_bf16 v204, v92, s66, v204
  v_dot2_f32_bf16 v209, v93, v93, v209
  v_dot2_f32_bf16 v205, v93, s66, v205
  v_dot2_f32_bf16 v210, v94, v94, v210
  v_dot2_f32_bf16 v206, v94, s66, v206
  v_dot2_f32_bf16 v211, v95, v95, v211
  v_dot2_f32_bf16 v207, v95, s66, v207
  v_dot2_f32_bf16 v208, v96, v96, v208
  v_dot2_f32_bf16 v204, v96, s66, v204
  v_dot2_f32_bf16 v209, v97, v97, v209
  v_dot2_f32_bf16 v205, v97, s66, v205
  v_dot2_f32_bf16 v210, v98, v98, v210
  v_dot2_f32_bf16 v206, v98, s66, v206
  v_dot2_f32_bf16 v211, v99, v99, v211
  v_dot2_f32_bf16 v207, v99, s66, v207
  v_dot2_f32_bf16 v208, v100, v100, v208
  v_dot2_f32_bf16 v204, v100, s66, v204
  v_dot2_f32_bf16 v209, v101, v101, v209
  v_dot2_f32_bf16 v205, v101, s66, v205
  v_dot2_f32_bf16 v210, v102, v102, v210
  v_dot2_f32_bf16 v206, v102, s66, v206
  v_dot2_f32_bf16 v211, v103, v103, v211
  v_dot2_f32_bf16 v207, v103, s66, v207
  v_dot2_f32_bf16 v208, v104, v104, v208
  v_dot2_f32_bf16 v204, v104, s66, v204
  v_dot2_f32_bf16 v209, v105, v105, v209
  v_dot2_f32_bf16 v205, v105, s66, v205
  v_dot2_f32_bf16 v210, v106, v106, v210
  v_dot2_f32_bf16 v206, v106, s66, v206
  v_dot2_f32_bf16 v211, v107, v107, v211
  v_dot2_f32_bf16 v207, v107, s66, v207
  v_dot2_f32_bf16 v208, v108, v108, v208
  v_dot2_f32_bf16 v204, v108, s66, v204
  v_dot2_f32_bf16 v209, v109, v109, v209
  v_dot2_f32_bf16 v205, v109, s66, v205
  v_dot2_f32_bf16 v210, v110, v110, v210
  v_dot2_f32_bf16 v206, v110, s66, v206
  v_dot2_f32_bf16 v211, v111, v111, v211
  v_dot2_f32_bf16 v207, v111, s66, v207
  v_dot2_f32_bf16 v208, v112, v112, v208
  v_dot2_f32_bf16 v204, v112, s66, v204
  v_dot2_f32_bf16 v209, v113, v113, v209
  v_dot2_f32_bf16 v205, v113, s66, v205
  v_dot2_f32_bf16 v210, v114, v114, v210
  v_dot2_f32_bf16 v206, v114, s66, v206
  v_dot2_f32_bf16 v211, v115, v115, v211
  v_dot2_f32_bf16 v207, v115, s66, v207
  v_dot2_f32_bf16 v208, v116, v116, v208
  v_dot2_f32_bf16 v204, v116, s66, v204
  v_dot2_f32_bf16 v209, v117, v117, v209
  v_dot2_f32_bf16 v205, v117, s66, v205
  v_dot2_f32_bf16 v210, v118, v118, v210
  v_dot2_f32_bf16 v206, v118, s66, v206
  v_dot2_f32_bf16 v211, v119, v119, v211
  v_dot2_f32_bf16 v207, v119, s66, v207
  ds_read_b64_tr_b16 v[168:169], v212 offset:49152
  ds_read_b64_tr_b16 v[170:171], v212 offset:49408
  ds_read_b64_tr_b16 v[172:173], v212 offset:50176
  ds_read_b64_tr_b16 v[174:175], v212 offset:50432
  ds_read_b64_tr_b16 v[176:177], v212 offset:51200
  ds_read_b64_tr_b16 v[178:179], v212 offset:51456
  ds_read_b64_tr_b16 v[180:181], v212 offset:52224
  ds_read_b64_tr_b16 v[182:183], v212 offset:52480
  ds_read_b64_tr_b16 v[184:185], v212 offset:53248
  ds_read_b64_tr_b16 v[186:187], v212 offset:53504
  ds_read_b64_tr_b16 v[188:189], v212 offset:54272
  ds_read_b64_tr_b16 v[190:191], v212 offset:54528
  s_waitcnt lgkmcnt(8)
  v_mfma_f32_32x32x16_bf16 v[120:135], v[168:171], v[72:75], v[120:135]
  ds_read_b64_tr_b16 v[168:169], v212 offset:55296
  ds_read_b64_tr_b16 v[170:171], v212 offset:55552
  v_mfma_f32_32x32x16_bf16 v[136:151], v[172:175], v[72:75], v[136:151]
  ds_read_b64_tr_b16 v[172:173], v212 offset:56320
  ds_read_b64_tr_b16 v[174:175], v212 offset:56576
  s_waitcnt lgkmcnt(8)
  v_mfma_f32_32x32x16_bf16 v[152:167], v[72:75], v[176:179], v[152:167]
  ds_read_b64_tr_b16 v[176:177], v212 offset:57344
  ds_read_b64_tr_b16 v[178:179], v212 offset:57600
  v_mfma_f32_32x32x16_bf16 v[120:135], v[180:183], v[76:79], v[120:135]
  ds_read_b64_tr_b16 v[180:181], v212 offset:58368
  ds_read_b64_tr_b16 v[182:183], v212 offset:58624
  s_waitcnt lgkmcnt(8)
  v_mfma_f32_32x32x16_bf16 v[136:151], v[184:187], v[76:79], v[136:151]
  ds_read_b64_tr_b16 v[184:185], v212 offset:59392
  ds_read_b64_tr_b16 v[186:187], v212 offset:59648
  v_mfma_f32_32x32x16_bf16 v[152:167], v[76:79], v[188:191], v[152:167]
  ds_read_b64_tr_b16 v[188:189], v212 offset:60416
  ds_read_b64_tr_b16 v[190:191], v212 offset:60672
  s_waitcnt lgkmcnt(8)
  v_mfma_f32_32x32x16_bf16 v[120:135], v[168:171], v[80:83], v[120:135]
  ds_read_b64_tr_b16 v[168:169], v213 offset:0
  ds_read_b64_tr_b16 v[170:171], v213 offset:256
  v_mfma_f32_32x32x16_bf16 v[136:151], v[172:175], v[80:83], v[136:151]
  ds_read_b64_tr_b16 v[172:173], v213 offset:1024
  ds_read_b64_tr_b16 v[174:175], v213 offset:1280
  s_waitcnt lgkmcnt(8)
  v_mfma_f32_32x32x16_bf16 v[152:167], v[80:83], v[176:179], v[152:167]
  ds_read_b64_tr_b16 v[176:177], v213 offset:2048
  ds_read_b64_tr_b16 v[178:179], v213 offset:2304
  v_mfma_f32_32x32x16_bf16 v[120:135], v[180:183], v[84:87], v[120:135]
  ds_read_b64_tr_b16 v[180:181], v213 offset:3072
  ds_read_b64_tr_b16 v[182:183], v213 offset:3328
  s_waitcnt lgkmcnt(8)
  v_mfma_f32_32x32x16_bf16 v[136:151], v[184:187], v[84:87], v[136:151]
  ds_read_b64_tr_b16 v[184:185], v213 offset:4096
  ds_read_b64_tr_b16 v[186:187], v213 offset:4352
  v_mfma_f32_32x32x16_bf16 v[152:167], v[84:87], v[188:191], v[152:167]
  ds_read_b64_tr_b16 v[188:189], v213 offset:5120
  ds_read_b64_tr_b16 v[190:191], v213 offset:5376
  s_waitcnt lgkmcnt(8)
  v_mfma_f32_32x32x16_bf16 v[120:135], v[168:171], v[88:91], v[120:135]
  ds_read_b64_tr_b16 v[168:169], v213 offset:6144
  ds_read_b64_tr_b16 v[170:171], v213 offset:6400
  v_mfma_f32_32x32x16_bf16 v[136:151], v[172:175], v[88:91], v[136:151]
  ds_read_b64_tr_b16 v[172:173], v213 offset:7168
  ds_read_b64_tr_b16 v[174:175], v213 offset:7424
  s_waitcnt lgkmcnt(8)
  v_mfma_f32_32x32x16_bf16 v[152:167], v[88:91], v[176:179], v[152:167]
  ds_read_b64_tr_b16 v[176:177], v213 offset:8192
  ds_read_b64_tr_b16 v[178:179], v213 offset:8448
  v_mfma_f32_32x32x16_bf16 v[120:135], v[180:183], v[92:95], v[120:135]
  ds_read_b64_tr_b16 v[180:181], v213 offset:9216
  ds_read_b64_tr_b16 v[182:183], v213 offset:9472
  s_waitcnt lgkmcnt(8)
  v_mfma_f32_32x32x16_bf16 v[136:151], v[184:187], v[92:95], v[136:151]
  ds_read_b64_tr_b16 v[184:185], v213 offset:10240
  ds_read_b64_tr_b16 v[186:187], v213 offset:10496
  v_mfma_f32_32x32x16_bf16 v[152:167], v[92:95], v[188:191], v[152:167]
  ds_read_b64_tr_b16 v[188:189], v213 offset:11264
  ds_read_b64_tr_b16 v[190:191], v213 offset:11520
  s_waitcnt lgkmcnt(8)
  v_mfma_f32_32x32x16_bf16 v[120:135], v[168:171], v[96:99], v[120:135]
  ds_read_b64_tr_b16 v[168:169], v213 offset:12288
  ds_read_b64_tr_b16 v[170:171], v213 offset:12544
  v_mfma_f32_32x32x16_bf16 v[136:151], v[172:175], v[96:99], v[136:151]
  ds_read_b64_tr_b16 v[172:173], v213 offset:13312
  ds_read_b64_tr_b16 v[174:175], v213 offset:13568
  s_waitcnt lgkmcnt(8)
  v_mfma_f32_32x32x16_bf16 v[152:167], v[96:99], v[176:179], v[152:167]
  ds_read_b64_tr_b16 v[176:177], v213 offset:14336
  ds_read_b64_tr_b16 v[178:179], v213 offset:14592
  v_mfma_f32_32x32x16_bf16 v[120:135], v[180:183], v[100:103], v[120:135]
  ds_read_b64_tr_b16 v[180:181], v213 offset:15360
  ds_read_b64_tr_b16 v[182:183], v213 offset:15616
  s_waitcnt lgkmcnt(8)
  v_mfma_f32_32x32x16_bf16 v[136:151], v[184:187], v[100:103], v[136:151]
  ds_read_b64_tr_b16 v[184:185], v213 offset:16384
  ds_read_b64_tr_b16 v[186:187], v213 offset:16640
  v_mfma_f32_32x32x16_bf16 v[152:167], v[100:103], v[188:191], v[152:167]
  ds_read_b64_tr_b16 v[188:189], v213 offset:17408
  ds_read_b64_tr_b16 v[190:191], v213 offset:17664
  s_waitcnt lgkmcnt(8)
  v_mfma_f32_32x32x16_bf16 v[120:135], v[168:171], v[104:107], v[120:135]
  ds_read_b64_tr_b16 v[168:169], v213 offset:18432
  ds_read_b64_tr_b16 v[170:171], v213 offset:18688
  v_mfma_f32_32x32x16_bf16 v[136:151], v[172:175], v[104:107], v[136:151]
  ds_read_b64_tr_b16 v[172:173], v213 offset:19456
  ds_read_b64_tr_b16 v[174:175], v213 offset:19712
  s_waitcnt lgkmcnt(8)
  v_mfma_f32_32x32x16_bf16 v[152:167], v[104:107], v[176:179], v[152:167]
  ds_read_b64_tr_b16 v[176:177], v213 offset:20480
  ds_read_b64_tr_b16 v[178:179], v213 offset:20736
  v_mfma_f32_32x32x16_bf16 v[120:135], v[180:183], v[108:111], v[120:135]
  ds_read_b64_tr_b16 v[180:181], v213 offset:21504
  ds_read_b64_tr_b16 v[182:183], v213 offset:21760
  s_waitcnt lgkmcnt(8)
  v_mfma_f32_32x32x16_bf16 v[136:151], v[184:187], v[108:111], v[136:151]
  ds_read_b64_tr_b16 v[184:185], v213 offset:22528
  ds_read_b64_tr_b16 v[186:187], v213 offset:22784
  v_mfma_f32_32x32x16_bf16 v[152:167], v[108:111], v[188:191], v[152:167]
  ds_read_b64_tr_b16 v[188:189], v213 offset:23552
  ds_read_b64_tr_b16 v[190:191], v213 offset:23808
  s_waitcnt lgkmcnt(8)
  v_mfma_f32_32x32x16_bf16 v[120:135], v[168:171], v[112:115], v[120:135]
  v_mfma_f32_32x32x16_bf16 v[136:151], v[172:175], v[112:115], v[136:151]
  s_waitcnt lgkmcnt(4)
  v_mfma_f32_32x32x16_bf16 v[152:167], v[112:115], v[176:179], v[152:167]
  v_mfma_f32_32x32x16_bf16 v[120:135], v[180:183], v[116:119], v[120:135]
  s_waitcnt lgkmcnt(0)
  v_mfma_f32_32x32x16_bf16 v[136:151], v[184:187], v[116:119], v[136:151]
  v_mfma_f32_32x32x16_bf16 v[152:167], v[116:119], v[188:191], v[152:167]
  v_add_f32 v204, v204, v205
  v_add_f32 v206, v206, v207
  v_add_f32 v204, v204, v206
  v_add_f32 v208, v208, v209
  v_add_f32 v210, v210, v211
  v_add_f32 v208, v208, v210
  s_mul_i32 s60, s42, 21504
  v_add_u32 v220, s60, v2
  v_mov_b32 v216, 0x3f803f80
  v_mov_b32 v217, 0x3f803f80
  v_mov_b32 v218, 0x3f803f80
  v_mov_b32 v219, 0x3f803f80
  ds_read_b64_tr_b16 v[168:169], v220 offset:0
  ds_read_b64_tr_b16 v[170:171], v220 offset:256
  ds_read_b64_tr_b16 v[172:173], v220 offset:1024
  ds_read_b64_tr_b16 v[174:175], v220 offset:1280
  ds_read_b64_tr_b16 v[176:177], v220 offset:2048
  ds_read_b64_tr_b16 v[178:179], v220 offset:2304
  ds_read_b64_tr_b16 v[180:181], v220 offset:3072
  ds_read_b64_tr_b16 v[182:183], v220 offset:3328
  ds_read_b64_tr_b16 v[184:185], v220 offset:4096
  ds_read_b64_tr_b16 v[186:187], v220 offset:4352
  ds_read_b64_tr_b16 v[188:189], v220 offset:5120
  ds_read_b64_tr_b16 v[190:191], v220 offset:5376
  s_waitcnt lgkmcnt(8)
  v_mfma_f32_32x32x16_bf16 v[8:23], v[216:219], v[168:171], 0
  ds_read_b64_tr_b16 v[168:169], v220 offset:6144
  ds_read_b64_tr_b16 v[170:171], v220 offset:6400
  v_mfma_f32_32x32x16_bf16 v[24:39], v[216:219], v[172:175], 0
  ds_read_b64_tr_b16 v[172:173], v220 offset:7168
  ds_read_b64_tr_b16 v[174:175], v220 offset:7424
  s_waitcnt lgkmcnt(8)
  v_mfma_f32_32x32x16_bf16 v[40:55], v[216:219], v[176:179], 0
  ds_read_b64_tr_b16 v[176:177], v220 offset:8192
  ds_read_b64_tr_b16 v[178:179], v220 offset:8448
  v_mfma_f32_32x32x16_bf16 v[8:23], v[216:219], v[180:183], v[8:23]
  ds_read_b64_tr_b16 v[180:181], v220 offset:9216
  ds_read_b64_tr_b16 v[182:183], v220 offset:9472
  s_waitcnt lgkmcnt(8)
  v_mfma_f32_32x32x16_bf16 v[24:39], v[216:219], v[184:187], v[24:39]
  ds_read_b64_tr_b16 v[184:185], v220 offset:10240
  ds_read_b64_tr_b16 v[186:187], v220 offset:10496
  v_mfma_f32_32x32x16_bf16 v[40:55], v[216:219], v[188:191], v[40:55]
  ds_read_b64_tr_b16 v[188:189], v220 offset:11264
  ds_read_b64_tr_b16 v[190:191], v220 offset:11520
  s_waitcnt lgkmcnt(8)
  v_mfma_f32_32x32x16_bf16 v[8:23], v[216:219], v[168:171], v[8:23]
  ds_read_b64_tr_b16 v[168:169], v220 offset:12288
  ds_read_b64_tr_b16 v[170:171], v220 offset:12544
  v_mfma_f32_32x32x16_bf16 v[24:39], v[216:219], v[172:175], v[24:39]
  ds_read_b64_tr_b16 v[172:173], v220 offset:13312
  ds_read_b64_tr_b16 v[174:175], v220 offset:13568
  s_waitcnt lgkmcnt(8)
  v_mfma_f32_32x32x16_bf16 v[40:55], v[216:219], v[176:179], v[40:55]
  ds_read_b64_tr_b16 v[176:177], v220 offset:14336
  ds_read_b64_tr_b16 v[178:179], v220 offset:14592
  v_mfma_f32_32x32x16_bf16 v[8:23], v[216:219], v[180:183], v[8:23]
  ds_read_b64_tr_b16 v[180:181], v220 offset:15360
  ds_read_b64_tr_b16 v[182:183], v220 offset:15616
  s_waitcnt lgkmcnt(8)
  v_mfma_f32_32x32x16_bf16 v[24:39], v[216:219], v[184:187], v[24:39]
  ds_read_b64_tr_b16 v[184:185], v220 offset:16384
  ds_read_b64_tr_b16 v[186:187], v220 offset:16640
  v_mfma_f32_32x32x16_bf16 v[40:55], v[216:219], v[188:191], v[40:55]
  ds_read_b64_tr_b16 v[188:189], v220 offset:17408
  ds_read_b64_tr_b16 v[190:191], v220 offset:17664
  s_waitcnt lgkmcnt(8)
  v_mfma_f32_32x32x16_bf16 v[8:23], v[216:219], v[168:171], v[8:23]
  ds_read_b64_tr_b16 v[168:169], v220 offset:18432
  ds_read_b64_tr_b16 v[170:171], v220 offset:18688
  v_mfma_f32_32x32x16_bf16 v[24:39], v[216:219], v[172:175], v[24:39]
  ds_read_b64_tr_b16 v[172:173], v220 offset:19456
  ds_read_b64_tr_b16 v[174:175], v220 offset:19712
  s_waitcnt lgkmcnt(8)
  v_mfma_f32_32x32x16_bf16 v[40:55], v[216:219], v[176:179], v[40:55]
  ds_read_b64_tr_b16 v[176:177], v220 offset:20480
  ds_read_b64_tr_b16 v[178:179], v220 offset:20736
  v_mfma_f32_32x32x16_bf16 v[8:23], v[216:219], v[180:183], v[8:23]
  s_waitcnt lgkmcnt(6)
  v_mfma_f32_32x32x16_bf16 v[24:39], v[216:219], v[184:187], v[24:39]
  v_mfma_f32_32x32x16_bf16 v[40:55], v[216:219], v[188:191], v[40:55]
  s_waitcnt lgkmcnt(2)
  v_mfma_f32_32x32x16_bf16 v[8:23], v[216:219], v[168:171], v[8:23]
  v_mfma_f32_32x32x16_bf16 v[24:39], v[216:219], v[172:175], v[24:39]
  s_waitcnt lgkmcnt(0)
  v_mfma_f32_32x32x16_bf16 v[40:55], v[216:219], v[176:179], v[40:55]
  s_mul_i32 s60, s52, 6
  s_add_u32 s60, s60, s42
  s_min_u32 s60, s60, 83
  s_lshl_b32 s61, s60, 10
  v_add_u32 v194, s61, v1
  ds_read_b128 v[64:67], v194
  s_mul_i32 s55, s53, 86016
  s_add_u32 s55, s55, s61
  s_add_u32 s55, s55, 0
  s_mul_i32 s60, s52, 6
  s_and_b32 s61, s42, 1
  s_add_u32 s60, s60, s61
  s_add_u32 s60, s60, 4
  s_min_u32 s60, s60, 83
  s_lshl_b32 s61, s60, 10
  v_add_u32 v194, s61, v1
  ds_read_b128 v[68:71], v194
  s_mul_i32 s56, s53, 86016
  s_add_u32 s56, s56, s61
  s_add_u32 s56, s56, 0
  s_lshl_b32 s60, s42, 9
  s_add_u32 s60, s60, 160768
  v_and_b32 v194, 31, v0
  v_lshlrev_b32 v194, 2, v194
  v_add_u32 v195, s60, v194
  ds_write_b32 v195, v8 offset:0
  ds_write_b32 v195, v24 offset:128
  ds_write_b32 v195, v40 offset:256
  s_waitcnt lgkmcnt(0)
  buffer_store_dwordx4 v[64:67], v1, s[28:31], s55 offen sc1
  buffer_store_dwordx4 v[68:71], v1, s[28:31], s56 offen sc1
  s_barrier
  v_add_u32 v195, 160768, v194
  ds_read_b32 v8, v195 offset:0
  ds_read_b32 v9, v195 offset:512
  ds_read_b32 v10, v195 offset:1024
  ds_read_b32 v11, v195 offset:1536
  ds_read_b32 v12, v195 offset:128
  ds_read_b32 v13, v195 offset:640
  ds_read_b32 v14, v195 offset:1152
  ds_read_b32 v15, v195 offset:1664
  ds_read_b32 v16, v195 offset:256
  ds_read_b32 v17, v195 offset:768
  ds_read_b32 v18, v195 offset:1280
  ds_read_b32 v19, v195 offset:1792
  s_waitcnt lgkmcnt(0)
  v_add_u32 v195, 159744, v194
  v_add_f32 v8, v8, v9
  v_add_f32 v10, v10, v11
  v_add_f32 v8, v8, v10
  ds_write_b32 v195, v8 offset:0
  v_add_f32 v12, v12, v13
  v_add_f32 v14, v14, v15
  v_add_f32 v12, v12, v14
  ds_write_b32 v195, v12 offset:128
  v_add_f32 v16, v16, v17
  v_add_f32 v18, v18, v19
  v_add_f32 v16, v16, v18
  ds_write_b32 v195, v16 offset:256
  v_mov_b32 v12, v204
  v_mov_b32 v13, v204
  s_nop 1
  v_permlane32_swap_b32 v12, v13
  v_add_f32 v8, v12, v13
  v_mov_b32 v12, v208
  v_mov_b32 v13, v208
  s_nop 1
  v_permlane32_swap_b32 v12, v13
  v_add_f32 v9, v12, v13
  v_mul_f32 v8, 0x3b124925, v8
  v_mul_f32 v9, 0x3b124925, v9
  v_fma_f32 v9, -v8, v8, v9
  v_max_f32 v9, 0, v9
  v_add_f32 v9, 0x3727c5ac, v9
  v_rsq_f32 v9, v9
  v_sub_f32 v10, 0, v8
  s_lshl_b32 s72, s42, 8
  s_add_u32 s72, s72, 162816
  v_and_b32 v14, 31, v0
  v_lshlrev_b32 v14, 2, v14
  v_add_u32 v15, s72, v14
  v_mul_f32 v12, v10, v9
  ds_write_b32 v15, v9
  ds_write_b32 v15, v12 offset:128
  v_lshrrev_b32 v16, 5, v0
  v_lshlrev_b32 v16, 4, v16
  v_add_u32 v17, 159744, v16
  ds_read_b128 v[20:23], v17 offset:0
  ds_read_b128 v[24:27], v17 offset:32
  ds_read_b128 v[28:31], v17 offset:64
  ds_read_b128 v[32:35], v17 offset:96
  ds_read_b128 v[36:39], v17 offset:128
  ds_read_b128 v[40:43], v17 offset:160
  ds_read_b128 v[44:47], v17 offset:192
  ds_read_b128 v[48:51], v17 offset:224
  v_add_u32 v14, 160000, v14
  ds_read_b32 v52, v14
  v_add_u32 v16, s72, v16
  ds_read_b128 v[56:59], v16 offset:0
  ds_read_b128 v[60:63], v16 offset:32
  ds_read_b128 v[64:67], v16 offset:64
  ds_read_b128 v[68:71], v16 offset:96
  ds_read_b128 v[72:75], v16 offset:128
  ds_read_b128 v[76:79], v16 offset:160
  ds_read_b128 v[80:83], v16 offset:192
  ds_read_b128 v[84:87], v16 offset:224
  v_mul_f32 v18, 0x3e8b97f6, v9
  v_mov_b32 v54, v9
  s_lshl_b32 s72, s53, 6
  s_add_u32 s72, s72, s54
  s_lshl_b32 s74, s72, 12
  s_add_u32 s74, s74, s46
  s_add_u32 s74, s74, 2097152
  s_lshl_b32 s75, s72, 2
  s_add_u32 s75, s75, s46
  s_add_u32 s75, s75, 31195136
  s_waitcnt lgkmcnt(9)
  v_pk_fma_f32 v[136:137], v[36:37], v[10:11], v[136:137] op_sel_hi:[1,0,1]
  v_pk_fma_f32 v[138:139], v[38:39], v[10:11], v[138:139] op_sel_hi:[1,0,1]
  v_pk_fma_f32 v[140:141], v[40:41], v[10:11], v[140:141] op_sel_hi:[1,0,1]
  v_pk_fma_f32 v[142:143], v[42:43], v[10:11], v[142:143] op_sel_hi:[1,0,1]
  v_pk_fma_f32 v[144:145], v[44:45], v[10:11], v[144:145] op_sel_hi:[1,0,1]
  v_pk_fma_f32 v[146:147], v[46:47], v[10:11], v[146:147] op_sel_hi:[1,0,1]
  v_pk_fma_f32 v[148:149], v[48:49], v[10:11], v[148:149] op_sel_hi:[1,0,1]
  v_pk_fma_f32 v[150:151], v[50:51], v[10:11], v[150:151] op_sel_hi:[1,0,1]
  v_pk_mul_f32 v[136:137], v[136:137], v[54:55] op_sel_hi:[1,0]
  v_pk_mul_f32 v[138:139], v[138:139], v[54:55] op_sel_hi:[1,0]
  v_pk_mul_f32 v[140:141], v[140:141], v[54:55] op_sel_hi:[1,0]
  v_pk_mul_f32 v[142:143], v[142:143], v[54:55] op_sel_hi:[1,0]
  v_pk_mul_f32 v[144:145], v[144:145], v[54:55] op_sel_hi:[1,0]
  v_pk_mul_f32 v[146:147], v[146:147], v[54:55] op_sel_hi:[1,0]
  v_pk_mul_f32 v[148:149], v[148:149], v[54:55] op_sel_hi:[1,0]
  v_pk_mul_f32 v[150:151], v[150:151], v[54:55] op_sel_hi:[1,0]
  v_cndmask_b32_e64 v148, v148, 0, s[48:49]
  v_cndmask_b32_e64 v149, v149, 0, s[48:49]
  v_cndmask_b32_e64 v150, v150, 0, s[48:49]
  v_cndmask_b32_e64 v151, v151, 0, s[48:49]
  v_cvt_pk_bf16_f32 v96, v136, v137
  v_cvt_pk_bf16_f32 v97, v138, v139
  v_cvt_pk_bf16_f32 v98, v140, v141
  v_cvt_pk_bf16_f32 v99, v142, v143
  v_cvt_pk_bf16_f32 v100, v144, v145
  v_cvt_pk_bf16_f32 v101, v146, v147
  v_cvt_pk_bf16_f32 v102, v148, v149
  v_cvt_pk_bf16_f32 v103, v150, v151
  v_mov_b32 v12, 0x3f80
  v_cndmask_b32_e64 v102, v102, v12, s[48:49]
  buffer_store_dwordx4 v[96:99], v1, s[28:31], s74 offen offset:0 sc1
  buffer_store_dwordx4 v[100:103], v1, s[28:31], s74 offen offset:1024 sc1
  s_waitcnt lgkmcnt(0)
  v_pk_mul_f32 v[72:73], v[72:73], v[52:53] op_sel_hi:[1,0]
  v_pk_mul_f32 v[74:75], v[74:75], v[52:53] op_sel_hi:[1,0]
  v_pk_mul_f32 v[76:77], v[76:77], v[52:53] op_sel_hi:[1,0]
  v_pk_mul_f32 v[78:79], v[78:79], v[52:53] op_sel_hi:[1,0]
  v_pk_mul_f32 v[80:81], v[80:81], v[52:53] op_sel_hi:[1,0]
  v_pk_mul_f32 v[82:83], v[82:83], v[52:53] op_sel_hi:[1,0]
  v_pk_mul_f32 v[84:85], v[84:85], v[52:53] op_sel_hi:[1,0]
  v_pk_mul_f32 v[86:87], v[86:87], v[52:53] op_sel_hi:[1,0]
  v_pk_fma_f32 v[152:153], v[152:153], v[56:57], v[72:73]
  v_pk_fma_f32 v[154:155], v[154:155], v[58:59], v[74:75]
  v_pk_fma_f32 v[156:157], v[156:157], v[60:61], v[76:77]
  v_pk_fma_f32 v[158:159], v[158:159], v[62:63], v[78:79]
  v_pk_fma_f32 v[160:161], v[160:161], v[64:65], v[80:81]
  v_pk_fma_f32 v[162:163], v[162:163], v[66:67], v[82:83]
  v_pk_fma_f32 v[164:165], v[164:165], v[68:69], v[84:85]
  v_pk_fma_f32 v[166:167], v[166:167], v[70:71], v[86:87]
  v_cvt_pk_bf16_f32 v104, v152, v153
  v_cvt_pk_bf16_f32 v105, v154, v155
  v_cvt_pk_bf16_f32 v106, v156, v157
  v_cvt_pk_bf16_f32 v107, v158, v159
  v_cvt_pk_bf16_f32 v108, v160, v161
  v_cvt_pk_bf16_f32 v109, v162, v163
  v_cvt_pk_bf16_f32 v110, v164, v165
  v_cvt_pk_bf16_f32 v111, v166, v167
  v_and_b32 v12, 31, v0
  v_cmp_eq_u32 vcc, 28, v12
  v_mov_b32 v13, 0x3f803f80
  s_nop 0
  v_cndmask_b32 v12, 0, v13, vcc
  v_cndmask_b32_e64 v104, v104, v12, s[50:51]
  v_cndmask_b32_e64 v105, v105, v12, s[50:51]
  v_cndmask_b32_e64 v106, v106, v12, s[50:51]
  v_cndmask_b32_e64 v107, v107, v12, s[50:51]
  v_cndmask_b32_e64 v108, v108, v12, s[50:51]
  v_cndmask_b32_e64 v109, v109, v12, s[50:51]
  v_cndmask_b32_e64 v110, v110, v12, s[50:51]
  v_cndmask_b32_e64 v111, v111, v12, s[50:51]
  buffer_store_dwordx4 v[104:107], v1, s[28:31], s74 offen offset:2048 sc1
  buffer_store_dwordx4 v[108:111], v1, s[28:31], s74 offen offset:3072 sc1
  v_pk_mul_f32 v[112:113], v[136:137], v[136:137]
  v_pk_fma_f32 v[112:113], v[138:139], v[138:139], v[112:113]
  v_pk_fma_f32 v[112:113], v[140:141], v[140:141], v[112:113]
  v_pk_fma_f32 v[112:113], v[142:143], v[142:143], v[112:113]
  v_pk_fma_f32 v[112:113], v[144:145], v[144:145], v[112:113]
  v_pk_fma_f32 v[112:113], v[146:147], v[146:147], v[112:113]
  v_pk_fma_f32 v[112:113], v[148:149], v[148:149], v[112:113]
  v_pk_fma_f32 v[112:113], v[150:151], v[150:151], v[112:113]
  v_add_f32 v112, v112, v113
  v_mov_b32 v12, v112
  v_mov_b32 v13, v112
  s_nop 1
  v_permlane32_swap_b32 v12, v13
  v_add_f32 v112, v12, v13
  s_nop 1
  v_max_f32_dpp v112, v112, v112 row_ror:8 row_mask:0xf bank_mask:0xf
  s_nop 1
  v_max_f32_dpp v112, v112, v112 row_ror:4 row_mask:0xf bank_mask:0xf
  s_nop 1
  v_max_f32_dpp v112, v112, v112 row_ror:2 row_mask:0xf bank_mask:0xf
  s_nop 1
  v_max_f32_dpp v112, v112, v112 row_ror:1 row_mask:0xf bank_mask:0xf
  v_mov_b32 v12, v112
  v_mov_b32 v13, v112
  s_nop 1
  v_permlane16_swap_b32 v12, v13
  v_max_f32 v114, v12, v13
  v_mov_b32 v12, 0
  buffer_store_dword v114, v12, s[28:31], s75 offen sc1
  v_pk_fma_f32 v[120:121], v[20:21], v[10:11], v[120:121] op_sel_hi:[1,0,1]
  v_pk_fma_f32 v[122:123], v[22:23], v[10:11], v[122:123] op_sel_hi:[1,0,1]
  v_pk_fma_f32 v[124:125], v[24:25], v[10:11], v[124:125] op_sel_hi:[1,0,1]
  v_pk_fma_f32 v[126:127], v[26:27], v[10:11], v[126:127] op_sel_hi:[1,0,1]
  v_pk_fma_f32 v[128:129], v[28:29], v[10:11], v[128:129] op_sel_hi:[1,0,1]
  v_pk_fma_f32 v[130:131], v[30:31], v[10:11], v[130:131] op_sel_hi:[1,0,1]
  v_pk_fma_f32 v[132:133], v[32:33], v[10:11], v[132:133] op_sel_hi:[1,0,1]
  v_pk_fma_f32 v[134:135], v[34:35], v[10:11], v[134:135] op_sel_hi:[1,0,1]
  v_pk_mul_f32 v[120:121], v[120:121], v[18:19] op_sel_hi:[1,0]
  v_pk_mul_f32 v[122:123], v[122:123], v[18:19] op_sel_hi:[1,0]
  v_pk_mul_f32 v[124:125], v[124:125], v[18:19] op_sel_hi:[1,0]
  v_pk_mul_f32 v[126:127], v[126:127], v[18:19] op_sel_hi:[1,0]
  v_pk_mul_f32 v[128:129], v[128:129], v[18:19] op_sel_hi:[1,0]
  v_pk_mul_f32 v[130:131], v[130:131], v[18:19] op_sel_hi:[1,0]
  v_pk_mul_f32 v[132:133], v[132:133], v[18:19] op_sel_hi:[1,0]
  v_pk_mul_f32 v[134:135], v[134:135], v[18:19] op_sel_hi:[1,0]
  v_cndmask_b32_e64 v132, v132, 0, s[48:49]
  v_cndmask_b32_e64 v133, v133, 0, s[48:49]
  v_cndmask_b32_e64 v134, v134, 0, s[48:49]
  v_cndmask_b32_e64 v135, v135, 0, s[48:49]
  v_cvt_pk_bf16_f32 v88, v120, v121
  v_cvt_pk_bf16_f32 v89, v122, v123
  v_cvt_pk_bf16_f32 v90, v124, v125
  v_cvt_pk_bf16_f32 v91, v126, v127
  v_cvt_pk_bf16_f32 v92, v128, v129
  v_cvt_pk_bf16_f32 v93, v130, v131
  v_cvt_pk_bf16_f32 v94, v132, v133
  v_cvt_pk_bf16_f32 v95, v134, v135
  v_pk_mul_f32 v[112:113], v[120:121], v[120:121]
  v_pk_fma_f32 v[112:113], v[122:123], v[122:123], v[112:113]
  v_pk_fma_f32 v[112:113], v[124:125], v[124:125], v[112:113]
  v_pk_fma_f32 v[112:113], v[126:127], v[126:127], v[112:113]
  v_pk_fma_f32 v[112:113], v[128:129], v[128:129], v[112:113]
  v_pk_fma_f32 v[112:113], v[130:131], v[130:131], v[112:113]
  v_pk_fma_f32 v[112:113], v[132:133], v[132:133], v[112:113]
  v_pk_fma_f32 v[112:113], v[134:135], v[134:135], v[112:113]
  v_add_f32 v112, v112, v113
  v_mov_b32 v12, v112
  v_mov_b32 v13, v112
  s_nop 1
  v_permlane32_swap_b32 v12, v13
  v_add_f32 v112, v12, v13
  v_sqrt_f32 v112, v112
  s_nop 0
  v_cndmask_b32_e64 v95, v95, v112, s[48:49]
  s_lshl_b32 s73, s42, 11
  s_add_u32 s73, s73, 151552
  v_add_u32 v13, s73, v1
  ds_write_b128 v13, v[88:91] offset:0
  ds_write_b128 v13, v[92:95] offset:1024
  s_waitcnt vmcnt(0)
  s_waitcnt lgkmcnt(0)
  s_barrier
  s_lshl_b32 s60, s53, 7
  s_lshl_b32 s77, s52, 3
  s_add_u32 s60, s60, s77
  s_add_u32 s60, s60, s46
  s_add_u32 s60, s60, 31457280
  s_cmp_lg_u32 s42, 0
  s_cbranch_scc1 L_pub_4
  v_mov_b32 v216, s40
  v_mov_b32 v217, s41
  v_mov_b32 v218, 0
  s_mov_b64 exec, 1
  buffer_store_dwordx2 v[216:217], v218, s[28:31], s60 offen sc1
  s_mov_b64 exec, -1
L_pub_4:
  s_cmp_ge_u32 s44, 28
  s_cbranch_scc1 L_nowo1_5
  s_mov_b32 s36, s8
  s_mov_b32 s37, s9
  s_mov_b32 s38, 401408
  s_mov_b32 s39, 0x20000
  v_lshrrev_b32 v4, 2, v0
  v_mul_u32_u24 v4, 896, v4
  v_and_b32 v5, 3, v0
  v_lshl_add_u32 v4, v5, 4, v4
  s_mul_i32 s68, s44, 37
  s_lshr_b32 s68, s68, 8
  s_mul_i32 s68, s68, 7
  s_sub_u32 s68, s44, s68
  s_lshl_b32 s68, s68, 7
  s_cmp_eq_u32 s42, 0
  s_cbranch_scc1 L_nw0_6
  s_sub_u32 s69, s42, 1
  s_cmp_ge_u32 s69, 16
  s_cbranch_scc1 L_wstd_8
L_wst_7:
  s_min_u32 s70, s69, 27
  s_mul_i32 s70, s70, 14336
  s_add_u32 s70, s70, s68
  s_mul_i32 s71, s69, 1024
  s_add_u32 m0, s71, 0
  s_add_u32 s72, s70, 0
  buffer_load_dwordx4 v4, s[36:39], s72 offen lds
  s_add_u32 m0, s71, 29696
  s_add_u32 s72, s70, 64
  buffer_load_dwordx4 v4, s[36:39], s72 offen lds
  s_add_u32 s69, s69, 3
  s_cmp_lt_u32 s69, 16
  s_cbranch_scc1 L_wst_7
L_wstd_8:
L_nw0_6:
L_nowo1_5:
L_layer:
  s_lshr_b32 s53, s44, 4
  s_lshl_b32 s54, s43, 1
  s_add_u32 s53, s53, s54
  s_and_b32 s52, s44, 15
  s_add_u32 s60, s42, 0
  s_and_b32 s60, s60, 3
  s_lshl_b32 s60, s60, 11
  s_add_u32 s60, s60, 151552
  v_add_u32 v216, s60, v1
  ds_read_b128 v[8:11], v216 offset:0
  ds_read_b128 v[12:15], v216 offset:1024
  s_add_u32 s60, s42, 1
  s_and_b32 s60, s60, 3
  s_lshl_b32 s60, s60, 11
  s_add_u32 s60, s60, 151552
  v_add_u32 v216, s60, v1
  ds_read_b128 v[16:19], v216 offset:0
  ds_read_b128 v[20:23], v216 offset:1024
  s_add_u32 s60, s42, 2
  s_and_b32 s60, s60, 3
  s_lshl_b32 s60, s60, 11
  s_add_u32 s60, s60, 151552
  v_add_u32 v216, s60, v1
  ds_read_b128 v[24:27], v216 offset:0
  ds_read_b128 v[28:31], v216 offset:1024
  s_add_u32 s60, s42, 3
  s_and_b32 s60, s60, 3
  s_lshl_b32 s60, s60, 11
  s_add_u32 s60, s60, 151552
  v_add_u32 v216, s60, v1
  ds_read_b128 v[32:35], v216 offset:0
  ds_read_b128 v[36:39], v216 offset:1024
  v_mov_b32 v40, 0
  v_mov_b32 v41, 0
  v_mov_b32 v42, 0
  v_mov_b32 v43, 0
  v_mov_b32 v44, 0
  v_mov_b32 v45, 0
  v_mov_b32 v46, 0
  v_mov_b32 v47, 0
  v_mov_b32 v48, 0
  v_mov_b32 v49, 0
  v_mov_b32 v50, 0
  v_mov_b32 v51, 0
  v_mov_b32 v52, 0
  v_mov_b32 v53, 0
  v_mov_b32 v54, 0
  v_mov_b32 v55, 0
  v_mov_b32 v56, 0
  v_mov_b32 v57, 0
  v_mov_b32 v58, 0
  v_mov_b32 v59, 0
  v_mov_b32 v60, 0
  v_mov_b32 v61, 0
  v_mov_b32 v62, 0
  v_mov_b32 v63, 0
  v_mov_b32 v64, 0
  v_mov_b32 v65, 0
  v_mov_b32 v66, 0
  v_mov_b32 v67, 0
  v_mov_b32 v68, 0
  v_mov_b32 v69, 0
  v_mov_b32 v70, 0
  v_mov_b32 v71, 0
  v_mov_b32 v72, 0
  v_mov_b32 v73, 0
  v_mov_b32 v74, 0
  v_mov_b32 v75, 0
  v_mov_b32 v76, 0
  v_mov_b32 v77, 0
  v_mov_b32 v78, 0
  v_mov_b32 v79, 0
  v_mov_b32 v80, 0
  v_mov_b32 v81, 0
  v_mov_b32 v82, 0
  v_mov_b32 v83, 0
  v_mov_b32 v84, 0
  v_mov_b32 v85, 0
  v_mov_b32 v86, 0
  v_mov_b32 v87, 0
  v_mov_b32 v88, 0
  v_mov_b32 v89, 0
  v_mov_b32 v90, 0
  v_mov_b32 v91, 0
  v_mov_b32 v92, 0
  v_mov_b32 v93, 0
  v_mov_b32 v94, 0
  v_mov_b32 v95, 0
  v_mov_b32 v96, 0
  v_mov_b32 v97, 0
  v_mov_b32 v98, 0
  v_mov_b32 v99, 0
  v_mov_b32 v100, 0
  v_mov_b32 v101, 0
  v_mov_b32 v102, 0
  v_mov_b32 v103, 0
  v_mov_b32 v144, 0
  v_mov_b32 v208, 0
  v_mov_b32 v145, 0
  v_mov_b32 v209, 0
  v_mov_b32 v146, 0
  v_mov_b32 v210, 0
  v_mov_b32 v147, 0
  v_mov_b32 v211, 0
  v_mov_b32 v148, 0
  v_mov_b32 v212, 0
  v_mov_b32 v149, 0
  v_mov_b32 v213, 0
  v_mov_b32 v150, 0
  v_mov_b32 v214, 0
  v_mov_b32 v151, 0
  v_mov_b32 v215, 0
  s_mov_b32 s59, 0
  v_mov_b32 v216, 160196
  v_mov_b32 v217, 0
  ds_write_b32 v216, v217
  s_waitcnt lgkmcnt(0)
  s_cmp_eq_u32 s42, 0
  s_cbranch_scc1 L_nw0_9
  s_cmp_ge_u32 s44, 28
  s_cbranch_scc1 L_nowo_10
  s_add_u32 s69, s42, 15
  s_cmp_ge_u32 s69, 29
  s_cbranch_scc1 L_wstd_12
L_wst_11:
  s_min_u32 s70, s69, 27
  s_mul_i32 s70, s70, 14336
  s_add_u32 s70, s70, s68
  s_mul_i32 s71, s69, 1024
  s_add_u32 m0, s71, 0
  s_add_u32 s72, s70, 0
  buffer_load_dwordx4 v4, s[36:39], s72 offen lds
  s_add_u32 m0, s71, 29696
  s_add_u32 s72, s70, 64
  buffer_load_dwordx4 v4, s[36:39], s72 offen lds
  s_add_u32 s69, s69, 3
  s_cmp_lt_u32 s69, 29
  s_cbranch_scc1 L_wst_11
L_wstd_12:
L_nowo_10:
L_nw0_9:
  s_cmp_lg_u32 s42, 0
  s_cbranch_scc1 L_w0_13
  v_and_b32 v216, 15, v0
  v_lshlrev_b32 v216, 3, v216
  s_lshl_b32 s54, s52, 7
  s_add_u32 s54, s54, s46
  s_add_u32 s54, s54, 31457280
  s_mov_b32 s76, 0
L_poll_14:
  buffer_load_dwordx2 v[218:219], v216, s[28:31], s54 offen sc1
  s_waitcnt vmcnt(0)
  v_cmp_eq_u32 vcc, s40, v218
  v_cmp_eq_u32 s[74:75], s41, v219
  s_nop 2
  s_and_b64 vcc, vcc, s[74:75]
  s_cmp_eq_u64 vcc, -1
  s_cbranch_scc1 L_polld_15
  s_add_u32 s76, s76, 1
  s_cmp_lt_u32 s76, 0x40000
  s_cbranch_scc1 L_poll_14
L_polld_15:
L_w0_13:
  s_barrier
  v_and_b32 v224, 31, v0
  v_lshlrev_b32 v224, 3, v224
  s_lshl_b32 s63, s43, 8
  s_add_u32 s63, s63, 31502336
  buffer_load_dwordx2 v[222:223], v224, s[28:31], s63 offen sc1
  s_lshl_b32 s54, s52, 8
  s_add_u32 s54, s54, s46
  s_add_u32 s54, s54, 31195136
  v_lshlrev_b32 v216, 2, v0
  buffer_load_dword v217, v216, s[28:31], s54 offen
  s_lshl_b32 s55, s52, 6
  s_lshl_b32 s60, s42, 4
  s_add_u32 s55, s55, s60
  s_lshl_b32 s55, s55, 12
  s_add_u32 s55, s55, s46
  s_add_u32 s55, s55, 2097152
  s_lshl_b32 s67, s52, 18
  s_add_u32 s67, s67, s46
  s_add_u32 s67, s67, 2355200
  buffer_load_dwordx4 v[152:155], v1, s[28:31], s55 offen offset:0
  buffer_load_dwordx4 v[156:159], v1, s[28:31], s55 offen offset:1024
  buffer_load_dwordx4 v[160:163], v1, s[28:31], s55 offen offset:2048
  buffer_load_dwordx4 v[164:167], v1, s[28:31], s55 offen offset:3072
  s_add_u32 s55, s55, 4096
  buffer_load_dwordx4 v[168:171], v1, s[28:31], s55 offen offset:0
  buffer_load_dwordx4 v[172:175], v1, s[28:31], s55 offen offset:1024
  buffer_load_dwordx4 v[176:179], v1, s[28:31], s55 offen offset:2048
  buffer_load_dwordx4 v[180:183], v1, s[28:31], s55 offen offset:3072
  s_add_u32 s55, s55, 4096
  s_waitcnt vmcnt(8)
  s_mov_b32 s76, 0
L_xfa_17:
  v_cmp_eq_u32 vcc, s40, v222
  s_nop 2
  s_cmp_eq_u64 vcc, -1
  s_cbranch_scc1 L_xf_16
  s_lshl_b32 s77, s43, 8
  s_add_u32 s77, s77, 31502336
  buffer_load_dwordx2 v[222:223], v224, s[28:31], s77 offen sc1
  s_waitcnt vmcnt(0)
  s_add_u32 s76, s76, 1
  s_cmp_lt_u32 s76, 0x40000
  s_cbranch_scc1 L_xfa_17
L_xf_16:
  s_getreg_b32 s77, hwreg(HW_REG_XCC_ID, 0, 4)
  v_cmp_eq_u32 vcc, s77, v223
  v_cmp_eq_u32 s[74:75], s40, v222
  s_nop 2
  s_and_b64 vcc, vcc, s[74:75]
  s_cmp_eq_u64 vcc, -1
  s_cselect_b32 s47, 1, 0
  v_max_f32_dpp v217, v217, v217 row_ror:8 row_mask:0xf bank_mask:0xf
  s_nop 1
  v_max_f32_dpp v217, v217, v217 row_ror:4 row_mask:0xf bank_mask:0xf
  s_nop 1
  v_max_f32_dpp v217, v217, v217 row_ror:2 row_mask:0xf bank_mask:0xf
  s_nop 1
  v_max_f32_dpp v217, v217, v217 row_ror:1 row_mask:0xf bank_mask:0xf
  v_mov_b32 v218, v217
  v_mov_b32 v219, v217
  s_nop 1
  v_permlane16_swap_b32 v218, v219
  v_max_f32 v217, v218, v219
  v_mov_b32 v218, v217
  v_mov_b32 v219, v217
  s_nop 1
  v_permlane32_swap_b32 v218, v219
  v_max_f32 v217, v218, v219
  v_sqrt_f32 v217, v217
  s_nop 0
  v_mul_f32 v217, 0xbf808000, v217
  v_mul_f32 v218, v217, v15
  v_cvt_pk_bf16_f32 v218, v218, 0
  v_cndmask_b32_e64 v14, v14, v218, s[48:49]
  v_cndmask_b32_e64 v15, v15, 0, s[48:49]
  v_mul_f32 v218, v217, v23
  v_cvt_pk_bf16_f32 v218, v218, 0
  v_cndmask_b32_e64 v22, v22, v218, s[48:49]
  v_cndmask_b32_e64 v23, v23, 0, s[48:49]
  v_mul_f32 v218, v217, v31
  v_cvt_pk_bf16_f32 v218, v218, 0
  v_cndmask_b32_e64 v30, v30, v218, s[48:49]
  v_cndmask_b32_e64 v31, v31, 0, s[48:49]
  v_mul_f32 v218, v217, v39
  v_cvt_pk_bf16_f32 v218, v218, 0
  v_cndmask_b32_e64 v38, v38, v218, s[48:49]
  v_cndmask_b32_e64 v39, v39, 0, s[48:49]
  buffer_load_dwordx4 v[184:187], v1, s[28:31], s55 offen offset:0
  buffer_load_dwordx4 v[188:191], v1, s[28:31], s55 offen offset:1024
  buffer_load_dwordx4 v[192:195], v1, s[28:31], s55 offen offset:2048
  buffer_load_dwordx4 v[196:199], v1, s[28:31], s55 offen offset:3072
  s_add_u32 s55, s55, 4096
  s_mov_b32 s36, s12
  s_mov_b32 s37, s13
  s_mov_b32 s38, 1605632
  s_mov_b32 s39, 0x20000
  v_lshrrev_b32 v4, 2, v0
  v_mul_u32_u24 v4, 3584, v4
  v_and_b32 v5, 3, v0
  v_lshl_add_u32 v4, v5, 4, v4
  s_cmp_ge_u32 s44, 14
  s_cselect_b32 s68, 14, 0
  s_sub_u32 s68, s44, s68
  s_lshl_b32 s68, s68, 7
  s_add_u32 s66, s42, 12
  s_mul_i32 s58, s66, 57344
  s_add_u32 s58, s58, s68
  s_lshl_b32 s66, s66, 12
  s_add_u32 s66, s66, 61440
  s_waitcnt vmcnt(8)
  v_mfma_f32_32x32x16_bf16 v[104:119], v[152:155], v[8:11], 0
  v_mfma_f32_32x32x16_bf16 v[104:119], v[156:159], v[12:15], v[104:119]
  s_cmp_lg_u32 s45, 0
  s_cbranch_scc1 L_attn1_18
  s_min_u32 s60, s44, 27
  s_cmp_ge_u32 s60, 14
  s_cselect_b32 s61, 1, 0
  s_cselect_b32 s62, 14, 0
  s_sub_u32 s62, s60, s62
  s_and_b32 s63, s62, 1
  s_lshr_b32 s62, s62, 1
  s_lshl_b32 s77, s43, 1
  s_add_u32 s61, s61, s77
  s_lshl_b32 s61, s61, 2
  s_add_u32 s61, s61, s42
  s_lshl_b32 s61, s61, 17
  s_lshl_b32 s63, s63, 11
  s_add_u32 s64, s61, s63
  s_mov_b32 s32, s14
  s_mov_b32 s33, s15
  s_mov_b32 s34, 8388608
  s_mov_b32 s35, 0x20000
  v_lshrrev_b32 v224, 2, v0
  v_mul_u32_u24 v224, 4096, v224
  v_and_b32 v225, 3, v0
  v_bfe_u32 v226, v0, 4, 2
  v_xor_b32 v225, v225, v226
  v_lshl_add_u32 v224, v225, 4, v224
  v_bfe_u32 v226, v0, 4, 1
  v_lshlrev_b32 v225, 10, v226
  v_and_b32 v226, 15, v0
  v_lshl_add_u32 v225, v226, 6, v225
  v_bfe_u32 v226, v0, 2, 2
  v_lshrrev_b32 v227, 5, v0
  v_xor_b32 v226, v226, v227
  v_lshl_add_u32 v225, v226, 4, v225
  s_mul_i32 s65, s42, 12288
  s_add_u32 s65, s65, 61440
  v_add_u32 v226, s65, v225
  v_xor_b32 v227, 32, v226
  s_nop 3
  v_mfma_f32_32x32x16_bf16 v[120:135], v[152:155], v[16:19], 0
  v_exp_f32 v104, v104
  v_exp_f32 v105, v105
  v_exp_f32 v106, v106
  v_exp_f32 v107, v107
  v_mfma_f32_32x32x16_bf16 v[120:135], v[156:159], v[20:23], v[120:135]
  s_add_u32 m0, s65, 0
  s_add_u32 s60, s64, 0
  buffer_load_dwordx4 v224, s[32:35], s60 offen lds
  v_exp_f32 v108, v108
  v_exp_f32 v109, v109
  v_exp_f32 v110, v110
  v_exp_f32 v111, v111
  v_cvt_pk_bf16_f32 v136, v104, v105
  v_cvt_pk_bf16_f32 v137, v106, v107
  v_mfma_f32_32x32x16_bf16 v[88:103], v[208:211], v[144:147], v[88:103]
  v_exp_f32 v112, v112
  v_exp_f32 v113, v113
  v_exp_f32 v114, v114
  v_exp_f32 v115, v115
  v_cvt_pk_bf16_f32 v138, v108, v109
  v_cvt_pk_bf16_f32 v139, v110, v111
  v_mfma_f32_32x32x16_bf16 v[88:103], v[212:215], v[148:151], v[88:103]
  v_exp_f32 v116, v116
  v_exp_f32 v117, v117
  v_exp_f32 v118, v118
  v_exp_f32 v119, v119
  v_cvt_pk_bf16_f32 v140, v112, v113
  v_cvt_pk_bf16_f32 v141, v114, v115
  v_cvt_pk_bf16_f32 v142, v116, v117
  v_cvt_pk_bf16_f32 v143, v118, v119
  v_mfma_f32_32x32x16_bf16 v[104:119], v[152:155], v[24:27], 0
  v_exp_f32 v120, v120
  v_exp_f32 v121, v121
  v_exp_f32 v122, v122
  v_exp_f32 v123, v123
  v_mfma_f32_32x32x16_bf16 v[104:119], v[156:159], v[28:31], v[104:119]
  s_add_u32 m0, s65, 1024
  s_add_u32 s60, s64, 65536
  buffer_load_dwordx4 v224, s[32:35], s60 offen lds
  v_exp_f32 v124, v124
  v_exp_f32 v125, v125
  v_exp_f32 v126, v126
  v_exp_f32 v127, v127
  v_cvt_pk_bf16_f32 v144, v120, v121
  v_cvt_pk_bf16_f32 v145, v122, v123
  v_mfma_f32_32x32x16_bf16 v[40:55], v[160:163], v[136:139], v[40:55]
  v_exp_f32 v128, v128
  v_exp_f32 v129, v129
  v_exp_f32 v130, v130
  v_exp_f32 v131, v131
  v_cvt_pk_bf16_f32 v146, v124, v125
  v_cvt_pk_bf16_f32 v147, v126, v127
  v_mfma_f32_32x32x16_bf16 v[40:55], v[164:167], v[140:143], v[40:55]
  v_exp_f32 v132, v132
  v_exp_f32 v133, v133
  v_exp_f32 v134, v134
  v_exp_f32 v135, v135
  v_cvt_pk_bf16_f32 v148, v128, v129
  v_cvt_pk_bf16_f32 v149, v130, v131
  buffer_load_dwordx4 v[200:203], v1, s[28:31], s55 offen offset:0
  buffer_load_dwordx4 v[204:207], v1, s[28:31], s55 offen offset:1024
  v_cvt_pk_bf16_f32 v150, v132, v133
  v_cvt_pk_bf16_f32 v151, v134, v135
  v_mfma_f32_32x32x16_bf16 v[120:135], v[152:155], v[32:35], 0
  v_exp_f32 v104, v104
  v_exp_f32 v105, v105
  v_exp_f32 v106, v106
  v_exp_f32 v107, v107
  v_mfma_f32_32x32x16_bf16 v[120:135], v[156:159], v[36:39], v[120:135]
  s_add_u32 m0, s65, 2048
  s_add_u32 s60, s64, 64
  buffer_load_dwordx4 v224, s[32:35], s60 offen lds
  v_exp_f32 v108, v108
  v_exp_f32 v109, v109
  v_exp_f32 v110, v110
  v_exp_f32 v111, v111
  v_cvt_pk_bf16_f32 v136, v104, v105
  v_cvt_pk_bf16_f32 v137, v106, v107
  v_mfma_f32_32x32x16_bf16 v[56:71], v[160:163], v[144:147], v[56:71]
  v_exp_f32 v112, v112
  v_exp_f32 v113, v113
  v_exp_f32 v114, v114
  v_exp_f32 v115, v115
  v_cvt_pk_bf16_f32 v138, v108, v109
  v_cvt_pk_bf16_f32 v139, v110, v111
  v_mfma_f32_32x32x16_bf16 v[56:71], v[164:167], v[148:151], v[56:71]
  v_exp_f32 v116, v116
  v_exp_f32 v117, v117
  v_exp_f32 v118, v118
  v_exp_f32 v119, v119
  v_cvt_pk_bf16_f32 v140, v112, v113
  v_cvt_pk_bf16_f32 v141, v114, v115
  buffer_load_dwordx4 v[208:211], v1, s[28:31], s55 offen offset:2048
  buffer_load_dwordx4 v[212:215], v1, s[28:31], s55 offen offset:3072
  s_add_u32 s55, s55, 4096
  v_cvt_pk_bf16_f32 v142, v116, v117
  v_cvt_pk_bf16_f32 v143, v118, v119
  s_waitcnt vmcnt(11)
  v_mfma_f32_32x32x16_bf16 v[104:119], v[168:171], v[8:11], 0
  v_exp_f32 v120, v120
  v_exp_f32 v121, v121
  v_exp_f32 v122, v122
  v_exp_f32 v123, v123
  v_mfma_f32_32x32x16_bf16 v[104:119], v[172:175], v[12:15], v[104:119]
  s_add_u32 m0, s65, 3072
  s_add_u32 s60, s64, 65600
  buffer_load_dwordx4 v224, s[32:35], s60 offen lds
  v_exp_f32 v124, v124
  v_exp_f32 v125, v125
  v_exp_f32 v126, v126
  v_exp_f32 v127, v127
  v_cvt_pk_bf16_f32 v144, v120, v121
  v_cvt_pk_bf16_f32 v145, v122, v123
  v_mfma_f32_32x32x16_bf16 v[72:87], v[160:163], v[136:139], v[72:87]
  v_exp_f32 v128, v128
  v_exp_f32 v129, v129
  v_exp_f32 v130, v130
  v_exp_f32 v131, v131
  v_cvt_pk_bf16_f32 v146, v124, v125
  v_cvt_pk_bf16_f32 v147, v126, v127
  v_mfma_f32_32x32x16_bf16 v[72:87], v[164:167], v[140:143], v[72:87]
  v_exp_f32 v132, v132
  v_exp_f32 v133, v133
  v_exp_f32 v134, v134
  v_exp_f32 v135, v135
  v_cvt_pk_bf16_f32 v148, v128, v129
  v_cvt_pk_bf16_f32 v149, v130, v131
  s_add_u32 m0, s66, 0
  s_add_u32 s69, s58, 1792
  buffer_load_dwordx4 v4, s[36:39], s69 offen lds
  v_cvt_pk_bf16_f32 v150, v132, v133
  v_cvt_pk_bf16_f32 v151, v134, v135
  v_mfma_f32_32x32x16_bf16 v[120:135], v[168:171], v[16:19], 0
  v_exp_f32 v104, v104
  v_exp_f32 v105, v105
  v_exp_f32 v106, v106
  v_exp_f32 v107, v107
  v_mfma_f32_32x32x16_bf16 v[120:135], v[172:175], v[20:23], v[120:135]
  s_add_u32 m0, s65, 4096
  s_add_u32 s60, s64, 128
  buffer_load_dwordx4 v224, s[32:35], s60 offen lds
  v_exp_f32 v108, v108
  v_exp_f32 v109, v109
  v_exp_f32 v110, v110
  v_exp_f32 v111, v111
  v_cvt_pk_bf16_f32 v136, v104, v105
  v_cvt_pk_bf16_f32 v137, v106, v107
  v_mfma_f32_32x32x16_bf16 v[88:103], v[160:163], v[144:147], v[88:103]
  v_exp_f32 v112, v112
  v_exp_f32 v113, v113
  v_exp_f32 v114, v114
  v_exp_f32 v115, v115
  v_cvt_pk_bf16_f32 v138, v108, v109
  v_cvt_pk_bf16_f32 v139, v110, v111
  v_mfma_f32_32x32x16_bf16 v[88:103], v[164:167], v[148:151], v[88:103]
  v_exp_f32 v116, v116
  v_exp_f32 v117, v117
  v_exp_f32 v118, v118
  v_exp_f32 v119, v119
  v_cvt_pk_bf16_f32 v140, v112, v113
  v_cvt_pk_bf16_f32 v141, v114, v115
  v_cvt_pk_bf16_f32 v142, v116, v117
  v_cvt_pk_bf16_f32 v143, v118, v119
  v_mfma_f32_32x32x16_bf16 v[104:119], v[168:171], v[24:27], 0
  v_exp_f32 v120, v120
  v_exp_f32 v121, v121
  v_exp_f32 v122, v122
  v_exp_f32 v123, v123
  v_mfma_f32_32x32x16_bf16 v[104:119], v[172:175], v[28:31], v[104:119]
  s_add_u32 m0, s65, 5120
  s_add_u32 s60, s64, 65664
  buffer_load_dwordx4 v224, s[32:35], s60 offen lds
  v_exp_f32 v124, v124
  v_exp_f32 v125, v125
  v_exp_f32 v126, v126
  v_exp_f32 v127, v127
  v_cvt_pk_bf16_f32 v144, v120, v121
  v_cvt_pk_bf16_f32 v145, v122, v123
  v_mfma_f32_32x32x16_bf16 v[40:55], v[176:179], v[136:139], v[40:55]
  v_exp_f32 v128, v128
  v_exp_f32 v129, v129
  v_exp_f32 v130, v130
  v_exp_f32 v131, v131
  v_cvt_pk_bf16_f32 v146, v124, v125
  v_cvt_pk_bf16_f32 v147, v126, v127
  v_mfma_f32_32x32x16_bf16 v[40:55], v[180:183], v[140:143], v[40:55]
  v_exp_f32 v132, v132
  v_exp_f32 v133, v133
  v_exp_f32 v134, v134
  v_exp_f32 v135, v135
  v_cvt_pk_bf16_f32 v148, v128, v129
  v_cvt_pk_bf16_f32 v149, v130, v131
  buffer_load_dwordx4 v[152:155], v1, s[28:31], s55 offen offset:0
  buffer_load_dwordx4 v[156:159], v1, s[28:31], s55 offen offset:1024
  v_cvt_pk_bf16_f32 v150, v132, v133
  v_cvt_pk_bf16_f32 v151, v134, v135
  v_mfma_f32_32x32x16_bf16 v[120:135], v[168:171], v[32:35], 0
  v_exp_f32 v104, v104
  v_exp_f32 v105, v105
  v_exp_f32 v106, v106
  v_exp_f32 v107, v107
  v_mfma_f32_32x32x16_bf16 v[120:135], v[172:175], v[36:39], v[120:135]
  s_add_u32 m0, s65, 6144
  s_add_u32 s60, s64, 192
  buffer_load_dwordx4 v224, s[32:35], s60 offen lds
  v_exp_f32 v108, v108
  v_exp_f32 v109, v109
  v_exp_f32 v110, v110
  v_exp_f32 v111, v111
  v_cvt_pk_bf16_f32 v136, v104, v105
  v_cvt_pk_bf16_f32 v137, v106, v107
  v_mfma_f32_32x32x16_bf16 v[56:71], v[176:179], v[144:147], v[56:71]
  v_exp_f32 v112, v112
  v_exp_f32 v113, v113
  v_exp_f32 v114, v114
  v_exp_f32 v115, v115
  v_cvt_pk_bf16_f32 v138, v108, v109
  v_cvt_pk_bf16_f32 v139, v110, v111
  v_mfma_f32_32x32x16_bf16 v[56:71], v[180:183], v[148:151], v[56:71]
  v_exp_f32 v116, v116
  v_exp_f32 v117, v117
  v_exp_f32 v118, v118
  v_exp_f32 v119, v119
  v_cvt_pk_bf16_f32 v140, v112, v113
  v_cvt_pk_bf16_f32 v141, v114, v115
  buffer_load_dwordx4 v[160:163], v1, s[28:31], s55 offen offset:2048
  buffer_load_dwordx4 v[164:167], v1, s[28:31], s55 offen offset:3072
  s_add_u32 s55, s55, 4096
  v_cvt_pk_bf16_f32 v142, v116, v117
  v_cvt_pk_bf16_f32 v143, v118, v119
  s_waitcnt vmcnt(16)
  v_mfma_f32_32x32x16_bf16 v[104:119], v[184:187], v[8:11], 0
  v_exp_f32 v120, v120
  v_exp_f32 v121, v121
  v_exp_f32 v122, v122
  v_exp_f32 v123, v123
  v_mfma_f32_32x32x16_bf16 v[104:119], v[188:191], v[12:15], v[104:119]
  s_add_u32 m0, s65, 7168
  s_add_u32 s60, s64, 65728
  buffer_load_dwordx4 v224, s[32:35], s60 offen lds
  v_exp_f32 v124, v124
  v_exp_f32 v125, v125
  v_exp_f32 v126, v126
  v_exp_f32 v127, v127
  v_cvt_pk_bf16_f32 v144, v120, v121
  v_cvt_pk_bf16_f32 v145, v122, v123
  v_mfma_f32_32x32x16_bf16 v[72:87], v[176:179], v[136:139], v[72:87]
  v_exp_f32 v128, v128
  v_exp_f32 v129, v129
  v_exp_f32 v130, v130
  v_exp_f32 v131, v131
  v_cvt_pk_bf16_f32 v146, v124, v125
  v_cvt_pk_bf16_f32 v147, v126, v127
  v_mfma_f32_32x32x16_bf16 v[72:87], v[180:183], v[140:143], v[72:87]
  v_exp_f32 v132, v132
  v_exp_f32 v133, v133
  v_exp_f32 v134, v134
  v_exp_f32 v135, v135
  v_cvt_pk_bf16_f32 v148, v128, v129
  v_cvt_pk_bf16_f32 v149, v130, v131
  s_add_u32 m0, s66, 1024
  s_add_u32 s69, s58, 1856
  buffer_load_dwordx4 v4, s[36:39], s69 offen lds
  v_cvt_pk_bf16_f32 v150, v132, v133
  v_cvt_pk_bf16_f32 v151, v134, v135
  v_mfma_f32_32x32x16_bf16 v[120:135], v[184:187], v[16:19], 0
  v_exp_f32 v104, v104
  v_exp_f32 v105, v105
  v_exp_f32 v106, v106
  v_exp_f32 v107, v107
  v_mfma_f32_32x32x16_bf16 v[120:135], v[188:191], v[20:23], v[120:135]
  s_add_u32 m0, s65, 8192
  s_add_u32 s60, s64, 256
  buffer_load_dwordx4 v224, s[32:35], s60 offen lds
  v_exp_f32 v108, v108
  v_exp_f32 v109, v109
  v_exp_f32 v110, v110
  v_exp_f32 v111, v111
  v_cvt_pk_bf16_f32 v136, v104, v105
  v_cvt_pk_bf16_f32 v137, v106, v107
  v_mfma_f32_32x32x16_bf16 v[88:103], v[176:179], v[144:147], v[88:103]
  v_exp_f32 v112, v112
  v_exp_f32 v113, v113
  v_exp_f32 v114, v114
  v_exp_f32 v115, v115
  v_cvt_pk_bf16_f32 v138, v108, v109
  v_cvt_pk_bf16_f32 v139, v110, v111
  v_mfma_f32_32x32x16_bf16 v[88:103], v[180:183], v[148:151], v[88:103]
  v_exp_f32 v116, v116
  v_exp_f32 v117, v117
  v_exp_f32 v118, v118
  v_exp_f32 v119, v119
  v_cvt_pk_bf16_f32 v140, v112, v113
  v_cvt_pk_bf16_f32 v141, v114, v115
  v_cvt_pk_bf16_f32 v142, v116, v117
  v_cvt_pk_bf16_f32 v143, v118, v119
  v_mfma_f32_32x32x16_bf16 v[104:119], v[184:187], v[24:27], 0
  v_exp_f32 v120, v120
  v_exp_f32 v121, v121
  v_exp_f32 v122, v122
  v_exp_f32 v123, v123
  v_mfma_f32_32x32x16_bf16 v[104:119], v[188:191], v[28:31], v[104:119]
  s_add_u32 m0, s65, 9216
  s_add_u32 s60, s64, 65792
  buffer_load_dwordx4 v224, s[32:35], s60 offen lds
  v_exp_f32 v124, v124
  v_exp_f32 v125, v125
  v_exp_f32 v126, v126
  v_exp_f32 v127, v127
  v_cvt_pk_bf16_f32 v144, v120, v121
  v_cvt_pk_bf16_f32 v145, v122, v123
  v_mfma_f32_32x32x16_bf16 v[40:55], v[192:195], v[136:139], v[40:55]
  v_exp_f32 v128, v128
  v_exp_f32 v129, v129
  v_exp_f32 v130, v130
  v_exp_f32 v131, v131
  v_cvt_pk_bf16_f32 v146, v124, v125
  v_cvt_pk_bf16_f32 v147, v126, v127
  v_mfma_f32_32x32x16_bf16 v[40:55], v[196:199], v[140:143], v[40:55]
  v_exp_f32 v132, v132
  v_exp_f32 v133, v133
  v_exp_f32 v134, v134
  v_exp_f32 v135, v135
  v_cvt_pk_bf16_f32 v148, v128, v129
  v_cvt_pk_bf16_f32 v149, v130, v131
  buffer_load_dwordx4 v[168:171], v1, s[28:31], s55 offen offset:0
  buffer_load_dwordx4 v[172:175], v1, s[28:31], s55 offen offset:1024
  v_cvt_pk_bf16_f32 v150, v132, v133
  v_cvt_pk_bf16_f32 v151, v134, v135
  v_mfma_f32_32x32x16_bf16 v[120:135], v[184:187], v[32:35], 0
  v_exp_f32 v104, v104
  v_exp_f32 v105, v105
  v_exp_f32 v106, v106
  v_exp_f32 v107, v107
  v_mfma_f32_32x32x16_bf16 v[120:135], v[188:191], v[36:39], v[120:135]
  s_add_u32 m0, s65, 10240
  s_add_u32 s60, s64, 320
  buffer_load_dwordx4 v224, s[32:35], s60 offen lds
  v_exp_f32 v108, v108
  v_exp_f32 v109, v109
  v_exp_f32 v110, v110
  v_exp_f32 v111, v111
  v_cvt_pk_bf16_f32 v136, v104, v105
  v_cvt_pk_bf16_f32 v137, v106, v107
  v_mfma_f32_32x32x16_bf16 v[56:71], v[192:195], v[144:147], v[56:71]
  v_exp_f32 v112, v112
  v_exp_f32 v113, v113
  v_exp_f32 v114, v114
  v_exp_f32 v115, v115
  v_cvt_pk_bf16_f32 v138, v108, v109
  v_cvt_pk_bf16_f32 v139, v110, v111
  v_mfma_f32_32x32x16_bf16 v[56:71], v[196:199], v[148:151], v[56:71]
  v_exp_f32 v116, v116
  v_exp_f32 v117, v117
  v_exp_f32 v118, v118
  v_exp_f32 v119, v119
  v_cvt_pk_bf16_f32 v140, v112, v113
  v_cvt_pk_bf16_f32 v141, v114, v115
  buffer_load_dwordx4 v[176:179], v1, s[28:31], s55 offen offset:2048
  buffer_load_dwordx4 v[180:183], v1, s[28:31], s55 offen offset:3072
  s_add_u32 s55, s55, 4096
  v_cvt_pk_bf16_f32 v142, v116, v117
  v_cvt_pk_bf16_f32 v143, v118, v119
  s_waitcnt vmcnt(18)
  v_mfma_f32_32x32x16_bf16 v[104:119], v[200:203], v[8:11], 0
  v_exp_f32 v120, v120
  v_exp_f32 v121, v121
  v_exp_f32 v122, v122
  v_exp_f32 v123, v123
  v_mfma_f32_32x32x16_bf16 v[104:119], v[204:207], v[12:15], v[104:119]
  s_add_u32 m0, s65, 11264
  s_add_u32 s60, s64, 65856
  buffer_load_dwordx4 v224, s[32:35], s60 offen lds
  ds_read_b128 a[0:3], v226 offset:0
  ds_read_b128 a[4:7], v227 offset:0
  v_exp_f32 v124, v124
  v_exp_f32 v125, v125
  v_exp_f32 v126, v126
  v_exp_f32 v127, v127
  v_cvt_pk_bf16_f32 v144, v120, v121
  v_cvt_pk_bf16_f32 v145, v122, v123
  v_mfma_f32_32x32x16_bf16 v[72:87], v[192:195], v[136:139], v[72:87]
  v_exp_f32 v128, v128
  v_exp_f32 v129, v129
  v_exp_f32 v130, v130
  v_exp_f32 v131, v131
  v_cvt_pk_bf16_f32 v146, v124, v125
  v_cvt_pk_bf16_f32 v147, v126, v127
  v_mfma_f32_32x32x16_bf16 v[72:87], v[196:199], v[140:143], v[72:87]
  v_exp_f32 v132, v132
  v_exp_f32 v133, v133
  v_exp_f32 v134, v134
  v_exp_f32 v135, v135
  v_cvt_pk_bf16_f32 v148, v128, v129
  v_cvt_pk_bf16_f32 v149, v130, v131
  s_add_u32 m0, s66, 2048
  s_add_u32 s69, s58, 0
  buffer_load_dwordx4 v4, s[36:39], s69 offen lds
  v_cvt_pk_bf16_f32 v150, v132, v133
  v_cvt_pk_bf16_f32 v151, v134, v135
  v_mfma_f32_32x32x16_bf16 v[120:135], v[200:203], v[16:19], 0
  v_exp_f32 v104, v104
  v_exp_f32 v105, v105
  v_exp_f32 v106, v106
  v_exp_f32 v107, v107
  v_mfma_f32_32x32x16_bf16 v[120:135], v[204:207], v[20:23], v[120:135]
  s_waitcnt lgkmcnt(0)
  s_add_u32 m0, s65, 0
  s_add_u32 s60, s64, 384
  buffer_load_dwordx4 v224, s[32:35], s60 offen lds
  v_exp_f32 v108, v108
  v_exp_f32 v109, v109
  v_exp_f32 v110, v110
  v_exp_f32 v111, v111
  v_cvt_pk_bf16_f32 v136, v104, v105
  v_cvt_pk_bf16_f32 v137, v106, v107
  v_mfma_f32_32x32x16_bf16 v[88:103], v[192:195], v[144:147], v[88:103]
  v_exp_f32 v112, v112
  v_exp_f32 v113, v113
  v_exp_f32 v114, v114
  v_exp_f32 v115, v115
  v_cvt_pk_bf16_f32 v138, v108, v109
  v_cvt_pk_bf16_f32 v139, v110, v111
  v_mfma_f32_32x32x16_bf16 v[88:103], v[196:199], v[148:151], v[88:103]
  v_exp_f32 v116, v116
  v_exp_f32 v117, v117
  v_exp_f32 v118, v118
  v_exp_f32 v119, v119
  v_cvt_pk_bf16_f32 v140, v112, v113
  v_cvt_pk_bf16_f32 v141, v114, v115
  v_cvt_pk_bf16_f32 v142, v116, v117
  v_cvt_pk_bf16_f32 v143, v118, v119
  v_mfma_f32_32x32x16_bf16 v[104:119], v[200:203], v[24:27], 0
  v_exp_f32 v120, v120
  v_exp_f32 v121, v121
  v_exp_f32 v122, v122
  v_exp_f32 v123, v123
  v_mfma_f32_32x32x16_bf16 v[104:119], v[204:207], v[28:31], v[104:119]
  s_add_u32 m0, s65, 1024
  s_add_u32 s60, s64, 65920
  buffer_load_dwordx4 v224, s[32:35], s60 offen lds
  s_waitcnt vmcnt(21)
  ds_read_b128 a[8:11], v226 offset:2048
  ds_read_b128 a[12:15], v227 offset:2048
  v_exp_f32 v124, v124
  v_exp_f32 v125, v125
  v_exp_f32 v126, v126
  v_exp_f32 v127, v127
  v_cvt_pk_bf16_f32 v144, v120, v121
  v_cvt_pk_bf16_f32 v145, v122, v123
  v_mfma_f32_32x32x16_bf16 v[40:55], v[208:211], v[136:139], v[40:55]
  v_exp_f32 v128, v128
  v_exp_f32 v129, v129
  v_exp_f32 v130, v130
  v_exp_f32 v131, v131
  v_cvt_pk_bf16_f32 v146, v124, v125
  v_cvt_pk_bf16_f32 v147, v126, v127
  v_mfma_f32_32x32x16_bf16 v[40:55], v[212:215], v[140:143], v[40:55]
  v_exp_f32 v132, v132
  v_exp_f32 v133, v133
  v_exp_f32 v134, v134
  v_exp_f32 v135, v135
  v_cvt_pk_bf16_f32 v148, v128, v129
  v_cvt_pk_bf16_f32 v149, v130, v131
  buffer_load_dwordx4 v[184:187], v1, s[28:31], s55 offen offset:0
  buffer_load_dwordx4 v[188:191], v1, s[28:31], s55 offen offset:1024
  v_cvt_pk_bf16_f32 v150, v132, v133
  v_cvt_pk_bf16_f32 v151, v134, v135
  v_mfma_f32_32x32x16_bf16 v[120:135], v[200:203], v[32:35], 0
  v_exp_f32 v104, v104
  v_exp_f32 v105, v105
  v_exp_f32 v106, v106
  v_exp_f32 v107, v107
  v_mfma_f32_32x32x16_bf16 v[120:135], v[204:207], v[36:39], v[120:135]
  s_waitcnt lgkmcnt(0)
  s_add_u32 m0, s65, 2048
  s_add_u32 s60, s64, 448
  buffer_load_dwordx4 v224, s[32:35], s60 offen lds
  v_exp_f32 v108, v108
  v_exp_f32 v109, v109
  v_exp_f32 v110, v110
  v_exp_f32 v111, v111
  v_cvt_pk_bf16_f32 v136, v104, v105
  v_cvt_pk_bf16_f32 v137, v106, v107
  v_mfma_f32_32x32x16_bf16 v[56:71], v[208:211], v[144:147], v[56:71]
  v_exp_f32 v112, v112
  v_exp_f32 v113, v113
  v_exp_f32 v114, v114
  v_exp_f32 v115, v115
  v_cvt_pk_bf16_f32 v138, v108, v109
  v_cvt_pk_bf16_f32 v139, v110, v111
  v_mfma_f32_32x32x16_bf16 v[56:71], v[212:215], v[148:151], v[56:71]
  v_exp_f32 v116, v116
  v_exp_f32 v117, v117
  v_exp_f32 v118, v118
  v_exp_f32 v119, v119
  v_cvt_pk_bf16_f32 v140, v112, v113
  v_cvt_pk_bf16_f32 v141, v114, v115
  buffer_load_dwordx4 v[192:195], v1, s[28:31], s55 offen offset:2048
  buffer_load_dwordx4 v[196:199], v1, s[28:31], s55 offen offset:3072
  s_add_u32 s55, s55, 4096
  v_cvt_pk_bf16_f32 v142, v116, v117
  v_cvt_pk_bf16_f32 v143, v118, v119
  s_waitcnt vmcnt(18)
  v_mfma_f32_32x32x16_bf16 v[104:119], v[152:155], v[8:11], 0
  v_exp_f32 v120, v120
  v_exp_f32 v121, v121
  v_exp_f32 v122, v122
  v_exp_f32 v123, v123
  v_mfma_f32_32x32x16_bf16 v[104:119], v[156:159], v[12:15], v[104:119]
  s_add_u32 m0, s65, 3072
  s_add_u32 s60, s64, 65984
  buffer_load_dwordx4 v224, s[32:35], s60 offen lds
  ds_read_b128 a[16:19], v226 offset:4096
  ds_read_b128 a[20:23], v227 offset:4096
  v_exp_f32 v124, v124
  v_exp_f32 v125, v125
  v_exp_f32 v126, v126
  v_exp_f32 v127, v127
  v_cvt_pk_bf16_f32 v144, v120, v121
  v_cvt_pk_bf16_f32 v145, v122, v123
  v_mfma_f32_32x32x16_bf16 v[72:87], v[208:211], v[136:139], v[72:87]
  v_exp_f32 v128, v128
  v_exp_f32 v129, v129
  v_exp_f32 v130, v130
  v_exp_f32 v131, v131
  v_cvt_pk_bf16_f32 v146, v124, v125
  v_cvt_pk_bf16_f32 v147, v126, v127
  v_mfma_f32_32x32x16_bf16 v[72:87], v[212:215], v[140:143], v[72:87]
  v_exp_f32 v132, v132
  v_exp_f32 v133, v133
  v_exp_f32 v134, v134
  v_exp_f32 v135, v135
  v_cvt_pk_bf16_f32 v148, v128, v129
  v_cvt_pk_bf16_f32 v149, v130, v131
  s_add_u32 m0, s66, 3072
  s_add_u32 s69, s58, 64
  buffer_load_dwordx4 v4, s[36:39], s69 offen lds
  s_add_u32 s58, s58, 229376
  s_add_u32 s66, s66, 16384
  v_cvt_pk_bf16_f32 v150, v132, v133
  v_cvt_pk_bf16_f32 v151, v134, v135
  v_mfma_f32_32x32x16_bf16 v[120:135], v[152:155], v[16:19], 0
  v_exp_f32 v104, v104
  v_exp_f32 v105, v105
  v_exp_f32 v106, v106
  v_exp_f32 v107, v107
  v_mfma_f32_32x32x16_bf16 v[120:135], v[156:159], v[20:23], v[120:135]
  s_waitcnt lgkmcnt(0)
  s_add_u32 m0, s65, 4096
  s_add_u32 s60, s64, 512
  buffer_load_dwordx4 v224, s[32:35], s60 offen lds
  v_exp_f32 v108, v108
  v_exp_f32 v109, v109
  v_exp_f32 v110, v110
  v_exp_f32 v111, v111
  v_cvt_pk_bf16_f32 v136, v104, v105
  v_cvt_pk_bf16_f32 v137, v106, v107
  v_mfma_f32_32x32x16_bf16 v[88:103], v[208:211], v[144:147], v[88:103]
  v_exp_f32 v112, v112
  v_exp_f32 v113, v113
  v_exp_f32 v114, v114
  v_exp_f32 v115, v115
  v_cvt_pk_bf16_f32 v138, v108, v109
  v_cvt_pk_bf16_f32 v139, v110, v111
  v_mfma_f32_32x32x16_bf16 v[88:103], v[212:215], v[148:151], v[88:103]
  v_exp_f32 v116, v116
  v_exp_f32 v117, v117
  v_exp_f32 v118, v118
  v_exp_f32 v119, v119
  v_cvt_pk_bf16_f32 v140, v112, v113
  v_cvt_pk_bf16_f32 v141, v114, v115
  v_cvt_pk_bf16_f32 v142, v116, v117
  v_cvt_pk_bf16_f32 v143, v118, v119
  v_mfma_f32_32x32x16_bf16 v[104:119], v[152:155], v[24:27], 0
  v_exp_f32 v120, v120
  v_exp_f32 v121, v121
  v_exp_f32 v122, v122
  v_exp_f32 v123, v123
  v_mfma_f32_32x32x16_bf16 v[104:119], v[156:159], v[28:31], v[104:119]
  s_add_u32 m0, s65, 5120
  s_add_u32 s60, s64, 66048
  buffer_load_dwordx4 v224, s[32:35], s60 offen lds
  s_waitcnt vmcnt(21)
  ds_read_b128 a[24:27], v226 offset:6144
  ds_read_b128 a[28:31], v227 offset:6144
  v_exp_f32 v124, v124
  v_exp_f32 v125, v125
  v_exp_f32 v126, v126
  v_exp_f32 v127, v127
  v_cvt_pk_bf16_f32 v144, v120, v121
  v_cvt_pk_bf16_f32 v145, v122, v123
  v_mfma_f32_32x32x16_bf16 v[40:55], v[160:163], v[136:139], v[40:55]
  v_exp_f32 v128, v128
  v_exp_f32 v129, v129
  v_exp_f32 v130, v130
  v_exp_f32 v131, v131
  v_cvt_pk_bf16_f32 v146, v124, v125
  v_cvt_pk_bf16_f32 v147, v126, v127
  v_mfma_f32_32x32x16_bf16 v[40:55], v[164:167], v[140:143], v[40:55]
  v_exp_f32 v132, v132
  v_exp_f32 v133, v133
  v_exp_f32 v134, v134
  v_exp_f32 v135, v135
  v_cvt_pk_bf16_f32 v148, v128, v129
  v_cvt_pk_bf16_f32 v149, v130, v131
  buffer_load_dwordx4 v[200:203], v1, s[28:31], s55 offen offset:0
  buffer_load_dwordx4 v[204:207], v1, s[28:31], s55 offen offset:1024
  v_cvt_pk_bf16_f32 v150, v132, v133
  v_cvt_pk_bf16_f32 v151, v134, v135
  v_mfma_f32_32x32x16_bf16 v[120:135], v[152:155], v[32:35], 0
  v_exp_f32 v104, v104
  v_exp_f32 v105, v105
  v_exp_f32 v106, v106
  v_exp_f32 v107, v107
  v_mfma_f32_32x32x16_bf16 v[120:135], v[156:159], v[36:39], v[120:135]
  s_waitcnt lgkmcnt(0)
  s_add_u32 m0, s65, 6144
  s_add_u32 s60, s64, 576
  buffer_load_dwordx4 v224, s[32:35], s60 offen lds
  v_exp_f32 v108, v108
  v_exp_f32 v109, v109
  v_exp_f32 v110, v110
  v_exp_f32 v111, v111
  v_cvt_pk_bf16_f32 v136, v104, v105
  v_cvt_pk_bf16_f32 v137, v106, v107
  v_mfma_f32_32x32x16_bf16 v[56:71], v[160:163], v[144:147], v[56:71]
  v_exp_f32 v112, v112
  v_exp_f32 v113, v113
  v_exp_f32 v114, v114
  v_exp_f32 v115, v115
  v_cvt_pk_bf16_f32 v138, v108, v109
  v_cvt_pk_bf16_f32 v139, v110, v111
  v_mfma_f32_32x32x16_bf16 v[56:71], v[164:167], v[148:151], v[56:71]
  v_exp_f32 v116, v116
  v_exp_f32 v117, v117
  v_exp_f32 v118, v118
  v_exp_f32 v119, v119
  v_cvt_pk_bf16_f32 v140, v112, v113
  v_cvt_pk_bf16_f32 v141, v114, v115
  buffer_load_dwordx4 v[208:211], v1, s[28:31], s55 offen offset:2048
  buffer_load_dwordx4 v[212:215], v1, s[28:31], s55 offen offset:3072
  s_add_u32 s55, s55, 4096
  v_cvt_pk_bf16_f32 v142, v116, v117
  v_cvt_pk_bf16_f32 v143, v118, v119
  s_waitcnt vmcnt(18)
  v_mfma_f32_32x32x16_bf16 v[104:119], v[168:171], v[8:11], 0
  v_exp_f32 v120, v120
  v_exp_f32 v121, v121
  v_exp_f32 v122, v122
  v_exp_f32 v123, v123
  v_mfma_f32_32x32x16_bf16 v[104:119], v[172:175], v[12:15], v[104:119]
  s_add_u32 m0, s65, 7168
  s_add_u32 s60, s64, 66112
  buffer_load_dwordx4 v224, s[32:35], s60 offen lds
  ds_read_b128 a[32:35], v226 offset:8192
  ds_read_b128 a[36:39], v227 offset:8192
  v_exp_f32 v124, v124
  v_exp_f32 v125, v125
  v_exp_f32 v126, v126
  v_exp_f32 v127, v127
  v_cvt_pk_bf16_f32 v144, v120, v121
  v_cvt_pk_bf16_f32 v145, v122, v123
  v_mfma_f32_32x32x16_bf16 v[72:87], v[160:163], v[136:139], v[72:87]
  v_exp_f32 v128, v128
  v_exp_f32 v129, v129
  v_exp_f32 v130, v130
  v_exp_f32 v131, v131
  v_cvt_pk_bf16_f32 v146, v124, v125
  v_cvt_pk_bf16_f32 v147, v126, v127
  v_mfma_f32_32x32x16_bf16 v[72:87], v[164:167], v[140:143], v[72:87]
  v_exp_f32 v132, v132
  v_exp_f32 v133, v133
  v_exp_f32 v134, v134
  v_exp_f32 v135, v135
  v_cvt_pk_bf16_f32 v148, v128, v129
  v_cvt_pk_bf16_f32 v149, v130, v131
  s_add_u32 m0, s66, 0
  s_add_u32 s69, s58, 1792
  buffer_load_dwordx4 v4, s[36:39], s69 offen lds
  v_cvt_pk_bf16_f32 v150, v132, v133
  v_cvt_pk_bf16_f32 v151, v134, v135
  v_mfma_f32_32x32x16_bf16 v[120:135], v[168:171], v[16:19], 0
  v_exp_f32 v104, v104
  v_exp_f32 v105, v105
  v_exp_f32 v106, v106
  v_exp_f32 v107, v107
  v_mfma_f32_32x32x16_bf16 v[120:135], v[172:175], v[20:23], v[120:135]
  s_waitcnt lgkmcnt(0)
  s_add_u32 m0, s65, 8192
  s_add_u32 s60, s64, 640
  buffer_load_dwordx4 v224, s[32:35], s60 offen lds
  v_exp_f32 v108, v108
  v_exp_f32 v109, v109
  v_exp_f32 v110, v110
  v_exp_f32 v111, v111
  v_cvt_pk_bf16_f32 v136, v104, v105
  v_cvt_pk_bf16_f32 v137, v106, v107
  v_mfma_f32_32x32x16_bf16 v[88:103], v[160:163], v[144:147], v[88:103]
  v_exp_f32 v112, v112
  v_exp_f32 v113, v113
  v_exp_f32 v114, v114
  v_exp_f32 v115, v115
  v_cvt_pk_bf16_f32 v138, v108, v109
  v_cvt_pk_bf16_f32 v139, v110, v111
  v_mfma_f32_32x32x16_bf16 v[88:103], v[164:167], v[148:151], v[88:103]
  v_exp_f32 v116, v116
  v_exp_f32 v117, v117
  v_exp_f32 v118, v118
  v_exp_f32 v119, v119
  v_cvt_pk_bf16_f32 v140, v112, v113
  v_cvt_pk_bf16_f32 v141, v114, v115
  v_cvt_pk_bf16_f32 v142, v116, v117
  v_cvt_pk_bf16_f32 v143, v118, v119
  v_mfma_f32_32x32x16_bf16 v[104:119], v[168:171], v[24:27], 0
  v_exp_f32 v120, v120
  v_exp_f32 v121, v121
  v_exp_f32 v122, v122
  v_exp_f32 v123, v123
  v_mfma_f32_32x32x16_bf16 v[104:119], v[172:175], v[28:31], v[104:119]
  s_add_u32 m0, s65, 9216
  s_add_u32 s60, s64, 66176
  buffer_load_dwordx4 v224, s[32:35], s60 offen lds
  s_waitcnt vmcnt(21)
  ds_read_b128 a[40:43], v226 offset:10240
  ds_read_b128 a[44:47], v227 offset:10240
  v_exp_f32 v124, v124
  v_exp_f32 v125, v125
  v_exp_f32 v126, v126
  v_exp_f32 v127, v127
  v_cvt_pk_bf16_f32 v144, v120, v121
  v_cvt_pk_bf16_f32 v145, v122, v123
  v_mfma_f32_32x32x16_bf16 v[40:55], v[176:179], v[136:139], v[40:55]
  v_exp_f32 v128, v128
  v_exp_f32 v129, v129
  v_exp_f32 v130, v130
  v_exp_f32 v131, v131
  v_cvt_pk_bf16_f32 v146, v124, v125
  v_cvt_pk_bf16_f32 v147, v126, v127
  v_mfma_f32_32x32x16_bf16 v[40:55], v[180:183], v[140:143], v[40:55]
  v_exp_f32 v132, v132
  v_exp_f32 v133, v133
  v_exp_f32 v134, v134
  v_exp_f32 v135, v135
  v_cvt_pk_bf16_f32 v148, v128, v129
  v_cvt_pk_bf16_f32 v149, v130, v131
  buffer_load_dwordx4 v[152:155], v1, s[28:31], s55 offen offset:0
  buffer_load_dwordx4 v[156:159], v1, s[28:31], s55 offen offset:1024
  v_cvt_pk_bf16_f32 v150, v132, v133
  v_cvt_pk_bf16_f32 v151, v134, v135
  v_mfma_f32_32x32x16_bf16 v[120:135], v[168:171], v[32:35], 0
  v_exp_f32 v104, v104
  v_exp_f32 v105, v105
  v_exp_f32 v106, v106
  v_exp_f32 v107, v107
  v_mfma_f32_32x32x16_bf16 v[120:135], v[172:175], v[36:39], v[120:135]
  s_waitcnt lgkmcnt(0)
  s_add_u32 m0, s65, 10240
  s_add_u32 s60, s64, 704
  buffer_load_dwordx4 v224, s[32:35], s60 offen lds
  v_exp_f32 v108, v108
  v_exp_f32 v109, v109
  v_exp_f32 v110, v110
  v_exp_f32 v111, v111
  v_cvt_pk_bf16_f32 v136, v104, v105
  v_cvt_pk_bf16_f32 v137, v106, v107
  v_mfma_f32_32x32x16_bf16 v[56:71], v[176:179], v[144:147], v[56:71]
  v_exp_f32 v112, v112
  v_exp_f32 v113, v113
  v_exp_f32 v114, v114
  v_exp_f32 v115, v115
  v_cvt_pk_bf16_f32 v138, v108, v109
  v_cvt_pk_bf16_f32 v139, v110, v111
  v_mfma_f32_32x32x16_bf16 v[56:71], v[180:183], v[148:151], v[56:71]
  v_exp_f32 v116, v116
  v_exp_f32 v117, v117
  v_exp_f32 v118, v118
  v_exp_f32 v119, v119
  v_cvt_pk_bf16_f32 v140, v112, v113
  v_cvt_pk_bf16_f32 v141, v114, v115
  buffer_load_dwordx4 v[160:163], v1, s[28:31], s55 offen offset:2048
  buffer_load_dwordx4 v[164:167], v1, s[28:31], s55 offen offset:3072
  s_add_u32 s55, s55, 4096
  v_cvt_pk_bf16_f32 v142, v116, v117
  v_cvt_pk_bf16_f32 v143, v118, v119
  s_waitcnt vmcnt(18)
  v_mfma_f32_32x32x16_bf16 v[104:119], v[184:187], v[8:11], 0
  v_exp_f32 v120, v120
  v_exp_f32 v121, v121
  v_exp_f32 v122, v122
  v_exp_f32 v123, v123
  v_mfma_f32_32x32x16_bf16 v[104:119], v[188:191], v[12:15], v[104:119]
  s_add_u32 m0, s65, 11264
  s_add_u32 s60, s64, 66240
  buffer_load_dwordx4 v224, s[32:35], s60 offen lds
  ds_read_b128 a[48:51], v226 offset:0
  ds_read_b128 a[52:55], v227 offset:0
  v_exp_f32 v124, v124
  v_exp_f32 v125, v125
  v_exp_f32 v126, v126
  v_exp_f32 v127, v127
  v_cvt_pk_bf16_f32 v144, v120, v121
  v_cvt_pk_bf16_f32 v145, v122, v123
  v_mfma_f32_32x32x16_bf16 v[72:87], v[176:179], v[136:139], v[72:87]
  v_exp_f32 v128, v128
  v_exp_f32 v129, v129
  v_exp_f32 v130, v130
  v_exp_f32 v131, v131
  v_cvt_pk_bf16_f32 v146, v124, v125
  v_cvt_pk_bf16_f32 v147, v126, v127
  v_mfma_f32_32x32x16_bf16 v[72:87], v[180:183], v[140:143], v[72:87]
  v_exp_f32 v132, v132
  v_exp_f32 v133, v133
  v_exp_f32 v134, v134
  v_exp_f32 v135, v135
  v_cvt_pk_bf16_f32 v148, v128, v129
  v_cvt_pk_bf16_f32 v149, v130, v131
  s_add_u32 m0, s66, 1024
  s_add_u32 s69, s58, 1856
  buffer_load_dwordx4 v4, s[36:39], s69 offen lds
  v_cvt_pk_bf16_f32 v150, v132, v133
  v_cvt_pk_bf16_f32 v151, v134, v135
  v_mfma_f32_32x32x16_bf16 v[120:135], v[184:187], v[16:19], 0
  v_exp_f32 v104, v104
  v_exp_f32 v105, v105
  v_exp_f32 v106, v106
  v_exp_f32 v107, v107
  v_mfma_f32_32x32x16_bf16 v[120:135], v[188:191], v[20:23], v[120:135]
  s_waitcnt lgkmcnt(0)
  s_add_u32 m0, s65, 0
  s_add_u32 s60, s64, 768
  buffer_load_dwordx4 v224, s[32:35], s60 offen lds
  v_exp_f32 v108, v108
  v_exp_f32 v109, v109
  v_exp_f32 v110, v110
  v_exp_f32 v111, v111
  v_cvt_pk_bf16_f32 v136, v104, v105
  v_cvt_pk_bf16_f32 v137, v106, v107
  v_mfma_f32_32x32x16_bf16 v[88:103], v[176:179], v[144:147], v[88:103]
  v_exp_f32 v112, v112
  v_exp_f32 v113, v113
  v_exp_f32 v114, v114
  v_exp_f32 v115, v115
  v_cvt_pk_bf16_f32 v138, v108, v109
  v_cvt_pk_bf16_f32 v139, v110, v111
  v_mfma_f32_32x32x16_bf16 v[88:103], v[180:183], v[148:151], v[88:103]
  v_exp_f32 v116, v116
  v_exp_f32 v117, v117
  v_exp_f32 v118, v118
  v_exp_f32 v119, v119
  v_cvt_pk_bf16_f32 v140, v112, v113
  v_cvt_pk_bf16_f32 v141, v114, v115
  v_cvt_pk_bf16_f32 v142, v116, v117
  v_cvt_pk_bf16_f32 v143, v118, v119
  v_mfma_f32_32x32x16_bf16 v[104:119], v[184:187], v[24:27], 0
  v_exp_f32 v120, v120
  v_exp_f32 v121, v121
  v_exp_f32 v122, v122
  v_exp_f32 v123, v123
  v_mfma_f32_32x32x16_bf16 v[104:119], v[188:191], v[28:31], v[104:119]
  s_add_u32 m0, s65, 1024
  s_add_u32 s60, s64, 66304
  buffer_load_dwordx4 v224, s[32:35], s60 offen lds
  s_waitcnt vmcnt(21)
  ds_read_b128 a[56:59], v226 offset:2048
  ds_read_b128 a[60:63], v227 offset:2048
  v_exp_f32 v124, v124
  v_exp_f32 v125, v125
  v_exp_f32 v126, v126
  v_exp_f32 v127, v127
  v_cvt_pk_bf16_f32 v144, v120, v121
  v_cvt_pk_bf16_f32 v145, v122, v123
  v_mfma_f32_32x32x16_bf16 v[40:55], v[192:195], v[136:139], v[40:55]
  v_exp_f32 v128, v128
  v_exp_f32 v129, v129
  v_exp_f32 v130, v130
  v_exp_f32 v131, v131
  v_cvt_pk_bf16_f32 v146, v124, v125
  v_cvt_pk_bf16_f32 v147, v126, v127
  v_mfma_f32_32x32x16_bf16 v[40:55], v[196:199], v[140:143], v[40:55]
  v_exp_f32 v132, v132
  v_exp_f32 v133, v133
  v_exp_f32 v134, v134
  v_exp_f32 v135, v135
  v_cvt_pk_bf16_f32 v148, v128, v129
  v_cvt_pk_bf16_f32 v149, v130, v131
  buffer_load_dwordx4 v[168:171], v1, s[28:31], s55 offen offset:0
  buffer_load_dwordx4 v[172:175], v1, s[28:31], s55 offen offset:1024
  v_cvt_pk_bf16_f32 v150, v132, v133
  v_cvt_pk_bf16_f32 v151, v134, v135
  v_mfma_f32_32x32x16_bf16 v[120:135], v[184:187], v[32:35], 0
  v_exp_f32 v104, v104
  v_exp_f32 v105, v105
  v_exp_f32 v106, v106
  v_exp_f32 v107, v107
  v_mfma_f32_32x32x16_bf16 v[120:135], v[188:191], v[36:39], v[120:135]
  s_waitcnt lgkmcnt(0)
  s_add_u32 m0, s65, 2048
  s_add_u32 s60, s64, 832
  buffer_load_dwordx4 v224, s[32:35], s60 offen lds
  v_exp_f32 v108, v108
  v_exp_f32 v109, v109
  v_exp_f32 v110, v110
  v_exp_f32 v111, v111
  v_cvt_pk_bf16_f32 v136, v104, v105
  v_cvt_pk_bf16_f32 v137, v106, v107
  v_mfma_f32_32x32x16_bf16 v[56:71], v[192:195], v[144:147], v[56:71]
  v_exp_f32 v112, v112
  v_exp_f32 v113, v113
  v_exp_f32 v114, v114
  v_exp_f32 v115, v115
  v_cvt_pk_bf16_f32 v138, v108, v109
  v_cvt_pk_bf16_f32 v139, v110, v111
  v_mfma_f32_32x32x16_bf16 v[56:71], v[196:199], v[148:151], v[56:71]
  v_exp_f32 v116, v116
  v_exp_f32 v117, v117
  v_exp_f32 v118, v118
  v_exp_f32 v119, v119
  v_cvt_pk_bf16_f32 v140, v112, v113
  v_cvt_pk_bf16_f32 v141, v114, v115
  buffer_load_dwordx4 v[176:179], v1, s[28:31], s55 offen offset:2048
  buffer_load_dwordx4 v[180:183], v1, s[28:31], s55 offen offset:3072
  s_add_u32 s55, s55, 4096
  v_cvt_pk_bf16_f32 v142, v116, v117
  v_cvt_pk_bf16_f32 v143, v118, v119
  s_waitcnt vmcnt(18)
  v_mfma_f32_32x32x16_bf16 v[104:119], v[200:203], v[8:11], 0
  v_exp_f32 v120, v120
  v_exp_f32 v121, v121
  v_exp_f32 v122, v122
  v_exp_f32 v123, v123
  v_mfma_f32_32x32x16_bf16 v[104:119], v[204:207], v[12:15], v[104:119]
  s_add_u32 m0, s65, 3072
  s_add_u32 s60, s64, 66368
  buffer_load_dwordx4 v224, s[32:35], s60 offen lds
  ds_read_b128 a[64:67], v226 offset:4096
  ds_read_b128 a[68:71], v227 offset:4096
  v_exp_f32 v124, v124
  v_exp_f32 v125, v125
  v_exp_f32 v126, v126
  v_exp_f32 v127, v127
  v_cvt_pk_bf16_f32 v144, v120, v121
  v_cvt_pk_bf16_f32 v145, v122, v123
  v_mfma_f32_32x32x16_bf16 v[72:87], v[192:195], v[136:139], v[72:87]
  v_exp_f32 v128, v128
  v_exp_f32 v129, v129
  v_exp_f32 v130, v130
  v_exp_f32 v131, v131
  v_cvt_pk_bf16_f32 v146, v124, v125
  v_cvt_pk_bf16_f32 v147, v126, v127
  v_mfma_f32_32x32x16_bf16 v[72:87], v[196:199], v[140:143], v[72:87]
  v_exp_f32 v132, v132
  v_exp_f32 v133, v133
  v_exp_f32 v134, v134
  v_exp_f32 v135, v135
  v_cvt_pk_bf16_f32 v148, v128, v129
  v_cvt_pk_bf16_f32 v149, v130, v131
  s_add_u32 m0, s66, 2048
  s_add_u32 s69, s58, 0
  buffer_load_dwordx4 v4, s[36:39], s69 offen lds
  v_cvt_pk_bf16_f32 v150, v132, v133
  v_cvt_pk_bf16_f32 v151, v134, v135
  v_mfma_f32_32x32x16_bf16 v[120:135], v[200:203], v[16:19], 0
  v_exp_f32 v104, v104
  v_exp_f32 v105, v105
  v_exp_f32 v106, v106
  v_exp_f32 v107, v107
  v_mfma_f32_32x32x16_bf16 v[120:135], v[204:207], v[20:23], v[120:135]
  s_waitcnt lgkmcnt(0)
  s_add_u32 m0, s65, 4096
  s_add_u32 s60, s64, 896
  buffer_load_dwordx4 v224, s[32:35], s60 offen lds
  v_exp_f32 v108, v108
  v_exp_f32 v109, v109
  v_exp_f32 v110, v110
  v_exp_f32 v111, v111
  v_cvt_pk_bf16_f32 v136, v104, v105
  v_cvt_pk_bf16_f32 v137, v106, v107
  v_mfma_f32_32x32x16_bf16 v[88:103], v[192:195], v[144:147], v[88:103]
  v_exp_f32 v112, v112
  v_exp_f32 v113, v113
  v_exp_f32 v114, v114
  v_exp_f32 v115, v115
  v_cvt_pk_bf16_f32 v138, v108, v109
  v_cvt_pk_bf16_f32 v139, v110, v111
  v_mfma_f32_32x32x16_bf16 v[88:103], v[196:199], v[148:151], v[88:103]
  v_exp_f32 v116, v116
  v_exp_f32 v117, v117
  v_exp_f32 v118, v118
  v_exp_f32 v119, v119
  v_cvt_pk_bf16_f32 v140, v112, v113
  v_cvt_pk_bf16_f32 v141, v114, v115
  v_cvt_pk_bf16_f32 v142, v116, v117
  v_cvt_pk_bf16_f32 v143, v118, v119
  v_mfma_f32_32x32x16_bf16 v[104:119], v[200:203], v[24:27], 0
  v_exp_f32 v120, v120
  v_exp_f32 v121, v121
  v_exp_f32 v122, v122
  v_exp_f32 v123, v123
  v_mfma_f32_32x32x16_bf16 v[104:119], v[204:207], v[28:31], v[104:119]
  s_add_u32 m0, s65, 5120
  s_add_u32 s60, s64, 66432
  buffer_load_dwordx4 v224, s[32:35], s60 offen lds
  s_waitcnt vmcnt(21)
  ds_read_b128 a[72:75], v226 offset:6144
  ds_read_b128 a[76:79], v227 offset:6144
  v_exp_f32 v124, v124
  v_exp_f32 v125, v125
  v_exp_f32 v126, v126
  v_exp_f32 v127, v127
  v_cvt_pk_bf16_f32 v144, v120, v121
  v_cvt_pk_bf16_f32 v145, v122, v123
  v_mfma_f32_32x32x16_bf16 v[40:55], v[208:211], v[136:139], v[40:55]
  v_exp_f32 v128, v128
  v_exp_f32 v129, v129
  v_exp_f32 v130, v130
  v_exp_f32 v131, v131
  v_cvt_pk_bf16_f32 v146, v124, v125
  v_cvt_pk_bf16_f32 v147, v126, v127
  v_mfma_f32_32x32x16_bf16 v[40:55], v[212:215], v[140:143], v[40:55]
  v_exp_f32 v132, v132
  v_exp_f32 v133, v133
  v_exp_f32 v134, v134
  v_exp_f32 v135, v135
  v_cvt_pk_bf16_f32 v148, v128, v129
  v_cvt_pk_bf16_f32 v149, v130, v131
  buffer_load_dwordx4 v[184:187], v1, s[28:31], s55 offen offset:0
  buffer_load_dwordx4 v[188:191], v1, s[28:31], s55 offen offset:1024
  v_cvt_pk_bf16_f32 v150, v132, v133
  v_cvt_pk_bf16_f32 v151, v134, v135
  v_mfma_f32_32x32x16_bf16 v[120:135], v[200:203], v[32:35], 0
  v_exp_f32 v104, v104
  v_exp_f32 v105, v105
  v_exp_f32 v106, v106
  v_exp_f32 v107, v107
  v_mfma_f32_32x32x16_bf16 v[120:135], v[204:207], v[36:39], v[120:135]
  s_waitcnt lgkmcnt(0)
  s_add_u32 m0, s65, 6144
  s_add_u32 s60, s64, 960
  buffer_load_dwordx4 v224, s[32:35], s60 offen lds
  v_exp_f32 v108, v108
  v_exp_f32 v109, v109
  v_exp_f32 v110, v110
  v_exp_f32 v111, v111
  v_cvt_pk_bf16_f32 v136, v104, v105
  v_cvt_pk_bf16_f32 v137, v106, v107
  v_mfma_f32_32x32x16_bf16 v[56:71], v[208:211], v[144:147], v[56:71]
  v_exp_f32 v112, v112
  v_exp_f32 v113, v113
  v_exp_f32 v114, v114
  v_exp_f32 v115, v115
  v_cvt_pk_bf16_f32 v138, v108, v109
  v_cvt_pk_bf16_f32 v139, v110, v111
  v_mfma_f32_32x32x16_bf16 v[56:71], v[212:215], v[148:151], v[56:71]
  v_exp_f32 v116, v116
  v_exp_f32 v117, v117
  v_exp_f32 v118, v118
  v_exp_f32 v119, v119
  v_cvt_pk_bf16_f32 v140, v112, v113
  v_cvt_pk_bf16_f32 v141, v114, v115
  buffer_load_dwordx4 v[192:195], v1, s[28:31], s55 offen offset:2048
  buffer_load_dwordx4 v[196:199], v1, s[28:31], s55 offen offset:3072
  s_add_u32 s55, s55, 4096
  v_cvt_pk_bf16_f32 v142, v116, v117
  v_cvt_pk_bf16_f32 v143, v118, v119
  s_waitcnt vmcnt(18)
  v_mfma_f32_32x32x16_bf16 v[104:119], v[152:155], v[8:11], 0
  v_exp_f32 v120, v120
  v_exp_f32 v121, v121
  v_exp_f32 v122, v122
  v_exp_f32 v123, v123
  v_mfma_f32_32x32x16_bf16 v[104:119], v[156:159], v[12:15], v[104:119]
  s_add_u32 m0, s65, 7168
  s_add_u32 s60, s64, 66496
  buffer_load_dwordx4 v224, s[32:35], s60 offen lds
  ds_read_b128 a[80:83], v226 offset:8192
  ds_read_b128 a[84:87], v227 offset:8192
  v_exp_f32 v124, v124
  v_exp_f32 v125, v125
  v_exp_f32 v126, v126
  v_exp_f32 v127, v127
  v_cvt_pk_bf16_f32 v144, v120, v121
  v_cvt_pk_bf16_f32 v145, v122, v123
  v_mfma_f32_32x32x16_bf16 v[72:87], v[208:211], v[136:139], v[72:87]
  v_exp_f32 v128, v128
  v_exp_f32 v129, v129
  v_exp_f32 v130, v130
  v_exp_f32 v131, v131
  v_cvt_pk_bf16_f32 v146, v124, v125
  v_cvt_pk_bf16_f32 v147, v126, v127
  v_mfma_f32_32x32x16_bf16 v[72:87], v[212:215], v[140:143], v[72:87]
  v_exp_f32 v132, v132
  v_exp_f32 v133, v133
  v_exp_f32 v134, v134
  v_exp_f32 v135, v135
  v_cvt_pk_bf16_f32 v148, v128, v129
  v_cvt_pk_bf16_f32 v149, v130, v131
  s_add_u32 m0, s66, 3072
  s_add_u32 s69, s58, 64
  buffer_load_dwordx4 v4, s[36:39], s69 offen lds
  s_add_u32 s58, s58, 229376
  s_add_u32 s66, s66, 16384
  v_cvt_pk_bf16_f32 v150, v132, v133
  v_cvt_pk_bf16_f32 v151, v134, v135
  v_mfma_f32_32x32x16_bf16 v[120:135], v[152:155], v[16:19], 0
  v_exp_f32 v104, v104
  v_exp_f32 v105, v105
  v_exp_f32 v106, v106
  v_exp_f32 v107, v107
  v_mfma_f32_32x32x16_bf16 v[120:135], v[156:159], v[20:23], v[120:135]
  s_waitcnt lgkmcnt(0)
  s_add_u32 m0, s65, 8192
  s_add_u32 s60, s64, 1024
  buffer_load_dwordx4 v224, s[32:35], s60 offen lds
  v_exp_f32 v108, v108
  v_exp_f32 v109, v109
  v_exp_f32 v110, v110
  v_exp_f32 v111, v111
  v_cvt_pk_bf16_f32 v136, v104, v105
  v_cvt_pk_bf16_f32 v137, v106, v107
  v_mfma_f32_32x32x16_bf16 v[88:103], v[208:211], v[144:147], v[88:103]
  v_exp_f32 v112, v112
  v_exp_f32 v113, v113
  v_exp_f32 v114, v114
  v_exp_f32 v115, v115
  v_cvt_pk_bf16_f32 v138, v108, v109
  v_cvt_pk_bf16_f32 v139, v110, v111
  v_mfma_f32_32x32x16_bf16 v[88:103], v[212:215], v[148:151], v[88:103]
  v_exp_f32 v116, v116
  v_exp_f32 v117, v117
  v_exp_f32 v118, v118
  v_exp_f32 v119, v119
  v_cvt_pk_bf16_f32 v140, v112, v113
  v_cvt_pk_bf16_f32 v141, v114, v115
  v_cvt_pk_bf16_f32 v142, v116, v117
  v_cvt_pk_bf16_f32 v143, v118, v119
  v_mfma_f32_32x32x16_bf16 v[104:119], v[152:155], v[24:27], 0
  v_exp_f32 v120, v120
  v_exp_f32 v121, v121
  v_exp_f32 v122, v122
  v_exp_f32 v123, v123
  v_mfma_f32_32x32x16_bf16 v[104:119], v[156:159], v[28:31], v[104:119]
  s_add_u32 m0, s65, 9216
  s_add_u32 s60, s64, 66560
  buffer_load_dwordx4 v224, s[32:35], s60 offen lds
  s_waitcnt vmcnt(21)
  ds_read_b128 a[88:91], v226 offset:10240
  ds_read_b128 a[92:95], v227 offset:10240
  v_exp_f32 v124, v124
  v_exp_f32 v125, v125
  v_exp_f32 v126, v126
  v_exp_f32 v127, v127
  v_cvt_pk_bf16_f32 v144, v120, v121
  v_cvt_pk_bf16_f32 v145, v122, v123
  v_mfma_f32_32x32x16_bf16 v[40:55], v[160:163], v[136:139], v[40:55]
  v_exp_f32 v128, v128
  v_exp_f32 v129, v129
  v_exp_f32 v130, v130
  v_exp_f32 v131, v131
  v_cvt_pk_bf16_f32 v146, v124, v125
  v_cvt_pk_bf16_f32 v147, v126, v127
  v_mfma_f32_32x32x16_bf16 v[40:55], v[164:167], v[140:143], v[40:55]
  v_exp_f32 v132, v132
  v_exp_f32 v133, v133
  v_exp_f32 v134, v134
  v_exp_f32 v135, v135
  v_cvt_pk_bf16_f32 v148, v128, v129
  v_cvt_pk_bf16_f32 v149, v130, v131
  buffer_load_dwordx4 v[200:203], v1, s[28:31], s55 offen offset:0
  buffer_load_dwordx4 v[204:207], v1, s[28:31], s55 offen offset:1024
  v_cvt_pk_bf16_f32 v150, v132, v133
  v_cvt_pk_bf16_f32 v151, v134, v135
  v_mfma_f32_32x32x16_bf16 v[120:135], v[152:155], v[32:35], 0
  v_exp_f32 v104, v104
  v_exp_f32 v105, v105
  v_exp_f32 v106, v106
  v_exp_f32 v107, v107
  v_mfma_f32_32x32x16_bf16 v[120:135], v[156:159], v[36:39], v[120:135]
  s_waitcnt lgkmcnt(0)
  s_add_u32 m0, s65, 10240
  s_add_u32 s60, s64, 1088
  buffer_load_dwordx4 v224, s[32:35], s60 offen lds
  v_exp_f32 v108, v108
  v_exp_f32 v109, v109
  v_exp_f32 v110, v110
  v_exp_f32 v111, v111
  v_cvt_pk_bf16_f32 v136, v104, v105
  v_cvt_pk_bf16_f32 v137, v106, v107
  v_mfma_f32_32x32x16_bf16 v[56:71], v[160:163], v[144:147], v[56:71]
  v_exp_f32 v112, v112
  v_exp_f32 v113, v113
  v_exp_f32 v114, v114
  v_exp_f32 v115, v115
  v_cvt_pk_bf16_f32 v138, v108, v109
  v_cvt_pk_bf16_f32 v139, v110, v111
  v_mfma_f32_32x32x16_bf16 v[56:71], v[164:167], v[148:151], v[56:71]
  v_exp_f32 v116, v116
  v_exp_f32 v117, v117
  v_exp_f32 v118, v118
  v_exp_f32 v119, v119
  v_cvt_pk_bf16_f32 v140, v112, v113
  v_cvt_pk_bf16_f32 v141, v114, v115
  buffer_load_dwordx4 v[208:211], v1, s[28:31], s55 offen offset:2048
  buffer_load_dwordx4 v[212:215], v1, s[28:31], s55 offen offset:3072
  s_add_u32 s55, s55, 4096
  v_cvt_pk_bf16_f32 v142, v116, v117
  v_cvt_pk_bf16_f32 v143, v118, v119
  s_waitcnt vmcnt(18)
  v_mfma_f32_32x32x16_bf16 v[104:119], v[168:171], v[8:11], 0
  v_exp_f32 v120, v120
  v_exp_f32 v121, v121
  v_exp_f32 v122, v122
  v_exp_f32 v123, v123
  v_mfma_f32_32x32x16_bf16 v[104:119], v[172:175], v[12:15], v[104:119]
  s_add_u32 m0, s65, 11264
  s_add_u32 s60, s64, 66624
  buffer_load_dwordx4 v224, s[32:35], s60 offen lds
  ds_read_b128 a[96:99], v226 offset:0
  ds_read_b128 a[100:103], v227 offset:0
  v_exp_f32 v124, v124
  v_exp_f32 v125, v125
  v_exp_f32 v126, v126
  v_exp_f32 v127, v127
  v_cvt_pk_bf16_f32 v144, v120, v121
  v_cvt_pk_bf16_f32 v145, v122, v123
  v_mfma_f32_32x32x16_bf16 v[72:87], v[160:163], v[136:139], v[72:87]
  v_exp_f32 v128, v128
  v_exp_f32 v129, v129
  v_exp_f32 v130, v130
  v_exp_f32 v131, v131
  v_cvt_pk_bf16_f32 v146, v124, v125
  v_cvt_pk_bf16_f32 v147, v126, v127
  v_mfma_f32_32x32x16_bf16 v[72:87], v[164:167], v[140:143], v[72:87]
  v_exp_f32 v132, v132
  v_exp_f32 v133, v133
  v_exp_f32 v134, v134
  v_exp_f32 v135, v135
  v_cvt_pk_bf16_f32 v148, v128, v129
  v_cvt_pk_bf16_f32 v149, v130, v131
  s_add_u32 m0, s66, 0
  s_add_u32 s69, s58, 1792
  buffer_load_dwordx4 v4, s[36:39], s69 offen lds
  v_cvt_pk_bf16_f32 v150, v132, v133
  v_cvt_pk_bf16_f32 v151, v134, v135
  v_mfma_f32_32x32x16_bf16 v[120:135], v[168:171], v[16:19], 0
  v_exp_f32 v104, v104
  v_exp_f32 v105, v105
  v_exp_f32 v106, v106
  v_exp_f32 v107, v107
  v_mfma_f32_32x32x16_bf16 v[120:135], v[172:175], v[20:23], v[120:135]
  s_waitcnt lgkmcnt(0)
  s_add_u32 m0, s65, 0
  s_add_u32 s60, s64, 1152
  buffer_load_dwordx4 v224, s[32:35], s60 offen lds
  v_exp_f32 v108, v108
  v_exp_f32 v109, v109
  v_exp_f32 v110, v110
  v_exp_f32 v111, v111
  v_cvt_pk_bf16_f32 v136, v104, v105
  v_cvt_pk_bf16_f32 v137, v106, v107
  v_mfma_f32_32x32x16_bf16 v[88:103], v[160:163], v[144:147], v[88:103]
  v_exp_f32 v112, v112
  v_exp_f32 v113, v113
  v_exp_f32 v114, v114
  v_exp_f32 v115, v115
  v_cvt_pk_bf16_f32 v138, v108, v109
  v_cvt_pk_bf16_f32 v139, v110, v111
  v_mfma_f32_32x32x16_bf16 v[88:103], v[164:167], v[148:151], v[88:103]
  v_exp_f32 v116, v116
  v_exp_f32 v117, v117
  v_exp_f32 v118, v118
  v_exp_f32 v119, v119
  v_cvt_pk_bf16_f32 v140, v112, v113
  v_cvt_pk_bf16_f32 v141, v114, v115
  v_cvt_pk_bf16_f32 v142, v116, v117
  v_cvt_pk_bf16_f32 v143, v118, v119
  v_mfma_f32_32x32x16_bf16 v[104:119], v[168:171], v[24:27], 0
  v_exp_f32 v120, v120
  v_exp_f32 v121, v121
  v_exp_f32 v122, v122
  v_exp_f32 v123, v123
  v_mfma_f32_32x32x16_bf16 v[104:119], v[172:175], v[28:31], v[104:119]
  s_add_u32 m0, s65, 1024
  s_add_u32 s60, s64, 66688
  buffer_load_dwordx4 v224, s[32:35], s60 offen lds
  s_waitcnt vmcnt(21)
  ds_read_b128 a[104:107], v226 offset:2048
  ds_read_b128 a[108:111], v227 offset:2048
  v_exp_f32 v124, v124
  v_exp_f32 v125, v125
  v_exp_f32 v126, v126
  v_exp_f32 v127, v127
  v_cvt_pk_bf16_f32 v144, v120, v121
  v_cvt_pk_bf16_f32 v145, v122, v123
  v_mfma_f32_32x32x16_bf16 v[40:55], v[176:179], v[136:139], v[40:55]
  v_exp_f32 v128, v128
  v_exp_f32 v129, v129
  v_exp_f32 v130, v130
  v_exp_f32 v131, v131
  v_cvt_pk_bf16_f32 v146, v124, v125
  v_cvt_pk_bf16_f32 v147, v126, v127
  v_mfma_f32_32x32x16_bf16 v[40:55], v[180:183], v[140:143], v[40:55]
  v_exp_f32 v132, v132
  v_exp_f32 v133, v133
  v_exp_f32 v134, v134
  v_exp_f32 v135, v135
  v_cvt_pk_bf16_f32 v148, v128, v129
  v_cvt_pk_bf16_f32 v149, v130, v131
  buffer_load_dwordx4 v[152:155], v1, s[28:31], s55 offen offset:0
  buffer_load_dwordx4 v[156:159], v1, s[28:31], s55 offen offset:1024
  v_cvt_pk_bf16_f32 v150, v132, v133
  v_cvt_pk_bf16_f32 v151, v134, v135
  v_mfma_f32_32x32x16_bf16 v[120:135], v[168:171], v[32:35], 0
  v_exp_f32 v104, v104
  v_exp_f32 v105, v105
  v_exp_f32 v106, v106
  v_exp_f32 v107, v107
  v_mfma_f32_32x32x16_bf16 v[120:135], v[172:175], v[36:39], v[120:135]
  s_waitcnt lgkmcnt(0)
  s_add_u32 m0, s65, 2048
  s_add_u32 s60, s64, 1216
  buffer_load_dwordx4 v224, s[32:35], s60 offen lds
  v_exp_f32 v108, v108
  v_exp_f32 v109, v109
  v_exp_f32 v110, v110
  v_exp_f32 v111, v111
  v_cvt_pk_bf16_f32 v136, v104, v105
  v_cvt_pk_bf16_f32 v137, v106, v107
  v_mfma_f32_32x32x16_bf16 v[56:71], v[176:179], v[144:147], v[56:71]
  v_exp_f32 v112, v112
  v_exp_f32 v113, v113
  v_exp_f32 v114, v114
  v_exp_f32 v115, v115
  v_cvt_pk_bf16_f32 v138, v108, v109
  v_cvt_pk_bf16_f32 v139, v110, v111
  v_mfma_f32_32x32x16_bf16 v[56:71], v[180:183], v[148:151], v[56:71]
  v_exp_f32 v116, v116
  v_exp_f32 v117, v117
  v_exp_f32 v118, v118
  v_exp_f32 v119, v119
  v_cvt_pk_bf16_f32 v140, v112, v113
  v_cvt_pk_bf16_f32 v141, v114, v115
  buffer_load_dwordx4 v[160:163], v1, s[28:31], s55 offen offset:2048
  buffer_load_dwordx4 v[164:167], v1, s[28:31], s55 offen offset:3072
  s_add_u32 s55, s55, 4096
  v_cvt_pk_bf16_f32 v142, v116, v117
  v_cvt_pk_bf16_f32 v143, v118, v119
  s_waitcnt vmcnt(18)
  v_mfma_f32_32x32x16_bf16 v[104:119], v[184:187], v[8:11], 0
  v_exp_f32 v120, v120
  v_exp_f32 v121, v121
  v_exp_f32 v122, v122
  v_exp_f32 v123, v123
  v_mfma_f32_32x32x16_bf16 v[104:119], v[188:191], v[12:15], v[104:119]
  s_add_u32 m0, s65, 3072
  s_add_u32 s60, s64, 66752
  buffer_load_dwordx4 v224, s[32:35], s60 offen lds
  ds_read_b128 a[112:115], v226 offset:4096
  ds_read_b128 a[116:119], v227 offset:4096
  v_exp_f32 v124, v124
  v_exp_f32 v125, v125
  v_exp_f32 v126, v126
  v_exp_f32 v127, v127
  v_cvt_pk_bf16_f32 v144, v120, v121
  v_cvt_pk_bf16_f32 v145, v122, v123
  v_mfma_f32_32x32x16_bf16 v[72:87], v[176:179], v[136:139], v[72:87]
  v_exp_f32 v128, v128
  v_exp_f32 v129, v129
  v_exp_f32 v130, v130
  v_exp_f32 v131, v131
  v_cvt_pk_bf16_f32 v146, v124, v125
  v_cvt_pk_bf16_f32 v147, v126, v127
  v_mfma_f32_32x32x16_bf16 v[72:87], v[180:183], v[140:143], v[72:87]
  v_exp_f32 v132, v132
  v_exp_f32 v133, v133
  v_exp_f32 v134, v134
  v_exp_f32 v135, v135
  v_cvt_pk_bf16_f32 v148, v128, v129
  v_cvt_pk_bf16_f32 v149, v130, v131
  s_add_u32 m0, s66, 1024
  s_add_u32 s69, s58, 1856
  buffer_load_dwordx4 v4, s[36:39], s69 offen lds
  v_cvt_pk_bf16_f32 v150, v132, v133
  v_cvt_pk_bf16_f32 v151, v134, v135
  v_mfma_f32_32x32x16_bf16 v[120:135], v[184:187], v[16:19], 0
  v_exp_f32 v104, v104
  v_exp_f32 v105, v105
  v_exp_f32 v106, v106
  v_exp_f32 v107, v107
  v_mfma_f32_32x32x16_bf16 v[120:135], v[188:191], v[20:23], v[120:135]
  s_waitcnt lgkmcnt(0)
  s_add_u32 m0, s65, 4096
  s_add_u32 s60, s64, 1280
  buffer_load_dwordx4 v224, s[32:35], s60 offen lds
  v_exp_f32 v108, v108
  v_exp_f32 v109, v109
  v_exp_f32 v110, v110
  v_exp_f32 v111, v111
  v_cvt_pk_bf16_f32 v136, v104, v105
  v_cvt_pk_bf16_f32 v137, v106, v107
  v_mfma_f32_32x32x16_bf16 v[88:103], v[176:179], v[144:147], v[88:103]
  v_exp_f32 v112, v112
  v_exp_f32 v113, v113
  v_exp_f32 v114, v114
  v_exp_f32 v115, v115
  v_cvt_pk_bf16_f32 v138, v108, v109
  v_cvt_pk_bf16_f32 v139, v110, v111
  v_mfma_f32_32x32x16_bf16 v[88:103], v[180:183], v[148:151], v[88:103]
  v_exp_f32 v116, v116
  v_exp_f32 v117, v117
  v_exp_f32 v118, v118
  v_exp_f32 v119, v119
  v_cvt_pk_bf16_f32 v140, v112, v113
  v_cvt_pk_bf16_f32 v141, v114, v115
  v_cvt_pk_bf16_f32 v142, v116, v117
  v_cvt_pk_bf16_f32 v143, v118, v119
  v_mfma_f32_32x32x16_bf16 v[104:119], v[184:187], v[24:27], 0
  v_exp_f32 v120, v120
  v_exp_f32 v121, v121
  v_exp_f32 v122, v122
  v_exp_f32 v123, v123
  v_mfma_f32_32x32x16_bf16 v[104:119], v[188:191], v[28:31], v[104:119]
  s_add_u32 m0, s65, 5120
  s_add_u32 s60, s64, 66816
  buffer_load_dwordx4 v224, s[32:35], s60 offen lds
  s_waitcnt vmcnt(21)
  ds_read_b128 a[120:123], v226 offset:6144
  ds_read_b128 a[124:127], v227 offset:6144
  v_exp_f32 v124, v124
  v_exp_f32 v125, v125
  v_exp_f32 v126, v126
  v_exp_f32 v127, v127
  v_cvt_pk_bf16_f32 v144, v120, v121
  v_cvt_pk_bf16_f32 v145, v122, v123
  v_mfma_f32_32x32x16_bf16 v[40:55], v[192:195], v[136:139], v[40:55]
  v_exp_f32 v128, v128
  v_exp_f32 v129, v129
  v_exp_f32 v130, v130
  v_exp_f32 v131, v131
  v_cvt_pk_bf16_f32 v146, v124, v125
  v_cvt_pk_bf16_f32 v147, v126, v127
  v_mfma_f32_32x32x16_bf16 v[40:55], v[196:199], v[140:143], v[40:55]
  v_exp_f32 v132, v132
  v_exp_f32 v133, v133
  v_exp_f32 v134, v134
  v_exp_f32 v135, v135
  v_cvt_pk_bf16_f32 v148, v128, v129
  v_cvt_pk_bf16_f32 v149, v130, v131
  buffer_load_dwordx4 v[168:171], v1, s[28:31], s55 offen offset:0
  buffer_load_dwordx4 v[172:175], v1, s[28:31], s55 offen offset:1024
  v_cvt_pk_bf16_f32 v150, v132, v133
  v_cvt_pk_bf16_f32 v151, v134, v135
  v_mfma_f32_32x32x16_bf16 v[120:135], v[184:187], v[32:35], 0
  v_exp_f32 v104, v104
  v_exp_f32 v105, v105
  v_exp_f32 v106, v106
  v_exp_f32 v107, v107
  v_mfma_f32_32x32x16_bf16 v[120:135], v[188:191], v[36:39], v[120:135]
  s_waitcnt lgkmcnt(0)
  s_add_u32 m0, s65, 6144
  s_add_u32 s60, s64, 1344
  buffer_load_dwordx4 v224, s[32:35], s60 offen lds
  v_exp_f32 v108, v108
  v_exp_f32 v109, v109
  v_exp_f32 v110, v110
  v_exp_f32 v111, v111
  v_cvt_pk_bf16_f32 v136, v104, v105
  v_cvt_pk_bf16_f32 v137, v106, v107
  v_mfma_f32_32x32x16_bf16 v[56:71], v[192:195], v[144:147], v[56:71]
  v_exp_f32 v112, v112
  v_exp_f32 v113, v113
  v_exp_f32 v114, v114
  v_exp_f32 v115, v115
  v_cvt_pk_bf16_f32 v138, v108, v109
  v_cvt_pk_bf16_f32 v139, v110, v111
  v_mfma_f32_32x32x16_bf16 v[56:71], v[196:199], v[148:151], v[56:71]
  v_exp_f32 v116, v116
  v_exp_f32 v117, v117
  v_exp_f32 v118, v118
  v_exp_f32 v119, v119
  v_cvt_pk_bf16_f32 v140, v112, v113
  v_cvt_pk_bf16_f32 v141, v114, v115
  buffer_load_dwordx4 v[176:179], v1, s[28:31], s55 offen offset:2048
  buffer_load_dwordx4 v[180:183], v1, s[28:31], s55 offen offset:3072
  s_add_u32 s55, s55, 4096
  v_cvt_pk_bf16_f32 v142, v116, v117
  v_cvt_pk_bf16_f32 v143, v118, v119
  s_waitcnt vmcnt(18)
  v_mfma_f32_32x32x16_bf16 v[104:119], v[200:203], v[8:11], 0
  v_exp_f32 v120, v120
  v_exp_f32 v121, v121
  v_exp_f32 v122, v122
  v_exp_f32 v123, v123
  v_mfma_f32_32x32x16_bf16 v[104:119], v[204:207], v[12:15], v[104:119]
  s_add_u32 m0, s65, 7168
  s_add_u32 s60, s64, 66880
  buffer_load_dwordx4 v224, s[32:35], s60 offen lds
  ds_read_b128 a[128:131], v226 offset:8192
  ds_read_b128 a[132:135], v227 offset:8192
  v_exp_f32 v124, v124
  v_exp_f32 v125, v125
  v_exp_f32 v126, v126
  v_exp_f32 v127, v127
  v_cvt_pk_bf16_f32 v144, v120, v121
  v_cvt_pk_bf16_f32 v145, v122, v123
  v_mfma_f32_32x32x16_bf16 v[72:87], v[192:195], v[136:139], v[72:87]
  v_exp_f32 v128, v128
  v_exp_f32 v129, v129
  v_exp_f32 v130, v130
  v_exp_f32 v131, v131
  v_cvt_pk_bf16_f32 v146, v124, v125
  v_cvt_pk_bf16_f32 v147, v126, v127
  v_mfma_f32_32x32x16_bf16 v[72:87], v[196:199], v[140:143], v[72:87]
  v_exp_f32 v132, v132
  v_exp_f32 v133, v133
  v_exp_f32 v134, v134
  v_exp_f32 v135, v135
  v_cvt_pk_bf16_f32 v148, v128, v129
  v_cvt_pk_bf16_f32 v149, v130, v131
  s_add_u32 m0, s66, 2048
  s_add_u32 s69, s58, 0
  buffer_load_dwordx4 v4, s[36:39], s69 offen lds
  v_cvt_pk_bf16_f32 v150, v132, v133
  v_cvt_pk_bf16_f32 v151, v134, v135
  v_mfma_f32_32x32x16_bf16 v[120:135], v[200:203], v[16:19], 0
  v_exp_f32 v104, v104
  v_exp_f32 v105, v105
  v_exp_f32 v106, v106
  v_exp_f32 v107, v107
  v_mfma_f32_32x32x16_bf16 v[120:135], v[204:207], v[20:23], v[120:135]
  s_waitcnt lgkmcnt(0)
  s_add_u32 m0, s65, 8192
  s_add_u32 s60, s64, 1408
  buffer_load_dwordx4 v224, s[32:35], s60 offen lds
  v_exp_f32 v108, v108
  v_exp_f32 v109, v109
  v_exp_f32 v110, v110
  v_exp_f32 v111, v111
  v_cvt_pk_bf16_f32 v136, v104, v105
  v_cvt_pk_bf16_f32 v137, v106, v107
  v_mfma_f32_32x32x16_bf16 v[88:103], v[192:195], v[144:147], v[88:103]
  v_exp_f32 v112, v112
  v_exp_f32 v113, v113
  v_exp_f32 v114, v114
  v_exp_f32 v115, v115
  v_cvt_pk_bf16_f32 v138, v108, v109
  v_cvt_pk_bf16_f32 v139, v110, v111
  v_mfma_f32_32x32x16_bf16 v[88:103], v[196:199], v[148:151], v[88:103]
  v_exp_f32 v116, v116
  v_exp_f32 v117, v117
  v_exp_f32 v118, v118
  v_exp_f32 v119, v119
  v_cvt_pk_bf16_f32 v140, v112, v113
  v_cvt_pk_bf16_f32 v141, v114, v115
  v_cvt_pk_bf16_f32 v142, v116, v117
  v_cvt_pk_bf16_f32 v143, v118, v119
  v_mfma_f32_32x32x16_bf16 v[104:119], v[200:203], v[24:27], 0
  v_exp_f32 v120, v120
  v_exp_f32 v121, v121
  v_exp_f32 v122, v122
  v_exp_f32 v123, v123
  v_mfma_f32_32x32x16_bf16 v[104:119], v[204:207], v[28:31], v[104:119]
  s_add_u32 m0, s65, 9216
  s_add_u32 s60, s64, 66944
  buffer_load_dwordx4 v224, s[32:35], s60 offen lds
  s_waitcnt vmcnt(21)
  ds_read_b128 a[136:139], v226 offset:10240
  ds_read_b128 a[140:143], v227 offset:10240
  v_exp_f32 v124, v124
  v_exp_f32 v125, v125
  v_exp_f32 v126, v126
  v_exp_f32 v127, v127
  v_cvt_pk_bf16_f32 v144, v120, v121
  v_cvt_pk_bf16_f32 v145, v122, v123
  v_mfma_f32_32x32x16_bf16 v[40:55], v[208:211], v[136:139], v[40:55]
  v_exp_f32 v128, v128
  v_exp_f32 v129, v129
  v_exp_f32 v130, v130
  v_exp_f32 v131, v131
  v_cvt_pk_bf16_f32 v146, v124, v125
  v_cvt_pk_bf16_f32 v147, v126, v127
  v_mfma_f32_32x32x16_bf16 v[40:55], v[212:215], v[140:143], v[40:55]
  v_exp_f32 v132, v132
  v_exp_f32 v133, v133
  v_exp_f32 v134, v134
  v_exp_f32 v135, v135
  v_cvt_pk_bf16_f32 v148, v128, v129
  v_cvt_pk_bf16_f32 v149, v130, v131
  buffer_load_dwordx4 v[184:187], v1, s[28:31], s55 offen offset:0
  buffer_load_dwordx4 v[188:191], v1, s[28:31], s55 offen offset:1024
  v_cvt_pk_bf16_f32 v150, v132, v133
  v_cvt_pk_bf16_f32 v151, v134, v135
  v_mfma_f32_32x32x16_bf16 v[120:135], v[200:203], v[32:35], 0
  v_exp_f32 v104, v104
  v_exp_f32 v105, v105
  v_exp_f32 v106, v106
  v_exp_f32 v107, v107
  v_mfma_f32_32x32x16_bf16 v[120:135], v[204:207], v[36:39], v[120:135]
  s_waitcnt lgkmcnt(0)
  s_add_u32 m0, s65, 10240
  s_add_u32 s60, s64, 1472
  buffer_load_dwordx4 v224, s[32:35], s60 offen lds
  v_exp_f32 v108, v108
  v_exp_f32 v109, v109
  v_exp_f32 v110, v110
  v_exp_f32 v111, v111
  v_cvt_pk_bf16_f32 v136, v104, v105
  v_cvt_pk_bf16_f32 v137, v106, v107
  v_mfma_f32_32x32x16_bf16 v[56:71], v[208:211], v[144:147], v[56:71]
  v_exp_f32 v112, v112
  v_exp_f32 v113, v113
  v_exp_f32 v114, v114
  v_exp_f32 v115, v115
  v_cvt_pk_bf16_f32 v138, v108, v109
  v_cvt_pk_bf16_f32 v139, v110, v111
  v_mfma_f32_32x32x16_bf16 v[56:71], v[212:215], v[148:151], v[56:71]
  v_exp_f32 v116, v116
  v_exp_f32 v117, v117
  v_exp_f32 v118, v118
  v_exp_f32 v119, v119
  v_cvt_pk_bf16_f32 v140, v112, v113
  v_cvt_pk_bf16_f32 v141, v114, v115
  buffer_load_dwordx4 v[192:195], v1, s[28:31], s55 offen offset:2048
  buffer_load_dwordx4 v[196:199], v1, s[28:31], s55 offen offset:3072
  s_add_u32 s55, s55, 4096
  v_cvt_pk_bf16_f32 v142, v116, v117
  v_cvt_pk_bf16_f32 v143, v118, v119
  s_waitcnt vmcnt(18)
  v_mfma_f32_32x32x16_bf16 v[104:119], v[152:155], v[8:11], 0
  v_exp_f32 v120, v120
  v_exp_f32 v121, v121
  v_exp_f32 v122, v122
  v_exp_f32 v123, v123
  v_mfma_f32_32x32x16_bf16 v[104:119], v[156:159], v[12:15], v[104:119]
  s_add_u32 m0, s65, 11264
  s_add_u32 s60, s64, 67008
  buffer_load_dwordx4 v224, s[32:35], s60 offen lds
  ds_read_b128 a[144:147], v226 offset:0
  ds_read_b128 a[148:151], v227 offset:0
  v_exp_f32 v124, v124
  v_exp_f32 v125, v125
  v_exp_f32 v126, v126
  v_exp_f32 v127, v127
  v_cvt_pk_bf16_f32 v144, v120, v121
  v_cvt_pk_bf16_f32 v145, v122, v123
  v_mfma_f32_32x32x16_bf16 v[72:87], v[208:211], v[136:139], v[72:87]
  v_exp_f32 v128, v128
  v_exp_f32 v129, v129
  v_exp_f32 v130, v130
  v_exp_f32 v131, v131
  v_cvt_pk_bf16_f32 v146, v124, v125
  v_cvt_pk_bf16_f32 v147, v126, v127
  v_mfma_f32_32x32x16_bf16 v[72:87], v[212:215], v[140:143], v[72:87]
  v_exp_f32 v132, v132
  v_exp_f32 v133, v133
  v_exp_f32 v134, v134
  v_exp_f32 v135, v135
  v_cvt_pk_bf16_f32 v148, v128, v129
  v_cvt_pk_bf16_f32 v149, v130, v131
  s_add_u32 m0, s66, 3072
  s_add_u32 s69, s58, 64
  buffer_load_dwordx4 v4, s[36:39], s69 offen lds
  s_add_u32 s58, s58, 229376
  s_add_u32 s66, s66, 16384
  v_cvt_pk_bf16_f32 v150, v132, v133
  v_cvt_pk_bf16_f32 v151, v134, v135
  v_mfma_f32_32x32x16_bf16 v[120:135], v[152:155], v[16:19], 0
  v_exp_f32 v104, v104
  v_exp_f32 v105, v105
  v_exp_f32 v106, v106
  v_exp_f32 v107, v107
  v_mfma_f32_32x32x16_bf16 v[120:135], v[156:159], v[20:23], v[120:135]
  s_waitcnt lgkmcnt(0)
  s_add_u32 m0, s65, 0
  s_add_u32 s60, s64, 1536
  buffer_load_dwordx4 v224, s[32:35], s60 offen lds
  v_exp_f32 v108, v108
  v_exp_f32 v109, v109
  v_exp_f32 v110, v110
  v_exp_f32 v111, v111
  v_cvt_pk_bf16_f32 v136, v104, v105
  v_cvt_pk_bf16_f32 v137, v106, v107
  v_mfma_f32_32x32x16_bf16 v[88:103], v[208:211], v[144:147], v[88:103]
  v_exp_f32 v112, v112
  v_exp_f32 v113, v113
  v_exp_f32 v114, v114
  v_exp_f32 v115, v115
  v_cvt_pk_bf16_f32 v138, v108, v109
  v_cvt_pk_bf16_f32 v139, v110, v111
  v_mfma_f32_32x32x16_bf16 v[88:103], v[212:215], v[148:151], v[88:103]
  v_exp_f32 v116, v116
  v_exp_f32 v117, v117
  v_exp_f32 v118, v118
  v_exp_f32 v119, v119
  v_cvt_pk_bf16_f32 v140, v112, v113
  v_cvt_pk_bf16_f32 v141, v114, v115
  v_cvt_pk_bf16_f32 v142, v116, v117
  v_cvt_pk_bf16_f32 v143, v118, v119
  v_mfma_f32_32x32x16_bf16 v[104:119], v[152:155], v[24:27], 0
  v_exp_f32 v120, v120
  v_exp_f32 v121, v121
  v_exp_f32 v122, v122
  v_exp_f32 v123, v123
  v_mfma_f32_32x32x16_bf16 v[104:119], v[156:159], v[28:31], v[104:119]
  s_add_u32 m0, s65, 1024
  s_add_u32 s60, s64, 67072
  buffer_load_dwordx4 v224, s[32:35], s60 offen lds
  s_waitcnt vmcnt(21)
  ds_read_b128 a[152:155], v226 offset:2048
  ds_read_b128 a[156:159], v227 offset:2048
  v_exp_f32 v124, v124
  v_exp_f32 v125, v125
  v_exp_f32 v126, v126
  v_exp_f32 v127, v127
  v_cvt_pk_bf16_f32 v144, v120, v121
  v_cvt_pk_bf16_f32 v145, v122, v123
  v_mfma_f32_32x32x16_bf16 v[40:55], v[160:163], v[136:139], v[40:55]
  v_exp_f32 v128, v128
  v_exp_f32 v129, v129
  v_exp_f32 v130, v130
  v_exp_f32 v131, v131
  v_cvt_pk_bf16_f32 v146, v124, v125
  v_cvt_pk_bf16_f32 v147, v126, v127
  v_mfma_f32_32x32x16_bf16 v[40:55], v[164:167], v[140:143], v[40:55]
  v_exp_f32 v132, v132
  v_exp_f32 v133, v133
  v_exp_f32 v134, v134
  v_exp_f32 v135, v135
  v_cvt_pk_bf16_f32 v148, v128, v129
  v_cvt_pk_bf16_f32 v149, v130, v131
  buffer_load_dwordx4 v[200:203], v1, s[28:31], s55 offen offset:0
  buffer_load_dwordx4 v[204:207], v1, s[28:31], s55 offen offset:1024
  v_cvt_pk_bf16_f32 v150, v132, v133
  v_cvt_pk_bf16_f32 v151, v134, v135
  v_mfma_f32_32x32x16_bf16 v[120:135], v[152:155], v[32:35], 0
  v_exp_f32 v104, v104
  v_exp_f32 v105, v105
  v_exp_f32 v106, v106
  v_exp_f32 v107, v107
  v_mfma_f32_32x32x16_bf16 v[120:135], v[156:159], v[36:39], v[120:135]
  s_waitcnt lgkmcnt(0)
  s_add_u32 m0, s65, 2048
  s_add_u32 s60, s64, 1600
  buffer_load_dwordx4 v224, s[32:35], s60 offen lds
  v_exp_f32 v108, v108
  v_exp_f32 v109, v109
  v_exp_f32 v110, v110
  v_exp_f32 v111, v111
  v_cvt_pk_bf16_f32 v136, v104, v105
  v_cvt_pk_bf16_f32 v137, v106, v107
  v_mfma_f32_32x32x16_bf16 v[56:71], v[160:163], v[144:147], v[56:71]
  v_exp_f32 v112, v112
  v_exp_f32 v113, v113
  v_exp_f32 v114, v114
  v_exp_f32 v115, v115
  v_cvt_pk_bf16_f32 v138, v108, v109
  v_cvt_pk_bf16_f32 v139, v110, v111
  v_mfma_f32_32x32x16_bf16 v[56:71], v[164:167], v[148:151], v[56:71]
  v_exp_f32 v116, v116
  v_exp_f32 v117, v117
  v_exp_f32 v118, v118
  v_exp_f32 v119, v119
  v_cvt_pk_bf16_f32 v140, v112, v113
  v_cvt_pk_bf16_f32 v141, v114, v115
  buffer_load_dwordx4 v[208:211], v1, s[28:31], s55 offen offset:2048
  buffer_load_dwordx4 v[212:215], v1, s[28:31], s55 offen offset:3072
  s_add_u32 s55, s55, 4096
  v_cvt_pk_bf16_f32 v142, v116, v117
  v_cvt_pk_bf16_f32 v143, v118, v119
  s_waitcnt vmcnt(18)
  v_mfma_f32_32x32x16_bf16 v[104:119], v[168:171], v[8:11], 0
  v_exp_f32 v120, v120
  v_exp_f32 v121, v121
  v_exp_f32 v122, v122
  v_exp_f32 v123, v123
  v_mfma_f32_32x32x16_bf16 v[104:119], v[172:175], v[12:15], v[104:119]
  s_add_u32 m0, s65, 3072
  s_add_u32 s60, s64, 67136
  buffer_load_dwordx4 v224, s[32:35], s60 offen lds
  ds_read_b128 a[160:163], v226 offset:4096
  ds_read_b128 a[164:167], v227 offset:4096
  v_exp_f32 v124, v124
  v_exp_f32 v125, v125
  v_exp_f32 v126, v126
  v_exp_f32 v127, v127
  v_cvt_pk_bf16_f32 v144, v120, v121
  v_cvt_pk_bf16_f32 v145, v122, v123
  v_mfma_f32_32x32x16_bf16 v[72:87], v[160:163], v[136:139], v[72:87]
  v_exp_f32 v128, v128
  v_exp_f32 v129, v129
  v_exp_f32 v130, v130
  v_exp_f32 v131, v131
  v_cvt_pk_bf16_f32 v146, v124, v125
  v_cvt_pk_bf16_f32 v147, v126, v127
  v_mfma_f32_32x32x16_bf16 v[72:87], v[164:167], v[140:143], v[72:87]
  v_exp_f32 v132, v132
  v_exp_f32 v133, v133
  v_exp_f32 v134, v134
  v_exp_f32 v135, v135
  v_cvt_pk_bf16_f32 v148, v128, v129
  v_cvt_pk_bf16_f32 v149, v130, v131
  v_cvt_pk_bf16_f32 v150, v132, v133
  v_cvt_pk_bf16_f32 v151, v134, v135
  v_mfma_f32_32x32x16_bf16 v[120:135], v[168:171], v[16:19], 0
  v_exp_f32 v104, v104
  v_exp_f32 v105, v105
  v_exp_f32 v106, v106
  v_exp_f32 v107, v107
  v_mfma_f32_32x32x16_bf16 v[120:135], v[172:175], v[20:23], v[120:135]
  s_waitcnt lgkmcnt(0)
  s_add_u32 m0, s65, 4096
  s_add_u32 s60, s64, 1664
  buffer_load_dwordx4 v224, s[32:35], s60 offen lds
  v_exp_f32 v108, v108
  v_exp_f32 v109, v109
  v_exp_f32 v110, v110
  v_exp_f32 v111, v111
  v_cvt_pk_bf16_f32 v136, v104, v105
  v_cvt_pk_bf16_f32 v137, v106, v107
  v_mfma_f32_32x32x16_bf16 v[88:103], v[160:163], v[144:147], v[88:103]
  v_exp_f32 v112, v112
  v_exp_f32 v113, v113
  v_exp_f32 v114, v114
  v_exp_f32 v115, v115
  v_cvt_pk_bf16_f32 v138, v108, v109
  v_cvt_pk_bf16_f32 v139, v110, v111
  v_mfma_f32_32x32x16_bf16 v[88:103], v[164:167], v[148:151], v[88:103]
  v_exp_f32 v116, v116
  v_exp_f32 v117, v117
  v_exp_f32 v118, v118
  v_exp_f32 v119, v119
  v_cvt_pk_bf16_f32 v140, v112, v113
  v_cvt_pk_bf16_f32 v141, v114, v115
  v_cvt_pk_bf16_f32 v142, v116, v117
  v_cvt_pk_bf16_f32 v143, v118, v119
  v_mfma_f32_32x32x16_bf16 v[104:119], v[168:171], v[24:27], 0
  v_exp_f32 v120, v120
  v_exp_f32 v121, v121
  v_exp_f32 v122, v122
  v_exp_f32 v123, v123
  v_mfma_f32_32x32x16_bf16 v[104:119], v[172:175], v[28:31], v[104:119]
  s_add_u32 m0, s65, 5120
  s_add_u32 s60, s64, 67200
  buffer_load_dwordx4 v224, s[32:35], s60 offen lds
  s_waitcnt vmcnt(20)
  ds_read_b128 a[168:171], v226 offset:6144
  ds_read_b128 a[172:175], v227 offset:6144
  v_exp_f32 v124, v124
  v_exp_f32 v125, v125
  v_exp_f32 v126, v126
  v_exp_f32 v127, v127
  v_cvt_pk_bf16_f32 v144, v120, v121
  v_cvt_pk_bf16_f32 v145, v122, v123
  v_mfma_f32_32x32x16_bf16 v[40:55], v[176:179], v[136:139], v[40:55]
  v_exp_f32 v128, v128
  v_exp_f32 v129, v129
  v_exp_f32 v130, v130
  v_exp_f32 v131, v131
  v_cvt_pk_bf16_f32 v146, v124, v125
  v_cvt_pk_bf16_f32 v147, v126, v127
  v_mfma_f32_32x32x16_bf16 v[40:55], v[180:183], v[140:143], v[40:55]
  v_exp_f32 v132, v132
  v_exp_f32 v133, v133
  v_exp_f32 v134, v134
  v_exp_f32 v135, v135
  v_cvt_pk_bf16_f32 v148, v128, v129
  v_cvt_pk_bf16_f32 v149, v130, v131
  v_cvt_pk_bf16_f32 v150, v132, v133
  v_cvt_pk_bf16_f32 v151, v134, v135
  v_mfma_f32_32x32x16_bf16 v[120:135], v[168:171], v[32:35], 0
  v_exp_f32 v104, v104
  v_exp_f32 v105, v105
  v_exp_f32 v106, v106
  v_exp_f32 v107, v107
  v_mfma_f32_32x32x16_bf16 v[120:135], v[172:175], v[36:39], v[120:135]
  s_waitcnt lgkmcnt(0)
  s_add_u32 m0, s65, 6144
  s_add_u32 s60, s64, 1728
  buffer_load_dwordx4 v224, s[32:35], s60 offen lds
  v_exp_f32 v108, v108
  v_exp_f32 v109, v109
  v_exp_f32 v110, v110
  v_exp_f32 v111, v111
  v_cvt_pk_bf16_f32 v136, v104, v105
  v_cvt_pk_bf16_f32 v137, v106, v107
  v_mfma_f32_32x32x16_bf16 v[56:71], v[176:179], v[144:147], v[56:71]
  v_exp_f32 v112, v112
  v_exp_f32 v113, v113
  v_exp_f32 v114, v114
  v_exp_f32 v115, v115
  v_cvt_pk_bf16_f32 v138, v108, v109
  v_cvt_pk_bf16_f32 v139, v110, v111
  v_mfma_f32_32x32x16_bf16 v[56:71], v[180:183], v[148:151], v[56:71]
  v_exp_f32 v116, v116
  v_exp_f32 v117, v117
  v_exp_f32 v118, v118
  v_exp_f32 v119, v119
  v_cvt_pk_bf16_f32 v140, v112, v113
  v_cvt_pk_bf16_f32 v141, v114, v115
  v_cvt_pk_bf16_f32 v142, v116, v117
  v_cvt_pk_bf16_f32 v143, v118, v119
  s_waitcnt vmcnt(13)
  v_mfma_f32_32x32x16_bf16 v[104:119], v[184:187], v[8:11], 0
  v_exp_f32 v120, v120
  v_exp_f32 v121, v121
  v_exp_f32 v122, v122
  v_exp_f32 v123, v123
  v_mfma_f32_32x32x16_bf16 v[104:119], v[188:191], v[12:15], v[104:119]
  s_add_u32 m0, s65, 7168
  s_add_u32 s60, s64, 67264
  buffer_load_dwordx4 v224, s[32:35], s60 offen lds
  ds_read_b128 a[176:179], v226 offset:8192
  ds_read_b128 a[180:183], v227 offset:8192
  v_exp_f32 v124, v124
  v_exp_f32 v125, v125
  v_exp_f32 v126, v126
  v_exp_f32 v127, v127
  v_cvt_pk_bf16_f32 v144, v120, v121
  v_cvt_pk_bf16_f32 v145, v122, v123
  v_mfma_f32_32x32x16_bf16 v[72:87], v[176:179], v[136:139], v[72:87]
  v_exp_f32 v128, v128
  v_exp_f32 v129, v129
  v_exp_f32 v130, v130
  v_exp_f32 v131, v131
  v_cvt_pk_bf16_f32 v146, v124, v125
  v_cvt_pk_bf16_f32 v147, v126, v127
  v_mfma_f32_32x32x16_bf16 v[72:87], v[180:183], v[140:143], v[72:87]
  v_exp_f32 v132, v132
  v_exp_f32 v133, v133
  v_exp_f32 v134, v134
  v_exp_f32 v135, v135
  v_cvt_pk_bf16_f32 v148, v128, v129
  v_cvt_pk_bf16_f32 v149, v130, v131
  v_cvt_pk_bf16_f32 v150, v132, v133
  v_cvt_pk_bf16_f32 v151, v134, v135
  v_mfma_f32_32x32x16_bf16 v[120:135], v[184:187], v[16:19], 0
  v_exp_f32 v104, v104
  v_exp_f32 v105, v105
  v_exp_f32 v106, v106
  v_exp_f32 v107, v107
  v_mfma_f32_32x32x16_bf16 v[120:135], v[188:191], v[20:23], v[120:135]
  s_waitcnt lgkmcnt(0)
  s_add_u32 m0, s65, 8192
  s_add_u32 s60, s64, 1792
  buffer_load_dwordx4 v224, s[32:35], s60 offen lds
  v_exp_f32 v108, v108
  v_exp_f32 v109, v109
  v_exp_f32 v110, v110
  v_exp_f32 v111, v111
  v_cvt_pk_bf16_f32 v136, v104, v105
  v_cvt_pk_bf16_f32 v137, v106, v107
  v_mfma_f32_32x32x16_bf16 v[88:103], v[176:179], v[144:147], v[88:103]
  v_exp_f32 v112, v112
  v_exp_f32 v113, v113
  v_exp_f32 v114, v114
  v_exp_f32 v115, v115
  v_cvt_pk_bf16_f32 v138, v108, v109
  v_cvt_pk_bf16_f32 v139, v110, v111
  v_mfma_f32_32x32x16_bf16 v[88:103], v[180:183], v[148:151], v[88:103]
  v_exp_f32 v116, v116
  v_exp_f32 v117, v117
  v_exp_f32 v118, v118
  v_exp_f32 v119, v119
  v_cvt_pk_bf16_f32 v140, v112, v113
  v_cvt_pk_bf16_f32 v141, v114, v115
  v_cvt_pk_bf16_f32 v142, v116, v117
  v_cvt_pk_bf16_f32 v143, v118, v119
  v_mfma_f32_32x32x16_bf16 v[104:119], v[184:187], v[24:27], 0
  v_exp_f32 v120, v120
  v_exp_f32 v121, v121
  v_exp_f32 v122, v122
  v_exp_f32 v123, v123
  v_mfma_f32_32x32x16_bf16 v[104:119], v[188:191], v[28:31], v[104:119]
  s_add_u32 m0, s65, 9216
  s_add_u32 s60, s64, 67328
  buffer_load_dwordx4 v224, s[32:35], s60 offen lds
  s_waitcnt vmcnt(15)
  ds_read_b128 a[184:187], v226 offset:10240
  ds_read_b128 a[188:191], v227 offset:10240
  v_exp_f32 v124, v124
  v_exp_f32 v125, v125
  v_exp_f32 v126, v126
  v_exp_f32 v127, v127
  v_cvt_pk_bf16_f32 v144, v120, v121
  v_cvt_pk_bf16_f32 v145, v122, v123
  v_mfma_f32_32x32x16_bf16 v[40:55], v[192:195], v[136:139], v[40:55]
  v_exp_f32 v128, v128
  v_exp_f32 v129, v129
  v_exp_f32 v130, v130
  v_exp_f32 v131, v131
  v_cvt_pk_bf16_f32 v146, v124, v125
  v_cvt_pk_bf16_f32 v147, v126, v127
  v_mfma_f32_32x32x16_bf16 v[40:55], v[196:199], v[140:143], v[40:55]
  v_exp_f32 v132, v132
  v_exp_f32 v133, v133
  v_exp_f32 v134, v134
  v_exp_f32 v135, v135
  v_cvt_pk_bf16_f32 v148, v128, v129
  v_cvt_pk_bf16_f32 v149, v130, v131
  v_cvt_pk_bf16_f32 v150, v132, v133
  v_cvt_pk_bf16_f32 v151, v134, v135
  v_mfma_f32_32x32x16_bf16 v[120:135], v[184:187], v[32:35], 0
  v_exp_f32 v104, v104
  v_exp_f32 v105, v105
  v_exp_f32 v106, v106
  v_exp_f32 v107, v107
  v_mfma_f32_32x32x16_bf16 v[120:135], v[188:191], v[36:39], v[120:135]
  s_waitcnt lgkmcnt(0)
  s_add_u32 m0, s65, 10240
  s_add_u32 s60, s64, 1856
  buffer_load_dwordx4 v224, s[32:35], s60 offen lds
  v_exp_f32 v108, v108
  v_exp_f32 v109, v109
  v_exp_f32 v110, v110
  v_exp_f32 v111, v111
  v_cvt_pk_bf16_f32 v136, v104, v105
  v_cvt_pk_bf16_f32 v137, v106, v107
  v_mfma_f32_32x32x16_bf16 v[56:71], v[192:195], v[144:147], v[56:71]
  v_exp_f32 v112, v112
  v_exp_f32 v113, v113
  v_exp_f32 v114, v114
  v_exp_f32 v115, v115
  v_cvt_pk_bf16_f32 v138, v108, v109
  v_cvt_pk_bf16_f32 v139, v110, v111
  v_mfma_f32_32x32x16_bf16 v[56:71], v[196:199], v[148:151], v[56:71]
  v_exp_f32 v116, v116
  v_exp_f32 v117, v117
  v_exp_f32 v118, v118
  v_exp_f32 v119, v119
  v_cvt_pk_bf16_f32 v140, v112, v113
  v_cvt_pk_bf16_f32 v141, v114, v115
  v_cvt_pk_bf16_f32 v142, v116, v117
  v_cvt_pk_bf16_f32 v143, v118, v119
  s_waitcnt vmcnt(8)
  v_mfma_f32_32x32x16_bf16 v[104:119], v[200:203], v[8:11], 0
  v_exp_f32 v120, v120
  v_exp_f32 v121, v121
  v_exp_f32 v122, v122
  v_exp_f32 v123, v123
  v_mfma_f32_32x32x16_bf16 v[104:119], v[204:207], v[12:15], v[104:119]
  s_add_u32 m0, s65, 11264
  s_add_u32 s60, s64, 67392
  buffer_load_dwordx4 v224, s[32:35], s60 offen lds
  ds_read_b128 a[192:195], v226 offset:0
  ds_read_b128 a[196:199], v227 offset:0
  v_exp_f32 v124, v124
  v_exp_f32 v125, v125
  v_exp_f32 v126, v126
  v_exp_f32 v127, v127
  v_cvt_pk_bf16_f32 v144, v120, v121
  v_cvt_pk_bf16_f32 v145, v122, v123
  v_mfma_f32_32x32x16_bf16 v[72:87], v[192:195], v[136:139], v[72:87]
  v_exp_f32 v128, v128
  v_exp_f32 v129, v129
  v_exp_f32 v130, v130
  v_exp_f32 v131, v131
  v_cvt_pk_bf16_f32 v146, v124, v125
  v_cvt_pk_bf16_f32 v147, v126, v127
  v_mfma_f32_32x32x16_bf16 v[72:87], v[196:199], v[140:143], v[72:87]
  v_exp_f32 v132, v132
  v_exp_f32 v133, v133
  v_exp_f32 v134, v134
  v_exp_f32 v135, v135
  v_cvt_pk_bf16_f32 v148, v128, v129
  v_cvt_pk_bf16_f32 v149, v130, v131
  v_cvt_pk_bf16_f32 v150, v132, v133
  v_cvt_pk_bf16_f32 v151, v134, v135
  v_mfma_f32_32x32x16_bf16 v[120:135], v[200:203], v[16:19], 0
  v_exp_f32 v104, v104
  v_exp_f32 v105, v105
  v_exp_f32 v106, v106
  v_exp_f32 v107, v107
  v_mfma_f32_32x32x16_bf16 v[120:135], v[204:207], v[20:23], v[120:135]
  s_waitcnt lgkmcnt(0)
  s_add_u32 m0, s65, 0
  s_add_u32 s60, s64, 1920
  buffer_load_dwordx4 v224, s[32:35], s60 offen lds
  v_exp_f32 v108, v108
  v_exp_f32 v109, v109
  v_exp_f32 v110, v110
  v_exp_f32 v111, v111
  v_cvt_pk_bf16_f32 v136, v104, v105
  v_cvt_pk_bf16_f32 v137, v106, v107
  v_mfma_f32_32x32x16_bf16 v[88:103], v[192:195], v[144:147], v[88:103]
  v_exp_f32 v112, v112
  v_exp_f32 v113, v113
  v_exp_f32 v114, v114
  v_exp_f32 v115, v115
  v_cvt_pk_bf16_f32 v138, v108, v109
  v_cvt_pk_bf16_f32 v139, v110, v111
  v_mfma_f32_32x32x16_bf16 v[88:103], v[196:199], v[148:151], v[88:103]
  v_exp_f32 v116, v116
  v_exp_f32 v117, v117
  v_exp_f32 v118, v118
  v_exp_f32 v119, v119
  v_cvt_pk_bf16_f32 v140, v112, v113
  v_cvt_pk_bf16_f32 v141, v114, v115
  v_cvt_pk_bf16_f32 v142, v116, v117
  v_cvt_pk_bf16_f32 v143, v118, v119
  v_mfma_f32_32x32x16_bf16 v[104:119], v[200:203], v[24:27], 0
  v_exp_f32 v120, v120
  v_exp_f32 v121, v121
  v_exp_f32 v122, v122
  v_exp_f32 v123, v123
  v_mfma_f32_32x32x16_bf16 v[104:119], v[204:207], v[28:31], v[104:119]
  s_add_u32 m0, s65, 1024
  s_add_u32 s60, s64, 67456
  buffer_load_dwordx4 v224, s[32:35], s60 offen lds
  s_waitcnt vmcnt(10)
  ds_read_b128 a[200:203], v226 offset:2048
  ds_read_b128 a[204:207], v227 offset:2048
  v_exp_f32 v124, v124
  v_exp_f32 v125, v125
  v_exp_f32 v126, v126
  v_exp_f32 v127, v127
  v_cvt_pk_bf16_f32 v144, v120, v121
  v_cvt_pk_bf16_f32 v145, v122, v123
  v_mfma_f32_32x32x16_bf16 v[40:55], v[208:211], v[136:139], v[40:55]
  v_exp_f32 v128, v128
  v_exp_f32 v129, v129
  v_exp_f32 v130, v130
  v_exp_f32 v131, v131
  v_cvt_pk_bf16_f32 v146, v124, v125
  v_cvt_pk_bf16_f32 v147, v126, v127
  v_mfma_f32_32x32x16_bf16 v[40:55], v[212:215], v[140:143], v[40:55]
  v_exp_f32 v132, v132
  v_exp_f32 v133, v133
  v_exp_f32 v134, v134
  v_exp_f32 v135, v135
  v_cvt_pk_bf16_f32 v148, v128, v129
  v_cvt_pk_bf16_f32 v149, v130, v131
  v_cvt_pk_bf16_f32 v150, v132, v133
  v_cvt_pk_bf16_f32 v151, v134, v135
  v_mfma_f32_32x32x16_bf16 v[120:135], v[200:203], v[32:35], 0
  v_exp_f32 v104, v104
  v_exp_f32 v105, v105
  v_exp_f32 v106, v106
  v_exp_f32 v107, v107
  v_mfma_f32_32x32x16_bf16 v[120:135], v[204:207], v[36:39], v[120:135]
  s_waitcnt lgkmcnt(0)
  s_add_u32 m0, s65, 2048
  s_add_u32 s60, s64, 1984
  buffer_load_dwordx4 v224, s[32:35], s60 offen lds
  v_exp_f32 v108, v108
  v_exp_f32 v109, v109
  v_exp_f32 v110, v110
  v_exp_f32 v111, v111
  v_cvt_pk_bf16_f32 v136, v104, v105
  v_cvt_pk_bf16_f32 v137, v106, v107
  v_mfma_f32_32x32x16_bf16 v[56:71], v[208:211], v[144:147], v[56:71]
  v_exp_f32 v112, v112
  v_exp_f32 v113, v113
  v_exp_f32 v114, v114
  v_exp_f32 v115, v115
  v_cvt_pk_bf16_f32 v138, v108, v109
  v_cvt_pk_bf16_f32 v139, v110, v111
  v_mfma_f32_32x32x16_bf16 v[56:71], v[212:215], v[148:151], v[56:71]
  v_exp_f32 v116, v116
  v_exp_f32 v117, v117
  v_exp_f32 v118, v118
  v_exp_f32 v119, v119
  v_cvt_pk_bf16_f32 v140, v112, v113
  v_cvt_pk_bf16_f32 v141, v114, v115
  v_cvt_pk_bf16_f32 v142, v116, v117
  v_cvt_pk_bf16_f32 v143, v118, v119
  v_mfma_f32_32x32x16_bf16 v[104:119], v[152:155], v[8:11], 0
  v_exp_f32 v120, v120
  v_exp_f32 v121, v121
  v_exp_f32 v122, v122
  v_exp_f32 v123, v123
  v_mfma_f32_32x32x16_bf16 v[104:119], v[156:159], v[12:15], v[104:119]
  s_add_u32 m0, s65, 3072
  s_add_u32 s60, s64, 67520
  buffer_load_dwordx4 v224, s[32:35], s60 offen lds
  s_waitcnt vmcnt(10)
  ds_read_b128 a[208:211], v226 offset:4096
  ds_read_b128 a[212:215], v227 offset:4096
  v_exp_f32 v124, v124
  v_exp_f32 v125, v125
  v_exp_f32 v126, v126
  v_exp_f32 v127, v127
  v_cvt_pk_bf16_f32 v144, v120, v121
  v_cvt_pk_bf16_f32 v145, v122, v123
  v_mfma_f32_32x32x16_bf16 v[72:87], v[208:211], v[136:139], v[72:87]
  v_exp_f32 v128, v128
  v_exp_f32 v129, v129
  v_exp_f32 v130, v130
  v_exp_f32 v131, v131
  v_cvt_pk_bf16_f32 v146, v124, v125
  v_cvt_pk_bf16_f32 v147, v126, v127
  v_mfma_f32_32x32x16_bf16 v[72:87], v[212:215], v[140:143], v[72:87]
  v_exp_f32 v132, v132
  v_exp_f32 v133, v133
  v_exp_f32 v134, v134
  v_exp_f32 v135, v135
  v_cvt_pk_bf16_f32 v148, v128, v129
  v_cvt_pk_bf16_f32 v149, v130, v131
  v_cvt_pk_bf16_f32 v150, v132, v133
  v_cvt_pk_bf16_f32 v151, v134, v135
  s_waitcnt vmcnt(8)
  ds_read_b128 a[216:219], v226 offset:6144
  ds_read_b128 a[220:223], v227 offset:6144
  s_waitcnt vmcnt(6)
  ds_read_b128 a[224:227], v226 offset:8192
  ds_read_b128 a[228:231], v227 offset:8192
  s_waitcnt vmcnt(4)
  ds_read_b128 a[232:235], v226 offset:10240
  ds_read_b128 a[236:239], v227 offset:10240
  s_waitcnt vmcnt(2)
  ds_read_b128 a[240:243], v226 offset:0
  ds_read_b128 a[244:247], v227 offset:0
  s_waitcnt vmcnt(0)
  ds_read_b128 a[248:251], v226 offset:2048
  ds_read_b128 a[252:255], v227 offset:2048
  s_waitcnt lgkmcnt(0)
  s_barrier
  s_branch L_attnj_19
L_attn1_18:
  s_mov_b32 s56, 0
  s_nop 7
L_attn_20:
  v_mfma_f32_32x32x16_bf16 v[120:135], v[152:155], v[16:19], 0
  v_exp_f32 v104, v104
  v_exp_f32 v105, v105
  v_exp_f32 v106, v106
  v_exp_f32 v107, v107
  v_mfma_f32_32x32x16_bf16 v[120:135], v[156:159], v[20:23], v[120:135]
  v_exp_f32 v108, v108
  v_exp_f32 v109, v109
  v_exp_f32 v110, v110
  v_exp_f32 v111, v111
  v_cvt_pk_bf16_f32 v136, v104, v105
  v_cvt_pk_bf16_f32 v137, v106, v107
  v_mfma_f32_32x32x16_bf16 v[88:103], v[208:211], v[144:147], v[88:103]
  v_exp_f32 v112, v112
  v_exp_f32 v113, v113
  v_exp_f32 v114, v114
  v_exp_f32 v115, v115
  v_cvt_pk_bf16_f32 v138, v108, v109
  v_cvt_pk_bf16_f32 v139, v110, v111
  v_mfma_f32_32x32x16_bf16 v[88:103], v[212:215], v[148:151], v[88:103]
  v_exp_f32 v116, v116
  v_exp_f32 v117, v117
  v_exp_f32 v118, v118
  v_exp_f32 v119, v119
  v_cvt_pk_bf16_f32 v140, v112, v113
  v_cvt_pk_bf16_f32 v141, v114, v115
  s_add_u32 m0, s66, 0
  s_add_u32 s69, s58, 1792
  buffer_load_dwordx4 v4, s[36:39], s69 offen lds
  v_cvt_pk_bf16_f32 v142, v116, v117
  v_cvt_pk_bf16_f32 v143, v118, v119
  v_mfma_f32_32x32x16_bf16 v[104:119], v[152:155], v[24:27], 0
  v_exp_f32 v120, v120
  v_exp_f32 v121, v121
  v_exp_f32 v122, v122
  v_exp_f32 v123, v123
  v_mfma_f32_32x32x16_bf16 v[104:119], v[156:159], v[28:31], v[104:119]
  v_exp_f32 v124, v124
  v_exp_f32 v125, v125
  v_exp_f32 v126, v126
  v_exp_f32 v127, v127
  v_cvt_pk_bf16_f32 v144, v120, v121
  v_cvt_pk_bf16_f32 v145, v122, v123
  v_mfma_f32_32x32x16_bf16 v[40:55], v[160:163], v[136:139], v[40:55]
  v_exp_f32 v128, v128
  v_exp_f32 v129, v129
  v_exp_f32 v130, v130
  v_exp_f32 v131, v131
  v_cvt_pk_bf16_f32 v146, v124, v125
  v_cvt_pk_bf16_f32 v147, v126, v127
  v_mfma_f32_32x32x16_bf16 v[40:55], v[164:167], v[140:143], v[40:55]
  v_exp_f32 v132, v132
  v_exp_f32 v133, v133
  v_exp_f32 v134, v134
  v_exp_f32 v135, v135
  v_cvt_pk_bf16_f32 v148, v128, v129
  v_cvt_pk_bf16_f32 v149, v130, v131
  buffer_load_dwordx4 v[200:203], v1, s[28:31], s55 offen offset:0
  buffer_load_dwordx4 v[204:207], v1, s[28:31], s55 offen offset:1024
  v_cvt_pk_bf16_f32 v150, v132, v133
  v_cvt_pk_bf16_f32 v151, v134, v135
  v_mfma_f32_32x32x16_bf16 v[120:135], v[152:155], v[32:35], 0
  v_exp_f32 v104, v104
  v_exp_f32 v105, v105
  v_exp_f32 v106, v106
  v_exp_f32 v107, v107
  v_mfma_f32_32x32x16_bf16 v[120:135], v[156:159], v[36:39], v[120:135]
  v_exp_f32 v108, v108
  v_exp_f32 v109, v109
  v_exp_f32 v110, v110
  v_exp_f32 v111, v111
  v_cvt_pk_bf16_f32 v136, v104, v105
  v_cvt_pk_bf16_f32 v137, v106, v107
  v_mfma_f32_32x32x16_bf16 v[56:71], v[160:163], v[144:147], v[56:71]
  v_exp_f32 v112, v112
  v_exp_f32 v113, v113
  v_exp_f32 v114, v114
  v_exp_f32 v115, v115
  v_cvt_pk_bf16_f32 v138, v108, v109
  v_cvt_pk_bf16_f32 v139, v110, v111
  v_mfma_f32_32x32x16_bf16 v[56:71], v[164:167], v[148:151], v[56:71]
  v_exp_f32 v116, v116
  v_exp_f32 v117, v117
  v_exp_f32 v118, v118
  v_exp_f32 v119, v119
  v_cvt_pk_bf16_f32 v140, v112, v113
  v_cvt_pk_bf16_f32 v141, v114, v115
  buffer_load_dwordx4 v[208:211], v1, s[28:31], s55 offen offset:2048
  buffer_load_dwordx4 v[212:215], v1, s[28:31], s55 offen offset:3072
  s_add_u32 s55, s55, 4096
  s_min_u32 s55, s55, s67
  v_cvt_pk_bf16_f32 v142, v116, v117
  v_cvt_pk_bf16_f32 v143, v118, v119
  s_waitcnt vmcnt(9)
  v_mfma_f32_32x32x16_bf16 v[104:119], v[168:171], v[8:11], 0
  v_exp_f32 v120, v120
  v_exp_f32 v121, v121
  v_exp_f32 v122, v122
  v_exp_f32 v123, v123
  v_mfma_f32_32x32x16_bf16 v[104:119], v[172:175], v[12:15], v[104:119]
  v_exp_f32 v124, v124
  v_exp_f32 v125, v125
  v_exp_f32 v126, v126
  v_exp_f32 v127, v127
  v_cvt_pk_bf16_f32 v144, v120, v121
  v_cvt_pk_bf16_f32 v145, v122, v123
  v_mfma_f32_32x32x16_bf16 v[72:87], v[160:163], v[136:139], v[72:87]
  v_exp_f32 v128, v128
  v_exp_f32 v129, v129
  v_exp_f32 v130, v130
  v_exp_f32 v131, v131
  v_cvt_pk_bf16_f32 v146, v124, v125
  v_cvt_pk_bf16_f32 v147, v126, v127
  v_mfma_f32_32x32x16_bf16 v[72:87], v[164:167], v[140:143], v[72:87]
  v_exp_f32 v132, v132
  v_exp_f32 v133, v133
  v_exp_f32 v134, v134
  v_exp_f32 v135, v135
  v_cvt_pk_bf16_f32 v148, v128, v129
  v_cvt_pk_bf16_f32 v149, v130, v131
  v_cvt_pk_bf16_f32 v150, v132, v133
  v_cvt_pk_bf16_f32 v151, v134, v135
  v_mfma_f32_32x32x16_bf16 v[120:135], v[168:171], v[16:19], 0
  v_exp_f32 v104, v104
  v_exp_f32 v105, v105
  v_exp_f32 v106, v106
  v_exp_f32 v107, v107
  v_mfma_f32_32x32x16_bf16 v[120:135], v[172:175], v[20:23], v[120:135]
  v_exp_f32 v108, v108
  v_exp_f32 v109, v109
  v_exp_f32 v110, v110
  v_exp_f32 v111, v111
  v_cvt_pk_bf16_f32 v136, v104, v105
  v_cvt_pk_bf16_f32 v137, v106, v107
  v_mfma_f32_32x32x16_bf16 v[88:103], v[160:163], v[144:147], v[88:103]
  v_exp_f32 v112, v112
  v_exp_f32 v113, v113
  v_exp_f32 v114, v114
  v_exp_f32 v115, v115
  v_cvt_pk_bf16_f32 v138, v108, v109
  v_cvt_pk_bf16_f32 v139, v110, v111
  v_mfma_f32_32x32x16_bf16 v[88:103], v[164:167], v[148:151], v[88:103]
  v_exp_f32 v116, v116
  v_exp_f32 v117, v117
  v_exp_f32 v118, v118
  v_exp_f32 v119, v119
  v_cvt_pk_bf16_f32 v140, v112, v113
  v_cvt_pk_bf16_f32 v141, v114, v115
  s_add_u32 m0, s66, 1024
  s_add_u32 s69, s58, 1856
  buffer_load_dwordx4 v4, s[36:39], s69 offen lds
  v_cvt_pk_bf16_f32 v142, v116, v117
  v_cvt_pk_bf16_f32 v143, v118, v119
  v_mfma_f32_32x32x16_bf16 v[104:119], v[168:171], v[24:27], 0
  v_exp_f32 v120, v120
  v_exp_f32 v121, v121
  v_exp_f32 v122, v122
  v_exp_f32 v123, v123
  v_mfma_f32_32x32x16_bf16 v[104:119], v[172:175], v[28:31], v[104:119]
  v_exp_f32 v124, v124
  v_exp_f32 v125, v125
  v_exp_f32 v126, v126
  v_exp_f32 v127, v127
  v_cvt_pk_bf16_f32 v144, v120, v121
  v_cvt_pk_bf16_f32 v145, v122, v123
  v_mfma_f32_32x32x16_bf16 v[40:55], v[176:179], v[136:139], v[40:55]
  v_exp_f32 v128, v128
  v_exp_f32 v129, v129
  v_exp_f32 v130, v130
  v_exp_f32 v131, v131
  v_cvt_pk_bf16_f32 v146, v124, v125
  v_cvt_pk_bf16_f32 v147, v126, v127
  v_mfma_f32_32x32x16_bf16 v[40:55], v[180:183], v[140:143], v[40:55]
  v_exp_f32 v132, v132
  v_exp_f32 v133, v133
  v_exp_f32 v134, v134
  v_exp_f32 v135, v135
  v_cvt_pk_bf16_f32 v148, v128, v129
  v_cvt_pk_bf16_f32 v149, v130, v131
  buffer_load_dwordx4 v[152:155], v1, s[28:31], s55 offen offset:0
  buffer_load_dwordx4 v[156:159], v1, s[28:31], s55 offen offset:1024
  v_cvt_pk_bf16_f32 v150, v132, v133
  v_cvt_pk_bf16_f32 v151, v134, v135
  v_mfma_f32_32x32x16_bf16 v[120:135], v[168:171], v[32:35], 0
  v_exp_f32 v104, v104
  v_exp_f32 v105, v105
  v_exp_f32 v106, v106
  v_exp_f32 v107, v107
  v_mfma_f32_32x32x16_bf16 v[120:135], v[172:175], v[36:39], v[120:135]
  v_exp_f32 v108, v108
  v_exp_f32 v109, v109
  v_exp_f32 v110, v110
  v_exp_f32 v111, v111
  v_cvt_pk_bf16_f32 v136, v104, v105
  v_cvt_pk_bf16_f32 v137, v106, v107
  v_mfma_f32_32x32x16_bf16 v[56:71], v[176:179], v[144:147], v[56:71]
  v_exp_f32 v112, v112
  v_exp_f32 v113, v113
  v_exp_f32 v114, v114
  v_exp_f32 v115, v115
  v_cvt_pk_bf16_f32 v138, v108, v109
  v_cvt_pk_bf16_f32 v139, v110, v111
  v_mfma_f32_32x32x16_bf16 v[56:71], v[180:183], v[148:151], v[56:71]
  v_exp_f32 v116, v116
  v_exp_f32 v117, v117
  v_exp_f32 v118, v118
  v_exp_f32 v119, v119
  v_cvt_pk_bf16_f32 v140, v112, v113
  v_cvt_pk_bf16_f32 v141, v114, v115
  buffer_load_dwordx4 v[160:163], v1, s[28:31], s55 offen offset:2048
  buffer_load_dwordx4 v[164:167], v1, s[28:31], s55 offen offset:3072
  s_add_u32 s55, s55, 4096
  s_min_u32 s55, s55, s67
  v_cvt_pk_bf16_f32 v142, v116, v117
  v_cvt_pk_bf16_f32 v143, v118, v119
  s_waitcnt vmcnt(10)
  v_mfma_f32_32x32x16_bf16 v[104:119], v[184:187], v[8:11], 0
  v_exp_f32 v120, v120
  v_exp_f32 v121, v121
  v_exp_f32 v122, v122
  v_exp_f32 v123, v123
  v_mfma_f32_32x32x16_bf16 v[104:119], v[188:191], v[12:15], v[104:119]
  v_exp_f32 v124, v124
  v_exp_f32 v125, v125
  v_exp_f32 v126, v126
  v_exp_f32 v127, v127
  v_cvt_pk_bf16_f32 v144, v120, v121
  v_cvt_pk_bf16_f32 v145, v122, v123
  v_mfma_f32_32x32x16_bf16 v[72:87], v[176:179], v[136:139], v[72:87]
  v_exp_f32 v128, v128
  v_exp_f32 v129, v129
  v_exp_f32 v130, v130
  v_exp_f32 v131, v131
  v_cvt_pk_bf16_f32 v146, v124, v125
  v_cvt_pk_bf16_f32 v147, v126, v127
  v_mfma_f32_32x32x16_bf16 v[72:87], v[180:183], v[140:143], v[72:87]
  v_exp_f32 v132, v132
  v_exp_f32 v133, v133
  v_exp_f32 v134, v134
  v_exp_f32 v135, v135
  v_cvt_pk_bf16_f32 v148, v128, v129
  v_cvt_pk_bf16_f32 v149, v130, v131
  v_cvt_pk_bf16_f32 v150, v132, v133
  v_cvt_pk_bf16_f32 v151, v134, v135
  v_mfma_f32_32x32x16_bf16 v[120:135], v[184:187], v[16:19], 0
  v_exp_f32 v104, v104
  v_exp_f32 v105, v105
  v_exp_f32 v106, v106
  v_exp_f32 v107, v107
  v_mfma_f32_32x32x16_bf16 v[120:135], v[188:191], v[20:23], v[120:135]
  v_exp_f32 v108, v108
  v_exp_f32 v109, v109
  v_exp_f32 v110, v110
  v_exp_f32 v111, v111
  v_cvt_pk_bf16_f32 v136, v104, v105
  v_cvt_pk_bf16_f32 v137, v106, v107
  v_mfma_f32_32x32x16_bf16 v[88:103], v[176:179], v[144:147], v[88:103]
  v_exp_f32 v112, v112
  v_exp_f32 v113, v113
  v_exp_f32 v114, v114
  v_exp_f32 v115, v115
  v_cvt_pk_bf16_f32 v138, v108, v109
  v_cvt_pk_bf16_f32 v139, v110, v111
  v_mfma_f32_32x32x16_bf16 v[88:103], v[180:183], v[148:151], v[88:103]
  v_exp_f32 v116, v116
  v_exp_f32 v117, v117
  v_exp_f32 v118, v118
  v_exp_f32 v119, v119
  v_cvt_pk_bf16_f32 v140, v112, v113
  v_cvt_pk_bf16_f32 v141, v114, v115
  s_add_u32 m0, s66, 2048
  s_add_u32 s69, s58, 0
  buffer_load_dwordx4 v4, s[36:39], s69 offen lds
  v_cvt_pk_bf16_f32 v142, v116, v117
  v_cvt_pk_bf16_f32 v143, v118, v119
  v_mfma_f32_32x32x16_bf16 v[104:119], v[184:187], v[24:27], 0
  v_exp_f32 v120, v120
  v_exp_f32 v121, v121
  v_exp_f32 v122, v122
  v_exp_f32 v123, v123
  v_mfma_f32_32x32x16_bf16 v[104:119], v[188:191], v[28:31], v[104:119]
  v_exp_f32 v124, v124
  v_exp_f32 v125, v125
  v_exp_f32 v126, v126
  v_exp_f32 v127, v127
  v_cvt_pk_bf16_f32 v144, v120, v121
  v_cvt_pk_bf16_f32 v145, v122, v123
  v_mfma_f32_32x32x16_bf16 v[40:55], v[192:195], v[136:139], v[40:55]
  v_exp_f32 v128, v128
  v_exp_f32 v129, v129
  v_exp_f32 v130, v130
  v_exp_f32 v131, v131
  v_cvt_pk_bf16_f32 v146, v124, v125
  v_cvt_pk_bf16_f32 v147, v126, v127
  v_mfma_f32_32x32x16_bf16 v[40:55], v[196:199], v[140:143], v[40:55]
  v_exp_f32 v132, v132
  v_exp_f32 v133, v133
  v_exp_f32 v134, v134
  v_exp_f32 v135, v135
  v_cvt_pk_bf16_f32 v148, v128, v129
  v_cvt_pk_bf16_f32 v149, v130, v131
  buffer_load_dwordx4 v[168:171], v1, s[28:31], s55 offen offset:0
  buffer_load_dwordx4 v[172:175], v1, s[28:31], s55 offen offset:1024
  v_cvt_pk_bf16_f32 v150, v132, v133
  v_cvt_pk_bf16_f32 v151, v134, v135
  v_mfma_f32_32x32x16_bf16 v[120:135], v[184:187], v[32:35], 0
  v_exp_f32 v104, v104
  v_exp_f32 v105, v105
  v_exp_f32 v106, v106
  v_exp_f32 v107, v107
  v_mfma_f32_32x32x16_bf16 v[120:135], v[188:191], v[36:39], v[120:135]
  v_exp_f32 v108, v108
  v_exp_f32 v109, v109
  v_exp_f32 v110, v110
  v_exp_f32 v111, v111
  v_cvt_pk_bf16_f32 v136, v104, v105
  v_cvt_pk_bf16_f32 v137, v106, v107
  v_mfma_f32_32x32x16_bf16 v[56:71], v[192:195], v[144:147], v[56:71]
  v_exp_f32 v112, v112
  v_exp_f32 v113, v113
  v_exp_f32 v114, v114
  v_exp_f32 v115, v115
  v_cvt_pk_bf16_f32 v138, v108, v109
  v_cvt_pk_bf16_f32 v139, v110, v111
  v_mfma_f32_32x32x16_bf16 v[56:71], v[196:199], v[148:151], v[56:71]
  v_exp_f32 v116, v116
  v_exp_f32 v117, v117
  v_exp_f32 v118, v118
  v_exp_f32 v119, v119
  v_cvt_pk_bf16_f32 v140, v112, v113
  v_cvt_pk_bf16_f32 v141, v114, v115
  buffer_load_dwordx4 v[176:179], v1, s[28:31], s55 offen offset:2048
  buffer_load_dwordx4 v[180:183], v1, s[28:31], s55 offen offset:3072
  s_add_u32 s55, s55, 4096
  s_min_u32 s55, s55, s67
  v_cvt_pk_bf16_f32 v142, v116, v117
  v_cvt_pk_bf16_f32 v143, v118, v119
  s_waitcnt vmcnt(10)
  v_mfma_f32_32x32x16_bf16 v[104:119], v[200:203], v[8:11], 0
  v_exp_f32 v120, v120
  v_exp_f32 v121, v121
  v_exp_f32 v122, v122
  v_exp_f32 v123, v123
  v_mfma_f32_32x32x16_bf16 v[104:119], v[204:207], v[12:15], v[104:119]
  v_exp_f32 v124, v124
  v_exp_f32 v125, v125
  v_exp_f32 v126, v126
  v_exp_f32 v127, v127
  v_cvt_pk_bf16_f32 v144, v120, v121
  v_cvt_pk_bf16_f32 v145, v122, v123
  v_mfma_f32_32x32x16_bf16 v[72:87], v[192:195], v[136:139], v[72:87]
  v_exp_f32 v128, v128
  v_exp_f32 v129, v129
  v_exp_f32 v130, v130
  v_exp_f32 v131, v131
  v_cvt_pk_bf16_f32 v146, v124, v125
  v_cvt_pk_bf16_f32 v147, v126, v127
  v_mfma_f32_32x32x16_bf16 v[72:87], v[196:199], v[140:143], v[72:87]
  v_exp_f32 v132, v132
  v_exp_f32 v133, v133
  v_exp_f32 v134, v134
  v_exp_f32 v135, v135
  v_cvt_pk_bf16_f32 v148, v128, v129
  v_cvt_pk_bf16_f32 v149, v130, v131
  v_cvt_pk_bf16_f32 v150, v132, v133
  v_cvt_pk_bf16_f32 v151, v134, v135
  v_mfma_f32_32x32x16_bf16 v[120:135], v[200:203], v[16:19], 0
  v_exp_f32 v104, v104
  v_exp_f32 v105, v105
  v_exp_f32 v106, v106
  v_exp_f32 v107, v107
  v_mfma_f32_32x32x16_bf16 v[120:135], v[204:207], v[20:23], v[120:135]
  v_exp_f32 v108, v108
  v_exp_f32 v109, v109
  v_exp_f32 v110, v110
  v_exp_f32 v111, v111
  v_cvt_pk_bf16_f32 v136, v104, v105
  v_cvt_pk_bf16_f32 v137, v106, v107
  v_mfma_f32_32x32x16_bf16 v[88:103], v[192:195], v[144:147], v[88:103]
  v_exp_f32 v112, v112
  v_exp_f32 v113, v113
  v_exp_f32 v114, v114
  v_exp_f32 v115, v115
  v_cvt_pk_bf16_f32 v138, v108, v109
  v_cvt_pk_bf16_f32 v139, v110, v111
  v_mfma_f32_32x32x16_bf16 v[88:103], v[196:199], v[148:151], v[88:103]
  v_exp_f32 v116, v116
  v_exp_f32 v117, v117
  v_exp_f32 v118, v118
  v_exp_f32 v119, v119
  v_cvt_pk_bf16_f32 v140, v112, v113
  v_cvt_pk_bf16_f32 v141, v114, v115
  s_add_u32 m0, s66, 3072
  s_add_u32 s69, s58, 64
  buffer_load_dwordx4 v4, s[36:39], s69 offen lds
  v_cvt_pk_bf16_f32 v142, v116, v117
  v_cvt_pk_bf16_f32 v143, v118, v119
  v_mfma_f32_32x32x16_bf16 v[104:119], v[200:203], v[24:27], 0
  v_exp_f32 v120, v120
  v_exp_f32 v121, v121
  v_exp_f32 v122, v122
  v_exp_f32 v123, v123
  v_mfma_f32_32x32x16_bf16 v[104:119], v[204:207], v[28:31], v[104:119]
  v_exp_f32 v124, v124
  v_exp_f32 v125, v125
  v_exp_f32 v126, v126
  v_exp_f32 v127, v127
  v_cvt_pk_bf16_f32 v144, v120, v121
  v_cvt_pk_bf16_f32 v145, v122, v123
  v_mfma_f32_32x32x16_bf16 v[40:55], v[208:211], v[136:139], v[40:55]
  v_exp_f32 v128, v128
  v_exp_f32 v129, v129
  v_exp_f32 v130, v130
  v_exp_f32 v131, v131
  v_cvt_pk_bf16_f32 v146, v124, v125
  v_cvt_pk_bf16_f32 v147, v126, v127
  v_mfma_f32_32x32x16_bf16 v[40:55], v[212:215], v[140:143], v[40:55]
  v_exp_f32 v132, v132
  v_exp_f32 v133, v133
  v_exp_f32 v134, v134
  v_exp_f32 v135, v135
  v_cvt_pk_bf16_f32 v148, v128, v129
  v_cvt_pk_bf16_f32 v149, v130, v131
  buffer_load_dwordx4 v[184:187], v1, s[28:31], s55 offen offset:0
  buffer_load_dwordx4 v[188:191], v1, s[28:31], s55 offen offset:1024
  v_cvt_pk_bf16_f32 v150, v132, v133
  v_cvt_pk_bf16_f32 v151, v134, v135
  v_mfma_f32_32x32x16_bf16 v[120:135], v[200:203], v[32:35], 0
  v_exp_f32 v104, v104
  v_exp_f32 v105, v105
  v_exp_f32 v106, v106
  v_exp_f32 v107, v107
  v_mfma_f32_32x32x16_bf16 v[120:135], v[204:207], v[36:39], v[120:135]
  v_exp_f32 v108, v108
  v_exp_f32 v109, v109
  v_exp_f32 v110, v110
  v_exp_f32 v111, v111
  v_cvt_pk_bf16_f32 v136, v104, v105
  v_cvt_pk_bf16_f32 v137, v106, v107
  v_mfma_f32_32x32x16_bf16 v[56:71], v[208:211], v[144:147], v[56:71]
  v_exp_f32 v112, v112
  v_exp_f32 v113, v113
  v_exp_f32 v114, v114
  v_exp_f32 v115, v115
  v_cvt_pk_bf16_f32 v138, v108, v109
  v_cvt_pk_bf16_f32 v139, v110, v111
  v_mfma_f32_32x32x16_bf16 v[56:71], v[212:215], v[148:151], v[56:71]
  v_exp_f32 v116, v116
  v_exp_f32 v117, v117
  v_exp_f32 v118, v118
  v_exp_f32 v119, v119
  v_cvt_pk_bf16_f32 v140, v112, v113
  v_cvt_pk_bf16_f32 v141, v114, v115
  buffer_load_dwordx4 v[192:195], v1, s[28:31], s55 offen offset:2048
  buffer_load_dwordx4 v[196:199], v1, s[28:31], s55 offen offset:3072
  s_add_u32 s55, s55, 4096
  s_min_u32 s55, s55, s67
  v_cvt_pk_bf16_f32 v142, v116, v117
  v_cvt_pk_bf16_f32 v143, v118, v119
  s_waitcnt vmcnt(10)
  v_mfma_f32_32x32x16_bf16 v[104:119], v[152:155], v[8:11], 0
  v_exp_f32 v120, v120
  v_exp_f32 v121, v121
  v_exp_f32 v122, v122
  v_exp_f32 v123, v123
  v_mfma_f32_32x32x16_bf16 v[104:119], v[156:159], v[12:15], v[104:119]
  v_exp_f32 v124, v124
  v_exp_f32 v125, v125
  v_exp_f32 v126, v126
  v_exp_f32 v127, v127
  v_cvt_pk_bf16_f32 v144, v120, v121
  v_cvt_pk_bf16_f32 v145, v122, v123
  v_mfma_f32_32x32x16_bf16 v[72:87], v[208:211], v[136:139], v[72:87]
  v_exp_f32 v128, v128
  v_exp_f32 v129, v129
  v_exp_f32 v130, v130
  v_exp_f32 v131, v131
  v_cvt_pk_bf16_f32 v146, v124, v125
  v_cvt_pk_bf16_f32 v147, v126, v127
  v_mfma_f32_32x32x16_bf16 v[72:87], v[212:215], v[140:143], v[72:87]
  v_exp_f32 v132, v132
  v_exp_f32 v133, v133
  v_exp_f32 v134, v134
  v_exp_f32 v135, v135
  v_cvt_pk_bf16_f32 v148, v128, v129
  v_cvt_pk_bf16_f32 v149, v130, v131
  v_cvt_pk_bf16_f32 v150, v132, v133
  v_cvt_pk_bf16_f32 v151, v134, v135
  s_cmp_lt_u32 s56, 2
  s_cselect_b32 s60, 229376, 0
  s_cselect_b32 s61, 16384, 0
  s_add_u32 s58, s58, s60
  s_add_u32 s66, s66, s61
  s_add_u32 s56, s56, 1
  s_cmp_lt_u32 s56, 4
  s_cbranch_scc1 L_attn_20
L_attnj_19:
  v_mfma_f32_32x32x16_bf16 v[88:103], v[208:211], v[144:147], v[88:103]
  v_mfma_f32_32x32x16_bf16 v[88:103], v[212:215], v[148:151], v[88:103]
  s_add_u32 s60, s42, 1
  s_and_b32 s60, s60, 3
  s_mul_i32 s60, s60, 12288
  s_add_u32 s60, s60, 61440
  v_add_u32 v216, s60, v1
  ds_write_b128 v216, v[56:59] offset:0
  ds_write_b128 v216, v[60:63] offset:1024
  ds_write_b128 v216, v[64:67] offset:2048
  ds_write_b128 v216, v[68:71] offset:3072
  s_add_u32 s60, s42, 2
  s_and_b32 s60, s60, 3
  s_mul_i32 s60, s60, 12288
  s_add_u32 s60, s60, 65536
  v_add_u32 v216, s60, v1
  ds_write_b128 v216, v[72:75] offset:0
  ds_write_b128 v216, v[76:79] offset:1024
  ds_write_b128 v216, v[80:83] offset:2048
  ds_write_b128 v216, v[84:87] offset:3072
  s_add_u32 s60, s42, 3
  s_and_b32 s60, s60, 3
  s_mul_i32 s60, s60, 12288
  s_add_u32 s60, s60, 69632
  v_add_u32 v216, s60, v1
  ds_write_b128 v216, v[88:91] offset:0
  ds_write_b128 v216, v[92:95] offset:1024
  ds_write_b128 v216, v[96:99] offset:2048
  ds_write_b128 v216, v[100:103] offset:3072
  s_waitcnt vmcnt(0) lgkmcnt(0)
  s_barrier
  s_mul_i32 s60, s42, 12288
  s_add_u32 s60, s60, 61440
  v_add_u32 v216, s60, v1
  ds_read_b128 v[104:107], v216 offset:0
  ds_read_b128 v[108:111], v216 offset:1024
  ds_read_b128 v[112:115], v216 offset:2048
  ds_read_b128 v[116:119], v216 offset:3072
  ds_read_b128 v[120:123], v216 offset:4096
  ds_read_b128 v[124:127], v216 offset:5120
  ds_read_b128 v[128:131], v216 offset:6144
  ds_read_b128 v[132:135], v216 offset:7168
  ds_read_b128 v[136:139], v216 offset:8192
  ds_read_b128 v[140:143], v216 offset:9216
  ds_read_b128 v[144:147], v216 offset:10240
  ds_read_b128 v[148:151], v216 offset:11264
  s_waitcnt lgkmcnt(8)
  v_pk_add_f32 v[40:41], v[40:41], v[104:105]
  v_pk_add_f32 v[42:43], v[42:43], v[106:107]
  v_pk_add_f32 v[44:45], v[44:45], v[108:109]
  v_pk_add_f32 v[46:47], v[46:47], v[110:111]
  v_pk_add_f32 v[48:49], v[48:49], v[112:113]
  v_pk_add_f32 v[50:51], v[50:51], v[114:115]
  v_pk_add_f32 v[52:53], v[52:53], v[116:117]
  v_pk_add_f32 v[54:55], v[54:55], v[118:119]
  s_waitcnt lgkmcnt(4)
  v_pk_add_f32 v[40:41], v[40:41], v[120:121]
  v_pk_add_f32 v[42:43], v[42:43], v[122:123]
  v_pk_add_f32 v[44:45], v[44:45], v[124:125]
  v_pk_add_f32 v[46:47], v[46:47], v[126:127]
  v_pk_add_f32 v[48:49], v[48:49], v[128:129]
  v_pk_add_f32 v[50:51], v[50:51], v[130:131]
  v_pk_add_f32 v[52:53], v[52:53], v[132:133]
  v_pk_add_f32 v[54:55], v[54:55], v[134:135]
  s_waitcnt lgkmcnt(0)
  v_pk_add_f32 v[40:41], v[40:41], v[136:137]
  v_pk_add_f32 v[42:43], v[42:43], v[138:139]
  v_pk_add_f32 v[44:45], v[44:45], v[140:141]
  v_pk_add_f32 v[46:47], v[46:47], v[142:143]
  v_pk_add_f32 v[48:49], v[48:49], v[144:145]
  v_pk_add_f32 v[50:51], v[50:51], v[146:147]
  v_pk_add_f32 v[52:53], v[52:53], v[148:149]
  v_pk_add_f32 v[54:55], v[54:55], v[150:151]
  v_mov_b32 v218, v52
  v_mov_b32 v220, v52
  s_nop 1
  v_permlane32_swap_b32 v218, v220
  v_cmp_le_f32 vcc, 0x17800000, v220
  s_nop 2
  s_cmp_eq_u64 vcc, -1
  s_cbranch_scc1 L_attn_ok_21
  s_cmp_lg_u32 s59, 0
  s_cbranch_scc1 L_attn_ok_21
  v_mov_b32 v218, 160196
  v_mov_b32 v219, 1
  ds_write_b32 v218, v219
L_attn_ok_21:
  v_rcp_f32 v220, v220
  s_nop 0
  v_pk_mul_f32 v[40:41], v[40:41], v[220:221] op_sel_hi:[1,0]
  v_pk_mul_f32 v[42:43], v[42:43], v[220:221] op_sel_hi:[1,0]
  v_pk_mul_f32 v[44:45], v[44:45], v[220:221] op_sel_hi:[1,0]
  v_pk_mul_f32 v[46:47], v[46:47], v[220:221] op_sel_hi:[1,0]
  v_pk_mul_f32 v[48:49], v[48:49], v[220:221] op_sel_hi:[1,0]
  v_pk_mul_f32 v[50:51], v[50:51], v[220:221] op_sel_hi:[1,0]
  v_pk_mul_f32 v[52:53], v[52:53], v[220:221] op_sel_hi:[1,0]
  v_pk_mul_f32 v[54:55], v[54:55], v[220:221] op_sel_hi:[1,0]
  v_cndmask_b32_e64 v52, v52, 0, s[48:49]
  v_cndmask_b32_e64 v53, v53, 0, s[48:49]
  v_cndmask_b32_e64 v54, v54, 0, s[48:49]
  v_cndmask_b32_e64 v55, v55, 0, s[48:49]
  v_cvt_pk_bf16_f32 v136, v40, v41
  v_cvt_pk_bf16_f32 v137, v42, v43
  v_cvt_pk_bf16_f32 v138, v44, v45
  v_cvt_pk_bf16_f32 v139, v46, v47
  v_cvt_pk_bf16_f32 v140, v48, v49
  v_cvt_pk_bf16_f32 v141, v50, v51
  v_cvt_pk_bf16_f32 v142, v52, v53
  v_cvt_pk_bf16_f32 v143, v54, v55
  s_lshl_b32 s60, s53, 2
  s_add_u32 s60, s60, s42
  s_lshl_b32 s60, s60, 4
  s_add_u32 s60, s60, s52
  s_lshl_b32 s60, s60, 11
  s_add_u32 s60, s60, s46
  s_add_u32 s60, s60, 7340032
  buffer_store_dwordx4 v[136:139], v1, s[28:31], s60 offen offset:0 sc1
  buffer_store_dwordx4 v[140:143], v1, s[28:31], s60 offen offset:1024 sc1
  s_waitcnt vmcnt(0) lgkmcnt(0)
  s_barrier
  v_mov_b32 v218, 160196
  ds_read_b32 v219, v218
  s_lshl_b32 s60, s53, 7
  s_lshl_b32 s61, s52, 3
  s_add_u32 s60, s60, s61
  s_add_u32 s60, s60, s46
  s_add_u32 s60, s60, 31461376
  s_waitcnt lgkmcnt(0)
  v_readfirstlane_b32 s61, v219
  s_nop 2
  s_cmp_lg_u32 s61, 0
  s_cbranch_scc1 L_fallback
  s_cmp_lg_u32 s42, 0
  s_cbranch_scc1 L_pub_22
  v_mov_b32 v216, s40
  v_mov_b32 v217, s41
  v_mov_b32 v218, 0
  s_mov_b64 exec, 1
  s_cmp_eq_u32 s47, 0
  s_cbranch_scc1 L_stg_23
  buffer_store_dwordx2 v[216:217], v218, s[28:31], s60 offen
  s_branch L_std_24
L_stg_23:
  buffer_store_dwordx2 v[216:217], v218, s[28:31], s60 offen sc1
L_std_24:
  s_mov_b64 exec, -1
L_pub_22:
  s_cmp_ge_u32 s44, 28
  s_cbranch_scc1 L_idle
  s_mul_i32 s52, s44, 37
  s_lshr_b32 s52, s52, 8
  s_mul_i32 s53, s52, 7
  s_sub_u32 s53, s44, s53
  s_lshl_b32 s77, s43, 2
  s_add_u32 s52, s52, s77
  s_and_b32 s54, s42, 1
  s_lshl_b32 s56, s52, 1
  s_add_u32 s54, s54, s56
  s_lshr_b32 s55, s42, 1
  s_lshl_b32 s57, s53, 1
  s_add_u32 s57, s57, s55
  s_lshl_b32 s59, s54, 15
  s_lshl_b32 s60, s55, 14
  s_add_u32 s59, s59, s60
  s_add_u32 s59, s59, 7340032
  s_add_u32 s59, s59, s46
  s_cmp_lg_u32 s45, 0
  s_cbranch_scc1 L_res_25
  s_mov_b32 s32, s4
  s_mov_b32 s33, s5
  s_mov_b32 s34, 1835008
  s_mov_b32 s35, 0x20000
  v_and_b32 v140, 31, v0
  v_mul_u32_u24 v140, 896, v140
  v_lshrrev_b32 v141, 5, v0
  v_lshl_add_u32 v140, v141, 4, v140
  s_mul_i32 s64, s54, 28672
  s_lshl_b32 s60, s57, 6
  s_add_u32 s64, s64, s60
  s_add_u32 s65, s64, 32
  s_branch L_resd_26
L_res_25:
  s_mov_b32 s32, s24
  s_mov_b32 s33, s25
  s_mov_b32 s34, 268435456
  s_mov_b32 s35, 0x20000
  v_mov_b32 v140, v1
  s_mul_i32 s64, s54, 28672
  s_lshl_b32 s60, s57, 11
  s_add_u32 s64, s64, s60
  s_add_u32 s64, s64, s46
  s_add_u32 s64, s64, 11534336
  s_sub_u32 s64, s64, 41943040
  s_add_u32 s65, s64, 1024
L_resd_26:
  s_mul_i32 s60, s55, 14336
  s_mul_i32 s61, s55, 29696
  s_add_u32 s62, s60, s61
  s_sub_u32 s63, s60, s61
  s_add_u32 s63, s63, 29696
  v_add_u32 v142, s62, v3
  v_add_u32 v143, s63, v3
  s_cmp_lg_u32 s42, 0
  s_cbranch_scc1 L_w0_27
  v_min_u32 v136, 15, v0
  v_lshlrev_b32 v136, 3, v136
  s_lshr_b32 s56, s52, 1
  s_lshl_b32 s56, s56, 7
  s_add_u32 s56, s56, s46
  s_add_u32 s56, s56, 31461376
  s_mov_b32 s76, 0
L_poll_28:
  buffer_load_dwordx2 v[138:139], v136, s[28:31], s56 offen sc1
  s_waitcnt vmcnt(0)
  v_cmp_eq_u32 vcc, s40, v138
  v_cmp_eq_u32 s[74:75], s41, v139
  s_nop 2
  s_and_b64 vcc, vcc, s[74:75]
  s_cmp_eq_u64 vcc, -1
  s_cbranch_scc1 L_polld_29
  s_add_u32 s76, s76, 1
  s_cmp_lt_u32 s76, 0x40000
  s_cbranch_scc1 L_poll_28
L_polld_29:
L_w0_27:
  s_barrier
  buffer_load_dwordx4 v[8:11], v1, s[28:31], s59 offen offset:0
  buffer_load_dwordx4 v[12:15], v1, s[28:31], s59 offen offset:1024
  buffer_load_dwordx4 v[16:19], v1, s[28:31], s59 offen offset:2048
  buffer_load_dwordx4 v[20:23], v1, s[28:31], s59 offen offset:3072
  s_add_u32 s59, s59, 4096
  buffer_load_dwordx4 v[24:27], v1, s[28:31], s59 offen offset:0
  buffer_load_dwordx4 v[28:31], v1, s[28:31], s59 offen offset:1024
  buffer_load_dwordx4 v[32:35], v1, s[28:31], s59 offen offset:2048
  buffer_load_dwordx4 v[36:39], v1, s[28:31], s59 offen offset:3072
  s_add_u32 s59, s59, 4096
  buffer_load_dwordx4 v[40:43], v1, s[28:31], s59 offen offset:0
  buffer_load_dwordx4 v[44:47], v1, s[28:31], s59 offen offset:1024
  buffer_load_dwordx4 v[48:51], v1, s[28:31], s59 offen offset:2048
  buffer_load_dwordx4 v[52:55], v1, s[28:31], s59 offen offset:3072
  ds_read_b64_tr_b16 v[104:105], v142 offset:0
  ds_read_b64_tr_b16 v[106:107], v142 offset:512
  ds_read_b64_tr_b16 v[108:109], v143 offset:0
  ds_read_b64_tr_b16 v[110:111], v143 offset:512
  ds_read_b64_tr_b16 v[112:113], v142 offset:1024
  ds_read_b64_tr_b16 v[114:115], v142 offset:1536
  ds_read_b64_tr_b16 v[116:117], v143 offset:1024
  ds_read_b64_tr_b16 v[118:119], v143 offset:1536
  ds_read_b64_tr_b16 v[120:121], v142 offset:1792
  ds_read_b64_tr_b16 v[122:123], v142 offset:2304
  ds_read_b64_tr_b16 v[124:125], v143 offset:1792
  ds_read_b64_tr_b16 v[126:127], v143 offset:2304
  s_waitcnt vmcnt(11)
  s_waitcnt lgkmcnt(8)
  v_mfma_f32_32x32x16_bf16 v[72:87], v[104:107], v[8:11], 0
  ds_read_b64_tr_b16 v[104:105], v142 offset:2816
  ds_read_b64_tr_b16 v[106:107], v142 offset:3328
  v_mfma_f32_32x32x16_bf16 v[88:103], v[108:111], v[8:11], 0
  s_add_u32 s59, s59, 4096
  buffer_load_dwordx4 v[56:59], v1, s[28:31], s59 offen offset:0
  ds_read_b64_tr_b16 v[108:109], v143 offset:2816
  ds_read_b64_tr_b16 v[110:111], v143 offset:3328
  s_waitcnt vmcnt(11)
  s_waitcnt lgkmcnt(8)
  v_mfma_f32_32x32x16_bf16 v[72:87], v[112:115], v[12:15], v[72:87]
  ds_read_b64_tr_b16 v[112:113], v142 offset:3584
  ds_read_b64_tr_b16 v[114:115], v142 offset:4096
  v_mfma_f32_32x32x16_bf16 v[88:103], v[116:119], v[12:15], v[88:103]
  buffer_load_dwordx4 v[60:63], v1, s[28:31], s59 offen offset:1024
  ds_read_b64_tr_b16 v[116:117], v143 offset:3584
  ds_read_b64_tr_b16 v[118:119], v143 offset:4096
  s_waitcnt vmcnt(11)
  s_waitcnt lgkmcnt(8)
  v_mfma_f32_32x32x16_bf16 v[72:87], v[120:123], v[16:19], v[72:87]
  ds_read_b64_tr_b16 v[120:121], v142 offset:4608
  ds_read_b64_tr_b16 v[122:123], v142 offset:5120
  v_mfma_f32_32x32x16_bf16 v[88:103], v[124:127], v[16:19], v[88:103]
  buffer_load_dwordx4 v[64:67], v1, s[28:31], s59 offen offset:2048
  ds_read_b64_tr_b16 v[124:125], v143 offset:4608
  ds_read_b64_tr_b16 v[126:127], v143 offset:5120
  s_waitcnt vmcnt(11)
  s_waitcnt lgkmcnt(8)
  v_mfma_f32_32x32x16_bf16 v[72:87], v[104:107], v[20:23], v[72:87]
  ds_read_b64_tr_b16 v[104:105], v142 offset:5376
  ds_read_b64_tr_b16 v[106:107], v142 offset:5888
  v_mfma_f32_32x32x16_bf16 v[88:103], v[108:111], v[20:23], v[88:103]
  buffer_load_dwordx4 v[68:71], v1, s[28:31], s59 offen offset:3072
  ds_read_b64_tr_b16 v[108:109], v143 offset:5376
  ds_read_b64_tr_b16 v[110:111], v143 offset:5888
  s_waitcnt vmcnt(11)
  s_waitcnt lgkmcnt(8)
  v_mfma_f32_32x32x16_bf16 v[72:87], v[112:115], v[24:27], v[72:87]
  ds_read_b64_tr_b16 v[112:113], v142 offset:6400
  ds_read_b64_tr_b16 v[114:115], v142 offset:6912
  v_mfma_f32_32x32x16_bf16 v[88:103], v[116:119], v[24:27], v[88:103]
  buffer_load_dwordx4 v[128:131], v140, s[32:35], s64 offen
  buffer_load_dwordx4 v[132:135], v140, s[32:35], s65 offen
  ds_read_b64_tr_b16 v[116:117], v143 offset:6400
  ds_read_b64_tr_b16 v[118:119], v143 offset:6912
  s_waitcnt vmcnt(12)
  s_waitcnt lgkmcnt(8)
  v_mfma_f32_32x32x16_bf16 v[72:87], v[120:123], v[28:31], v[72:87]
  ds_read_b64_tr_b16 v[120:121], v142 offset:7168
  ds_read_b64_tr_b16 v[122:123], v142 offset:7680
  v_mfma_f32_32x32x16_bf16 v[88:103], v[124:127], v[28:31], v[88:103]
  s_add_u32 s69, s42, 0
  s_mul_i32 s70, s69, 57344
  s_add_u32 s70, s70, s68
  s_mul_i32 s71, s69, 4096
  s_add_u32 m0, s71, 61440
  s_add_u32 s72, s70, 1792
  buffer_load_dwordx4 v4, s[36:39], s72 offen lds
  s_add_u32 m0, s71, 62464
  s_add_u32 s72, s70, 1856
  buffer_load_dwordx4 v4, s[36:39], s72 offen lds
  ds_read_b64_tr_b16 v[124:125], v143 offset:7168
  ds_read_b64_tr_b16 v[126:127], v143 offset:7680
  s_waitcnt vmcnt(13)
  s_waitcnt lgkmcnt(8)
  v_mfma_f32_32x32x16_bf16 v[72:87], v[104:107], v[32:35], v[72:87]
  ds_read_b64_tr_b16 v[104:105], v142 offset:8192
  ds_read_b64_tr_b16 v[106:107], v142 offset:8704
  v_mfma_f32_32x32x16_bf16 v[88:103], v[108:111], v[32:35], v[88:103]
  s_add_u32 m0, s71, 63488
  s_add_u32 s72, s70, 0
  buffer_load_dwordx4 v4, s[36:39], s72 offen lds
  s_add_u32 m0, s71, 64512
  s_add_u32 s72, s70, 64
  buffer_load_dwordx4 v4, s[36:39], s72 offen lds
  ds_read_b64_tr_b16 v[108:109], v143 offset:8192
  ds_read_b64_tr_b16 v[110:111], v143 offset:8704
  s_waitcnt vmcnt(14)
  s_waitcnt lgkmcnt(8)
  v_mfma_f32_32x32x16_bf16 v[72:87], v[112:115], v[36:39], v[72:87]
  ds_read_b64_tr_b16 v[112:113], v142 offset:8960
  ds_read_b64_tr_b16 v[114:115], v142 offset:9472
  v_mfma_f32_32x32x16_bf16 v[88:103], v[116:119], v[36:39], v[88:103]
  s_add_u32 s69, s42, 4
  s_mul_i32 s70, s69, 57344
  s_add_u32 s70, s70, s68
  s_mul_i32 s71, s69, 4096
  s_add_u32 m0, s71, 61440
  s_add_u32 s72, s70, 1792
  buffer_load_dwordx4 v4, s[36:39], s72 offen lds
  ds_read_b64_tr_b16 v[116:117], v143 offset:8960
  ds_read_b64_tr_b16 v[118:119], v143 offset:9472
  s_waitcnt vmcnt(14)
  s_waitcnt lgkmcnt(8)
  v_mfma_f32_32x32x16_bf16 v[72:87], v[120:123], v[40:43], v[72:87]
  ds_read_b64_tr_b16 v[120:121], v142 offset:9984
  ds_read_b64_tr_b16 v[122:123], v142 offset:10496
  v_mfma_f32_32x32x16_bf16 v[88:103], v[124:127], v[40:43], v[88:103]
  s_add_u32 m0, s71, 62464
  s_add_u32 s72, s70, 1856
  buffer_load_dwordx4 v4, s[36:39], s72 offen lds
  ds_read_b64_tr_b16 v[124:125], v143 offset:9984
  ds_read_b64_tr_b16 v[126:127], v143 offset:10496
  s_waitcnt vmcnt(14)
  s_waitcnt lgkmcnt(8)
  v_mfma_f32_32x32x16_bf16 v[72:87], v[104:107], v[44:47], v[72:87]
  ds_read_b64_tr_b16 v[104:105], v142 offset:10752
  ds_read_b64_tr_b16 v[106:107], v142 offset:11264
  v_mfma_f32_32x32x16_bf16 v[88:103], v[108:111], v[44:47], v[88:103]
  s_add_u32 m0, s71, 63488
  s_add_u32 s72, s70, 0
  buffer_load_dwordx4 v4, s[36:39], s72 offen lds
  ds_read_b64_tr_b16 v[108:109], v143 offset:10752
  ds_read_b64_tr_b16 v[110:111], v143 offset:11264
  s_waitcnt vmcnt(14)
  s_waitcnt lgkmcnt(8)
  v_mfma_f32_32x32x16_bf16 v[72:87], v[112:115], v[48:51], v[72:87]
  ds_read_b64_tr_b16 v[112:113], v142 offset:11776
  ds_read_b64_tr_b16 v[114:115], v142 offset:12288
  v_mfma_f32_32x32x16_bf16 v[88:103], v[116:119], v[48:51], v[88:103]
  s_add_u32 m0, s71, 64512
  s_add_u32 s72, s70, 64
  buffer_load_dwordx4 v4, s[36:39], s72 offen lds
  ds_read_b64_tr_b16 v[116:117], v143 offset:11776
  ds_read_b64_tr_b16 v[118:119], v143 offset:12288
  s_waitcnt vmcnt(14)
  s_waitcnt lgkmcnt(8)
  v_mfma_f32_32x32x16_bf16 v[72:87], v[120:123], v[52:55], v[72:87]
  ds_read_b64_tr_b16 v[120:121], v142 offset:12544
  ds_read_b64_tr_b16 v[122:123], v142 offset:13056
  v_mfma_f32_32x32x16_bf16 v[88:103], v[124:127], v[52:55], v[88:103]
  s_add_u32 s69, s42, 8
  s_mul_i32 s70, s69, 57344
  s_add_u32 s70, s70, s68
  s_mul_i32 s71, s69, 4096
  s_add_u32 m0, s71, 61440
  s_add_u32 s72, s70, 1792
  buffer_load_dwordx4 v4, s[36:39], s72 offen lds
  ds_read_b64_tr_b16 v[124:125], v143 offset:12544
  ds_read_b64_tr_b16 v[126:127], v143 offset:13056
  s_waitcnt vmcnt(14)
  s_waitcnt lgkmcnt(8)
  v_mfma_f32_32x32x16_bf16 v[72:87], v[104:107], v[56:59], v[72:87]
  ds_read_b64_tr_b16 v[104:105], v142 offset:13568
  ds_read_b64_tr_b16 v[106:107], v142 offset:14080
  v_mfma_f32_32x32x16_bf16 v[88:103], v[108:111], v[56:59], v[88:103]
  s_add_u32 m0, s71, 62464
  s_add_u32 s72, s70, 1856
  buffer_load_dwordx4 v4, s[36:39], s72 offen lds
  ds_read_b64_tr_b16 v[108:109], v143 offset:13568
  ds_read_b64_tr_b16 v[110:111], v143 offset:14080
  s_waitcnt vmcnt(14)
  s_waitcnt lgkmcnt(8)
  v_mfma_f32_32x32x16_bf16 v[72:87], v[112:115], v[60:63], v[72:87]
  v_mfma_f32_32x32x16_bf16 v[88:103], v[116:119], v[60:63], v[88:103]
  s_add_u32 m0, s71, 63488
  s_add_u32 s72, s70, 0
  buffer_load_dwordx4 v4, s[36:39], s72 offen lds
  s_waitcnt vmcnt(14)
  s_waitcnt lgkmcnt(4)
  v_mfma_f32_32x32x16_bf16 v[72:87], v[120:123], v[64:67], v[72:87]
  v_mfma_f32_32x32x16_bf16 v[88:103], v[124:127], v[64:67], v[88:103]
  s_add_u32 m0, s71, 64512
  s_add_u32 s72, s70, 64
  buffer_load_dwordx4 v4, s[36:39], s72 offen lds
  s_waitcnt vmcnt(14)
  s_waitcnt lgkmcnt(0)
  v_mfma_f32_32x32x16_bf16 v[72:87], v[104:107], v[68:71], v[72:87]
  v_mfma_f32_32x32x16_bf16 v[88:103], v[108:111], v[68:71], v[88:103]
  s_barrier
  s_xor_b32 s60, s42, 2
  s_lshl_b32 s60, s60, 12
  v_add_u32 v136, s60, v1
  s_nop 7
  ds_write_b128 v136, v[88:91] offset:0
  ds_write_b128 v136, v[92:95] offset:1024
  ds_write_b128 v136, v[96:99] offset:2048
  ds_write_b128 v136, v[100:103] offset:3072
  s_waitcnt vmcnt(12)
  s_cmp_lg_u32 s45, 0
  s_cbranch_scc1 L_rsw_30
  v_permlane32_swap_b32 v128, v130
  v_permlane32_swap_b32 v129, v131
  v_permlane32_swap_b32 v132, v134
  v_permlane32_swap_b32 v133, v135
  s_nop 1
L_rsw_30:
  v_lshlrev_b32 v8, 16, v128
  v_and_b32 v9, 0xffff0000, v128
  v_lshlrev_b32 v10, 16, v129
  v_and_b32 v11, 0xffff0000, v129
  v_lshlrev_b32 v12, 16, v130
  v_and_b32 v13, 0xffff0000, v130
  v_lshlrev_b32 v14, 16, v131
  v_and_b32 v15, 0xffff0000, v131
  v_lshlrev_b32 v16, 16, v132
  v_and_b32 v17, 0xffff0000, v132
  v_lshlrev_b32 v18, 16, v133
  v_and_b32 v19, 0xffff0000, v133
  v_lshlrev_b32 v20, 16, v134
  v_and_b32 v21, 0xffff0000, v134
  v_lshlrev_b32 v22, 16, v135
  v_and_b32 v23, 0xffff0000, v135
  s_waitcnt lgkmcnt(0)
  s_barrier
  s_lshl_b32 s60, s42, 12
  v_add_u32 v136, s60, v1
  ds_read_b128 v[88:91], v136 offset:0
  ds_read_b128 v[92:95], v136 offset:1024
  ds_read_b128 v[96:99], v136 offset:2048
  ds_read_b128 v[100:103], v136 offset:3072
  v_pk_add_f32 v[72:73], v[72:73], v[8:9]
  v_pk_add_f32 v[74:75], v[74:75], v[10:11]
  v_pk_add_f32 v[76:77], v[76:77], v[12:13]
  v_pk_add_f32 v[78:79], v[78:79], v[14:15]
  v_pk_add_f32 v[80:81], v[80:81], v[16:17]
  v_pk_add_f32 v[82:83], v[82:83], v[18:19]
  v_pk_add_f32 v[84:85], v[84:85], v[20:21]
  v_pk_add_f32 v[86:87], v[86:87], v[22:23]
  s_waitcnt lgkmcnt(0)
  v_pk_add_f32 v[72:73], v[72:73], v[88:89]
  v_pk_add_f32 v[74:75], v[74:75], v[90:91]
  v_pk_add_f32 v[76:77], v[76:77], v[92:93]
  v_pk_add_f32 v[78:79], v[78:79], v[94:95]
  v_pk_add_f32 v[80:81], v[80:81], v[96:97]
  v_pk_add_f32 v[82:83], v[82:83], v[98:99]
  v_pk_add_f32 v[84:85], v[84:85], v[100:101]
  v_pk_add_f32 v[86:87], v[86:87], v[102:103]
  v_cvt_pk_bf16_f32 v24, v72, v73
  v_cvt_pk_bf16_f32 v25, v74, v75
  v_cvt_pk_bf16_f32 v26, v76, v77
  v_cvt_pk_bf16_f32 v27, v78, v79
  v_cvt_pk_bf16_f32 v28, v80, v81
  v_cvt_pk_bf16_f32 v29, v82, v83
  v_cvt_pk_bf16_f32 v30, v84, v85
  v_cvt_pk_bf16_f32 v31, v86, v87
  v_pk_add_f32 v[32:33], v[72:73], v[74:75]
  v_pk_mul_f32 v[34:35], v[72:73], v[72:73]
  v_pk_add_f32 v[32:33], v[32:33], v[76:77]
  v_pk_add_f32 v[32:33], v[32:33], v[78:79]
  v_pk_add_f32 v[32:33], v[32:33], v[80:81]
  v_pk_add_f32 v[32:33], v[32:33], v[82:83]
  v_pk_add_f32 v[32:33], v[32:33], v[84:85]
  v_pk_add_f32 v[32:33], v[32:33], v[86:87]
  v_pk_fma_f32 v[34:35], v[74:75], v[74:75], v[34:35]
  v_pk_fma_f32 v[34:35], v[76:77], v[76:77], v[34:35]
  v_pk_fma_f32 v[34:35], v[78:79], v[78:79], v[34:35]
  v_pk_fma_f32 v[34:35], v[80:81], v[80:81], v[34:35]
  v_pk_fma_f32 v[34:35], v[82:83], v[82:83], v[34:35]
  v_pk_fma_f32 v[34:35], v[84:85], v[84:85], v[34:35]
  v_pk_fma_f32 v[34:35], v[86:87], v[86:87], v[34:35]
  v_add_f32 v32, v32, v33
  v_add_f32 v34, v34, v35
  v_mov_b32 v36, v32
  v_mov_b32 v37, v32
  s_nop 1
  v_permlane32_swap_b32 v36, v37
  v_add_f32 v32, v36, v37
  v_mov_b32 v36, v34
  v_mov_b32 v37, v34
  s_nop 1
  v_permlane32_swap_b32 v36, v37
  v_add_f32 v34, v36, v37
  v_mov_b32 v33, v34
  s_mul_i32 s56, s54, 28672
  s_lshl_b32 s60, s57, 11
  s_add_u32 s56, s56, s60
  s_add_u32 s56, s56, s46
  s_add_u32 s56, s56, 9437184
  s_mul_i32 s60, s54, 14
  s_add_u32 s60, s60, s57
  s_lshl_b32 s60, s60, 8
  s_add_u32 s60, s60, s46
  s_add_u32 s60, s60, 30408704
  v_and_b32 v36, 31, v0
  v_lshlrev_b32 v36, 3, v36
  buffer_store_dwordx4 v[24:27], v1, s[28:31], s56 offen offset:0 sc1
  buffer_store_dwordx4 v[28:31], v1, s[28:31], s56 offen offset:1024 sc1
  buffer_store_dwordx2 v[32:33], v36, s[28:31], s60 offen sc1
  s_mov_b32 s36, s12
  s_mov_b32 s37, s13
  s_mov_b32 s38, 1605632
  s_mov_b32 s39, 0x20000
  v_lshrrev_b32 v4, 2, v0
  v_mul_u32_u24 v4, 3584, v4
  v_and_b32 v5, 3, v0
  v_lshl_add_u32 v4, v5, 4, v4
  s_cmp_ge_u32 s44, 14
  s_cselect_b32 s68, 14, 0
  s_sub_u32 s68, s44, s68
  s_lshl_b32 s68, s68, 7
  s_add_u32 s69, s42, 24
L_wst_31:
  s_mul_i32 s70, s69, 57344
  s_add_u32 s70, s70, s68
  s_mul_i32 s71, s69, 4096
  s_add_u32 m0, s71, -81920
  s_add_u32 s72, s70, 1792
  buffer_load_dwordx4 v4, s[36:39], s72 offen lds
  s_add_u32 m0, s71, -80896
  s_add_u32 s72, s70, 1856
  buffer_load_dwordx4 v4, s[36:39], s72 offen lds
  s_add_u32 m0, s71, -79872
  s_add_u32 s72, s70, 0
  buffer_load_dwordx4 v4, s[36:39], s72 offen lds
  s_add_u32 m0, s71, -78848
  s_add_u32 s72, s70, 64
  buffer_load_dwordx4 v4, s[36:39], s72 offen lds
  s_add_u32 s69, s69, 4
  s_cmp_lt_u32 s69, 28
  s_cbranch_scc1 L_wst_31
L_wstd_32:
  s_waitcnt vmcnt(4)
  s_waitcnt lgkmcnt(0)
  s_barrier
  s_lshr_b32 s56, s52, 1
  s_lshl_b32 s56, s56, 7
  s_and_b32 s60, s52, 1
  s_mul_i32 s60, s60, 7
  s_add_u32 s60, s60, s53
  s_lshl_b32 s60, s60, 3
  s_add_u32 s56, s56, s60
  s_add_u32 s56, s56, s46
  s_add_u32 s56, s56, 31465472
  s_cmp_lg_u32 s42, 0
  s_cbranch_scc1 L_pub_33
  v_mov_b32 v136, s40
  v_mov_b32 v137, s41
  v_mov_b32 v138, 0
  s_mov_b64 exec, 1
  s_cmp_eq_u32 s47, 0
  s_cbranch_scc1 L_stg_34
  buffer_store_dwordx2 v[136:137], v138, s[28:31], s56 offen
  s_branch L_std_35
L_stg_34:
  buffer_store_dwordx2 v[136:137], v138, s[28:31], s56 offen sc1
L_std_35:
  s_mov_b64 exec, -1
L_pub_33:
  s_cmp_ge_u32 s44, 14
  s_cselect_b32 s55, 14, 0
  s_cselect_b32 s52, 1, 0
  s_sub_u32 s53, s44, s55
  s_lshl_b32 s55, s43, 1
  s_add_u32 s52, s52, s55
  s_lshl_b32 s54, s52, 2
  s_add_u32 s54, s54, s42
  s_mul_i32 s59, s54, 28672
  s_add_u32 s59, s59, s46
  s_add_u32 s59, s59, 9437184
  v_add_u32 v241, 61440, v3
  v_add_u32 v243, 16384, v3
  v_add_u32 v245, 126976, v3
  v_mov_b32 v244, 0xc0135761
  v_mov_b32 v246, 0xbdd2d3e8
  v_mov_b32 v248, 1.0
  v_lshrrev_b32 v249, 5, v0
  v_lshlrev_b32 v249, 4, v249
  v_add_u32 v249, 160256, v249
  s_cmp_eq_u32 s42, 0
  s_cbranch_scc1 L_nw0_36
  s_waitcnt vmcnt(0)
L_nw0_36:
  s_cmp_lg_u32 s42, 0
  s_cbranch_scc1 L_w0_37
  v_min_u32 v208, 13, v0
  v_lshlrev_b32 v208, 3, v208
  s_lshl_b32 s55, s52, 7
  s_add_u32 s55, s55, s46
  s_add_u32 s55, s55, 31465472
  s_mov_b32 s76, 0
L_poll_38:
  buffer_load_dwordx2 v[210:211], v208, s[28:31], s55 offen sc1
  s_waitcnt vmcnt(0)
  v_cmp_eq_u32 vcc, s40, v210
  v_cmp_eq_u32 s[74:75], s41, v211
  s_nop 2
  s_and_b64 vcc, vcc, s[74:75]
  s_cmp_eq_u64 vcc, -1
  s_cbranch_scc1 L_polld_39
  s_add_u32 s76, s76, 1
  s_cmp_lt_u32 s76, 0x40000
  s_cbranch_scc1 L_poll_38
L_polld_39:
L_w0_37:
  s_barrier
  buffer_load_dwordx4 v[8:11], v1, s[28:31], s59 offen offset:0
  buffer_load_dwordx4 v[12:15], v1, s[28:31], s59 offen offset:1024
  buffer_load_dwordx4 v[16:19], v1, s[28:31], s59 offen offset:2048
  buffer_load_dwordx4 v[20:23], v1, s[28:31], s59 offen offset:3072
  s_add_u32 s59, s59, 4096
  buffer_load_dwordx4 v[24:27], v1, s[28:31], s59 offen offset:0
  buffer_load_dwordx4 v[28:31], v1, s[28:31], s59 offen offset:1024
  buffer_load_dwordx4 v[32:35], v1, s[28:31], s59 offen offset:2048
  buffer_load_dwordx4 v[36:39], v1, s[28:31], s59 offen offset:3072
  s_add_u32 s59, s59, 4096
  buffer_load_dwordx4 v[40:43], v1, s[28:31], s59 offen offset:0
  buffer_load_dwordx4 v[44:47], v1, s[28:31], s59 offen offset:1024
  buffer_load_dwordx4 v[48:51], v1, s[28:31], s59 offen offset:2048
  buffer_load_dwordx4 v[52:55], v1, s[28:31], s59 offen offset:3072
  s_cmp_lg_u32 s45, 0
  s_cbranch_scc1 L_cs4a_40
  v_lshlrev_b32 v208, 3, v0
  s_lshl_b32 s60, s53, 9
  s_add_u32 s61, s60, 31260672
  s_add_u32 s60, s60, 31267840
  buffer_load_dwordx2 v[250:251], v208, s[28:31], s60 offen sc1
  buffer_load_dwordx2 v[252:253], v208, s[28:31], s61 offen sc1
L_cs4a_40:
  ds_read_b64_tr_b16 v[184:185], v241 offset:0
  ds_read_b64_tr_b16 v[186:187], v241 offset:512
  ds_read_b64_tr_b16 v[188:189], v241 offset:1024
  ds_read_b64_tr_b16 v[190:191], v241 offset:1536
  ds_read_b64_tr_b16 v[192:193], v241 offset:4096
  ds_read_b64_tr_b16 v[194:195], v241 offset:4608
  ds_read_b64_tr_b16 v[196:197], v241 offset:5120
  ds_read_b64_tr_b16 v[198:199], v241 offset:5632
  ds_read_b64_tr_b16 v[200:201], v241 offset:8192
  ds_read_b64_tr_b16 v[202:203], v241 offset:8704
  ds_read_b64_tr_b16 v[204:205], v241 offset:9216
  ds_read_b64_tr_b16 v[206:207], v241 offset:9728
  s_waitcnt vmcnt(11)
  s_waitcnt lgkmcnt(8)
  v_mfma_f32_32x32x16_bf16 v[120:135], v[184:187], v[8:11], 0
  ds_read_b64_tr_b16 v[184:185], v241 offset:12288
  ds_read_b64_tr_b16 v[186:187], v241 offset:12800
  v_mfma_f32_32x32x16_bf16 v[136:151], v[188:191], v[8:11], 0
  s_add_u32 s59, s59, 4096
  buffer_load_dwordx4 v[56:59], v1, s[28:31], s59 offen offset:0
  ds_read_b64_tr_b16 v[188:189], v241 offset:13312
  ds_read_b64_tr_b16 v[190:191], v241 offset:13824
  s_waitcnt vmcnt(11)
  s_waitcnt lgkmcnt(8)
  v_mfma_f32_32x32x16_bf16 v[120:135], v[192:195], v[12:15], v[120:135]
  ds_read_b64_tr_b16 v[192:193], v241 offset:16384
  ds_read_b64_tr_b16 v[194:195], v241 offset:16896
  v_mfma_f32_32x32x16_bf16 v[136:151], v[196:199], v[12:15], v[136:151]
  buffer_load_dwordx4 v[60:63], v1, s[28:31], s59 offen offset:1024
  ds_read_b64_tr_b16 v[196:197], v241 offset:17408
  ds_read_b64_tr_b16 v[198:199], v241 offset:17920
  s_waitcnt vmcnt(11)
  s_waitcnt lgkmcnt(8)
  v_mfma_f32_32x32x16_bf16 v[120:135], v[200:203], v[16:19], v[120:135]
  ds_read_b64_tr_b16 v[200:201], v241 offset:20480
  ds_read_b64_tr_b16 v[202:203], v241 offset:20992
  v_mfma_f32_32x32x16_bf16 v[136:151], v[204:207], v[16:19], v[136:151]
  buffer_load_dwordx4 v[64:67], v1, s[28:31], s59 offen offset:2048
  ds_read_b64_tr_b16 v[204:205], v241 offset:21504
  ds_read_b64_tr_b16 v[206:207], v241 offset:22016
  s_waitcnt vmcnt(11)
  s_waitcnt lgkmcnt(8)
  v_mfma_f32_32x32x16_bf16 v[120:135], v[184:187], v[20:23], v[120:135]
  ds_read_b64_tr_b16 v[184:185], v241 offset:24576
  ds_read_b64_tr_b16 v[186:187], v241 offset:25088
  v_mfma_f32_32x32x16_bf16 v[136:151], v[188:191], v[20:23], v[136:151]
  buffer_load_dwordx4 v[68:71], v1, s[28:31], s59 offen offset:3072
  ds_read_b64_tr_b16 v[188:189], v241 offset:25600
  ds_read_b64_tr_b16 v[190:191], v241 offset:26112
  s_waitcnt vmcnt(11)
  s_waitcnt lgkmcnt(8)
  v_mfma_f32_32x32x16_bf16 v[120:135], v[192:195], v[24:27], v[120:135]
  ds_read_b64_tr_b16 v[192:193], v241 offset:28672
  ds_read_b64_tr_b16 v[194:195], v241 offset:29184
  v_mfma_f32_32x32x16_bf16 v[136:151], v[196:199], v[24:27], v[136:151]
  s_add_u32 s59, s59, 4096
  buffer_load_dwordx4 v[72:75], v1, s[28:31], s59 offen offset:0
  ds_read_b64_tr_b16 v[196:197], v241 offset:29696
  ds_read_b64_tr_b16 v[198:199], v241 offset:30208
  s_waitcnt vmcnt(11)
  s_waitcnt lgkmcnt(8)
  v_mfma_f32_32x32x16_bf16 v[120:135], v[200:203], v[28:31], v[120:135]
  ds_read_b64_tr_b16 v[200:201], v241 offset:32768
  ds_read_b64_tr_b16 v[202:203], v241 offset:33280
  v_mfma_f32_32x32x16_bf16 v[136:151], v[204:207], v[28:31], v[136:151]
  buffer_load_dwordx4 v[76:79], v1, s[28:31], s59 offen offset:1024
  ds_read_b64_tr_b16 v[204:205], v241 offset:33792
  ds_read_b64_tr_b16 v[206:207], v241 offset:34304
  s_waitcnt vmcnt(11)
  s_waitcnt lgkmcnt(8)
  v_mfma_f32_32x32x16_bf16 v[120:135], v[184:187], v[32:35], v[120:135]
  ds_read_b64_tr_b16 v[184:185], v241 offset:36864
  ds_read_b64_tr_b16 v[186:187], v241 offset:37376
  v_mfma_f32_32x32x16_bf16 v[136:151], v[188:191], v[32:35], v[136:151]
  buffer_load_dwordx4 v[80:83], v1, s[28:31], s59 offen offset:2048
  ds_read_b64_tr_b16 v[188:189], v241 offset:37888
  ds_read_b64_tr_b16 v[190:191], v241 offset:38400
  s_waitcnt vmcnt(11)
  s_waitcnt lgkmcnt(8)
  v_mfma_f32_32x32x16_bf16 v[120:135], v[192:195], v[36:39], v[120:135]
  ds_read_b64_tr_b16 v[192:193], v241 offset:40960
  ds_read_b64_tr_b16 v[194:195], v241 offset:41472
  v_mfma_f32_32x32x16_bf16 v[136:151], v[196:199], v[36:39], v[136:151]
  buffer_load_dwordx4 v[84:87], v1, s[28:31], s59 offen offset:3072
  ds_read_b64_tr_b16 v[196:197], v241 offset:41984
  ds_read_b64_tr_b16 v[198:199], v241 offset:42496
  s_waitcnt vmcnt(11)
  s_waitcnt lgkmcnt(8)
  v_mfma_f32_32x32x16_bf16 v[120:135], v[200:203], v[40:43], v[120:135]
  ds_read_b64_tr_b16 v[200:201], v241 offset:45056
  ds_read_b64_tr_b16 v[202:203], v241 offset:45568
  v_mfma_f32_32x32x16_bf16 v[136:151], v[204:207], v[40:43], v[136:151]
  s_add_u32 s59, s59, 4096
  buffer_load_dwordx4 v[88:91], v1, s[28:31], s59 offen offset:0
  ds_read_b64_tr_b16 v[204:205], v241 offset:46080
  ds_read_b64_tr_b16 v[206:207], v241 offset:46592
  s_waitcnt vmcnt(11)
  s_waitcnt lgkmcnt(8)
  v_mfma_f32_32x32x16_bf16 v[120:135], v[184:187], v[44:47], v[120:135]
  ds_read_b64_tr_b16 v[184:185], v241 offset:49152
  ds_read_b64_tr_b16 v[186:187], v241 offset:49664
  v_mfma_f32_32x32x16_bf16 v[136:151], v[188:191], v[44:47], v[136:151]
  buffer_load_dwordx4 v[92:95], v1, s[28:31], s59 offen offset:1024
  ds_read_b64_tr_b16 v[188:189], v241 offset:50176
  ds_read_b64_tr_b16 v[190:191], v241 offset:50688
  s_waitcnt vmcnt(11)
  s_waitcnt lgkmcnt(8)
  v_mfma_f32_32x32x16_bf16 v[120:135], v[192:195], v[48:51], v[120:135]
  ds_read_b64_tr_b16 v[192:193], v241 offset:53248
  ds_read_b64_tr_b16 v[194:195], v241 offset:53760
  v_mfma_f32_32x32x16_bf16 v[136:151], v[196:199], v[48:51], v[136:151]
  buffer_load_dwordx4 v[96:99], v1, s[28:31], s59 offen offset:2048
  ds_read_b64_tr_b16 v[196:197], v241 offset:54272
  ds_read_b64_tr_b16 v[198:199], v241 offset:54784
  s_waitcnt vmcnt(11)
  s_waitcnt lgkmcnt(8)
  v_mfma_f32_32x32x16_bf16 v[120:135], v[200:203], v[52:55], v[120:135]
  ds_read_b64_tr_b16 v[200:201], v241 offset:57344
  ds_read_b64_tr_b16 v[202:203], v241 offset:57856
  v_mfma_f32_32x32x16_bf16 v[136:151], v[204:207], v[52:55], v[136:151]
  buffer_load_dwordx4 v[100:103], v1, s[28:31], s59 offen offset:3072
  ds_read_b64_tr_b16 v[204:205], v241 offset:58368
  ds_read_b64_tr_b16 v[206:207], v241 offset:58880
  s_waitcnt vmcnt(11)
  s_waitcnt lgkmcnt(8)
  v_mfma_f32_32x32x16_bf16 v[120:135], v[184:187], v[56:59], v[120:135]
  ds_read_b64_tr_b16 v[184:185], v241 offset:61440
  ds_read_b64_tr_b16 v[186:187], v241 offset:61952
  v_mfma_f32_32x32x16_bf16 v[136:151], v[188:191], v[56:59], v[136:151]
  s_add_u32 s59, s59, 4096
  buffer_load_dwordx4 v[104:107], v1, s[28:31], s59 offen offset:0
  ds_read_b64_tr_b16 v[188:189], v241 offset:62464
  ds_read_b64_tr_b16 v[190:191], v241 offset:62976
  s_waitcnt vmcnt(11)
  s_waitcnt lgkmcnt(8)
  v_mfma_f32_32x32x16_bf16 v[120:135], v[192:195], v[60:63], v[120:135]
  ds_read_b64_tr_b16 v[192:193], v245 offset:0
  ds_read_b64_tr_b16 v[194:195], v245 offset:512
  v_mfma_f32_32x32x16_bf16 v[136:151], v[196:199], v[60:63], v[136:151]
  buffer_load_dwordx4 v[108:111], v1, s[28:31], s59 offen offset:1024
  ds_read_b64_tr_b16 v[196:197], v245 offset:1024
  ds_read_b64_tr_b16 v[198:199], v245 offset:1536
  s_waitcnt vmcnt(11)
  s_waitcnt lgkmcnt(8)
  v_mfma_f32_32x32x16_bf16 v[120:135], v[200:203], v[64:67], v[120:135]
  ds_read_b64_tr_b16 v[200:201], v245 offset:4096
  ds_read_b64_tr_b16 v[202:203], v245 offset:4608
  v_mfma_f32_32x32x16_bf16 v[136:151], v[204:207], v[64:67], v[136:151]
  buffer_load_dwordx4 v[112:115], v1, s[28:31], s59 offen offset:2048
  ds_read_b64_tr_b16 v[204:205], v245 offset:5120
  ds_read_b64_tr_b16 v[206:207], v245 offset:5632
  s_waitcnt vmcnt(11)
  s_waitcnt lgkmcnt(8)
  v_mfma_f32_32x32x16_bf16 v[120:135], v[184:187], v[68:71], v[120:135]
  ds_read_b64_tr_b16 v[184:185], v245 offset:8192
  ds_read_b64_tr_b16 v[186:187], v245 offset:8704
  v_mfma_f32_32x32x16_bf16 v[136:151], v[188:191], v[68:71], v[136:151]
  buffer_load_dwordx4 v[116:119], v1, s[28:31], s59 offen offset:3072
  ds_read_b64_tr_b16 v[188:189], v245 offset:9216
  ds_read_b64_tr_b16 v[190:191], v245 offset:9728
  s_waitcnt vmcnt(11)
  s_waitcnt lgkmcnt(8)
  v_mfma_f32_32x32x16_bf16 v[120:135], v[192:195], v[72:75], v[120:135]
  ds_read_b64_tr_b16 v[192:193], v245 offset:12288
  ds_read_b64_tr_b16 v[194:195], v245 offset:12800
  v_mfma_f32_32x32x16_bf16 v[136:151], v[196:199], v[72:75], v[136:151]
  v_and_b32 v208, 31, v0
  v_lshlrev_b32 v208, 3, v208
  v_lshrrev_b32 v209, 5, v0
  v_mul_u32_u24 v209, 1792, v209
  v_add_u32 v208, v208, v209
  s_mul_i32 s60, s54, 3584
  s_add_u32 s60, s60, s46
  s_add_u32 s60, s60, 30408704
  buffer_load_dwordx2 v[224:225], v208, s[28:31], s60 offen offset:0
  buffer_load_dwordx2 v[226:227], v208, s[28:31], s60 offen offset:256
  buffer_load_dwordx2 v[228:229], v208, s[28:31], s60 offen offset:512
  buffer_load_dwordx2 v[230:231], v208, s[28:31], s60 offen offset:768
  buffer_load_dwordx2 v[232:233], v208, s[28:31], s60 offen offset:1024
  buffer_load_dwordx2 v[234:235], v208, s[28:31], s60 offen offset:1280
  buffer_load_dwordx2 v[236:237], v208, s[28:31], s60 offen offset:1536
  ds_read_b64_tr_b16 v[196:197], v245 offset:13312
  ds_read_b64_tr_b16 v[198:199], v245 offset:13824
  s_waitcnt vmcnt(17)
  s_waitcnt lgkmcnt(8)
  v_mfma_f32_32x32x16_bf16 v[120:135], v[200:203], v[76:79], v[120:135]
  ds_read_b64_tr_b16 v[200:201], v245 offset:16384
  ds_read_b64_tr_b16 v[202:203], v245 offset:16896
  v_mfma_f32_32x32x16_bf16 v[136:151], v[204:207], v[76:79], v[136:151]
  ds_read_b64_tr_b16 v[204:205], v245 offset:17408
  ds_read_b64_tr_b16 v[206:207], v245 offset:17920
  s_waitcnt vmcnt(16)
  s_waitcnt lgkmcnt(8)
  v_mfma_f32_32x32x16_bf16 v[120:135], v[184:187], v[80:83], v[120:135]
  ds_read_b64_tr_b16 v[184:185], v245 offset:20480
  ds_read_b64_tr_b16 v[186:187], v245 offset:20992
  v_mfma_f32_32x32x16_bf16 v[136:151], v[188:191], v[80:83], v[136:151]
  ds_read_b64_tr_b16 v[188:189], v245 offset:21504
  ds_read_b64_tr_b16 v[190:191], v245 offset:22016
  s_waitcnt vmcnt(15)
  s_waitcnt lgkmcnt(8)
  v_mfma_f32_32x32x16_bf16 v[120:135], v[192:195], v[84:87], v[120:135]
  ds_read_b64_tr_b16 v[192:193], v245 offset:24576
  ds_read_b64_tr_b16 v[194:195], v245 offset:25088
  v_mfma_f32_32x32x16_bf16 v[136:151], v[196:199], v[84:87], v[136:151]
  ds_read_b64_tr_b16 v[196:197], v245 offset:25600
  ds_read_b64_tr_b16 v[198:199], v245 offset:26112
  s_waitcnt vmcnt(14)
  s_waitcnt lgkmcnt(8)
  v_mfma_f32_32x32x16_bf16 v[120:135], v[200:203], v[88:91], v[120:135]
  ds_read_b64_tr_b16 v[200:201], v245 offset:28672
  ds_read_b64_tr_b16 v[202:203], v245 offset:29184
  v_mfma_f32_32x32x16_bf16 v[136:151], v[204:207], v[88:91], v[136:151]
  ds_read_b64_tr_b16 v[204:205], v245 offset:29696
  ds_read_b64_tr_b16 v[206:207], v245 offset:30208
  s_waitcnt vmcnt(13)
  s_waitcnt lgkmcnt(8)
  v_mfma_f32_32x32x16_bf16 v[120:135], v[184:187], v[92:95], v[120:135]
  ds_read_b64_tr_b16 v[184:185], v243 offset:0
  ds_read_b64_tr_b16 v[186:187], v243 offset:512
  v_mfma_f32_32x32x16_bf16 v[136:151], v[188:191], v[92:95], v[136:151]
  ds_read_b64_tr_b16 v[188:189], v243 offset:1024
  ds_read_b64_tr_b16 v[190:191], v243 offset:1536
  s_waitcnt vmcnt(12)
  s_waitcnt lgkmcnt(8)
  v_mfma_f32_32x32x16_bf16 v[120:135], v[192:195], v[96:99], v[120:135]
  ds_read_b64_tr_b16 v[192:193], v243 offset:4096
  ds_read_b64_tr_b16 v[194:195], v243 offset:4608
  v_mfma_f32_32x32x16_bf16 v[136:151], v[196:199], v[96:99], v[136:151]
  ds_read_b64_tr_b16 v[196:197], v243 offset:5120
  ds_read_b64_tr_b16 v[198:199], v243 offset:5632
  s_waitcnt vmcnt(11)
  s_waitcnt lgkmcnt(8)
  v_mfma_f32_32x32x16_bf16 v[120:135], v[200:203], v[100:103], v[120:135]
  ds_read_b64_tr_b16 v[200:201], v243 offset:8192
  ds_read_b64_tr_b16 v[202:203], v243 offset:8704
  v_mfma_f32_32x32x16_bf16 v[136:151], v[204:207], v[100:103], v[136:151]
  ds_read_b64_tr_b16 v[204:205], v243 offset:9216
  ds_read_b64_tr_b16 v[206:207], v243 offset:9728
  s_waitcnt vmcnt(10)
  s_waitcnt lgkmcnt(8)
  v_mfma_f32_32x32x16_bf16 v[120:135], v[184:187], v[104:107], v[120:135]
  ds_read_b64_tr_b16 v[184:185], v243 offset:12288
  ds_read_b64_tr_b16 v[186:187], v243 offset:12800
  v_mfma_f32_32x32x16_bf16 v[136:151], v[188:191], v[104:107], v[136:151]
  ds_read_b64_tr_b16 v[188:189], v243 offset:13312
  ds_read_b64_tr_b16 v[190:191], v243 offset:13824
  s_waitcnt vmcnt(9)
  s_waitcnt lgkmcnt(8)
  v_mfma_f32_32x32x16_bf16 v[120:135], v[192:195], v[108:111], v[120:135]
  v_mfma_f32_32x32x16_bf16 v[136:151], v[196:199], v[108:111], v[136:151]
  s_waitcnt vmcnt(8)
  s_waitcnt lgkmcnt(4)
  v_mfma_f32_32x32x16_bf16 v[120:135], v[200:203], v[112:115], v[120:135]
  v_mfma_f32_32x32x16_bf16 v[136:151], v[204:207], v[112:115], v[136:151]
  s_waitcnt vmcnt(7)
  s_waitcnt lgkmcnt(0)
  v_mfma_f32_32x32x16_bf16 v[120:135], v[184:187], v[116:119], v[120:135]
  v_mfma_f32_32x32x16_bf16 v[136:151], v[188:191], v[116:119], v[136:151]
  s_waitcnt vmcnt(0)
  s_cmp_lg_u32 s45, 0
  s_cbranch_scc1 L_cs4b_41
  s_mov_b32 s76, 0
L_cs4c_42:
  s_waitcnt vmcnt(0)
  v_xor_b32 v209, v250, v251
  v_xor_b32 v210, v252, v253
  s_lshl_b32 s77, s40, 1
  s_or_b32 s77, s77, 1
  v_cmp_eq_u32 vcc, s77, v209
  v_cmp_eq_u32 s[74:75], s77, v210
  s_nop 2
  s_and_b64 vcc, vcc, s[74:75]
  s_cmp_eq_u64 vcc, -1
  s_cbranch_scc1 L_cs4d_43
  v_lshlrev_b32 v208, 3, v0
  s_lshl_b32 s60, s53, 9
  s_add_u32 s61, s60, 31260672
  s_add_u32 s60, s60, 31267840
  buffer_load_dwordx2 v[250:251], v208, s[28:31], s60 offen sc1
  buffer_load_dwordx2 v[252:253], v208, s[28:31], s61 offen sc1
  s_add_u32 s76, s76, 1
  s_cmp_lt_u32 s76, 0x40000
  s_cbranch_scc1 L_cs4c_42
L_cs4d_43:
  v_lshlrev_b32 v208, 2, v0
  v_add_u32 v208, 160256, v208
  ds_write_b32 v208, v250
  ds_write_b32 v208, v252 offset:256
  s_waitcnt lgkmcnt(0)
L_cs4b_41:
  v_pk_add_f32 v[224:225], v[224:225], v[226:227]
  v_pk_add_f32 v[228:229], v[228:229], v[230:231]
  v_pk_add_f32 v[232:233], v[232:233], v[234:235]
  v_pk_add_f32 v[224:225], v[224:225], v[236:237]
  v_pk_add_f32 v[228:229], v[228:229], v[232:233]
  v_pk_add_f32 v[224:225], v[224:225], v[228:229]
  v_mov_b32 v250, v224
  v_mov_b32 v252, v225
  v_mov_b32 v208, v250
  v_mov_b32 v209, v250
  s_nop 1
  v_permlane32_swap_b32 v208, v209
  v_add_f32 v250, v208, v209
  v_mov_b32 v208, v252
  v_mov_b32 v209, v252
  s_nop 1
  v_permlane32_swap_b32 v208, v209
  v_add_f32 v252, v208, v209
  v_mul_f32 v240, 0xbb124925, v250
  v_mul_f32 v242, 0x3b124925, v252
  v_fma_f32 v242, -v240, v240, v242
  v_max_f32 v242, 0, v242
  v_add_f32 v242, 0x3727c5ac, v242
  v_rsq_f32 v242, v242
  ds_read_b128 v[208:211], v249 offset:0
  ds_read_b128 v[212:215], v249 offset:32
  ds_read_b128 v[216:219], v249 offset:64
  ds_read_b128 v[220:223], v249 offset:96
  s_waitcnt lgkmcnt(0)
  v_pk_fma_f32 v[120:121], v[208:209], v[240:241], v[120:121] op_sel_hi:[1,0,1]
  v_pk_fma_f32 v[122:123], v[210:211], v[240:241], v[122:123] op_sel_hi:[1,0,1]
  v_pk_fma_f32 v[124:125], v[212:213], v[240:241], v[124:125] op_sel_hi:[1,0,1]
  v_pk_fma_f32 v[126:127], v[214:215], v[240:241], v[126:127] op_sel_hi:[1,0,1]
  v_pk_fma_f32 v[128:129], v[216:217], v[240:241], v[128:129] op_sel_hi:[1,0,1]
  v_pk_fma_f32 v[130:131], v[218:219], v[240:241], v[130:131] op_sel_hi:[1,0,1]
  v_pk_fma_f32 v[132:133], v[220:221], v[240:241], v[132:133] op_sel_hi:[1,0,1]
  v_pk_fma_f32 v[134:135], v[222:223], v[240:241], v[134:135] op_sel_hi:[1,0,1]
  v_pk_mul_f32 v[120:121], v[120:121], v[242:243] op_sel_hi:[1,0]
  v_pk_mul_f32 v[122:123], v[122:123], v[242:243] op_sel_hi:[1,0]
  v_pk_mul_f32 v[124:125], v[124:125], v[242:243] op_sel_hi:[1,0]
  v_pk_mul_f32 v[126:127], v[126:127], v[242:243] op_sel_hi:[1,0]
  v_pk_mul_f32 v[128:129], v[128:129], v[242:243] op_sel_hi:[1,0]
  v_pk_mul_f32 v[130:131], v[130:131], v[242:243] op_sel_hi:[1,0]
  v_pk_mul_f32 v[132:133], v[132:133], v[242:243] op_sel_hi:[1,0]
  v_pk_mul_f32 v[134:135], v[134:135], v[242:243] op_sel_hi:[1,0]
  v_pk_mul_f32 v[224:225], v[120:121], v[120:121]
  v_pk_mul_f32 v[226:227], v[122:123], v[122:123]
  v_pk_mul_f32 v[228:229], v[124:125], v[124:125]
  v_pk_mul_f32 v[230:231], v[126:127], v[126:127]
  v_pk_mul_f32 v[232:233], v[128:129], v[128:129]
  v_pk_mul_f32 v[234:235], v[130:131], v[130:131]
  v_pk_mul_f32 v[236:237], v[132:133], v[132:133]
  v_pk_mul_f32 v[238:239], v[134:135], v[134:135]
  v_pk_fma_f32 v[224:225], v[224:225], v[246:247], v[244:245] op_sel_hi:[1,0,0]
  v_pk_fma_f32 v[226:227], v[226:227], v[246:247], v[244:245] op_sel_hi:[1,0,0]
  v_pk_fma_f32 v[228:229], v[228:229], v[246:247], v[244:245] op_sel_hi:[1,0,0]
  v_pk_fma_f32 v[230:231], v[230:231], v[246:247], v[244:245] op_sel_hi:[1,0,0]
  v_pk_fma_f32 v[232:233], v[232:233], v[246:247], v[244:245] op_sel_hi:[1,0,0]
  v_pk_fma_f32 v[234:235], v[234:235], v[246:247], v[244:245] op_sel_hi:[1,0,0]
  v_pk_fma_f32 v[236:237], v[236:237], v[246:247], v[244:245] op_sel_hi:[1,0,0]
  v_pk_fma_f32 v[238:239], v[238:239], v[246:247], v[244:245] op_sel_hi:[1,0,0]
  v_pk_mul_f32 v[224:225], v[120:121], v[224:225]
  v_pk_mul_f32 v[226:227], v[122:123], v[226:227]
  v_pk_mul_f32 v[228:229], v[124:125], v[228:229]
  v_pk_mul_f32 v[230:231], v[126:127], v[230:231]
  v_pk_mul_f32 v[232:233], v[128:129], v[232:233]
  v_pk_mul_f32 v[234:235], v[130:131], v[234:235]
  v_pk_mul_f32 v[236:237], v[132:133], v[236:237]
  v_pk_mul_f32 v[238:239], v[134:135], v[238:239]
  v_exp_f32 v224, v224
  v_exp_f32 v225, v225
  v_exp_f32 v226, v226
  v_exp_f32 v227, v227
  v_exp_f32 v228, v228
  v_exp_f32 v229, v229
  v_exp_f32 v230, v230
  v_exp_f32 v231, v231
  v_exp_f32 v232, v232
  v_exp_f32 v233, v233
  v_exp_f32 v234, v234
  v_exp_f32 v235, v235
  v_exp_f32 v236, v236
  v_exp_f32 v237, v237
  v_exp_f32 v238, v238
  v_exp_f32 v239, v239
  v_pk_add_f32 v[224:225], v[224:225], v[248:249] op_sel_hi:[1,0]
  v_pk_add_f32 v[226:227], v[226:227], v[248:249] op_sel_hi:[1,0]
  v_pk_add_f32 v[228:229], v[228:229], v[248:249] op_sel_hi:[1,0]
  v_pk_add_f32 v[230:231], v[230:231], v[248:249] op_sel_hi:[1,0]
  v_pk_add_f32 v[232:233], v[232:233], v[248:249] op_sel_hi:[1,0]
  v_pk_add_f32 v[234:235], v[234:235], v[248:249] op_sel_hi:[1,0]
  v_pk_add_f32 v[236:237], v[236:237], v[248:249] op_sel_hi:[1,0]
  v_pk_add_f32 v[238:239], v[238:239], v[248:249] op_sel_hi:[1,0]
  v_rcp_f32 v224, v224
  v_rcp_f32 v225, v225
  v_rcp_f32 v226, v226
  v_rcp_f32 v227, v227
  v_rcp_f32 v228, v228
  v_rcp_f32 v229, v229
  v_rcp_f32 v230, v230
  v_rcp_f32 v231, v231
  v_rcp_f32 v232, v232
  v_rcp_f32 v233, v233
  v_rcp_f32 v234, v234
  v_rcp_f32 v235, v235
  v_rcp_f32 v236, v236
  v_rcp_f32 v237, v237
  v_rcp_f32 v238, v238
  v_rcp_f32 v239, v239
  v_pk_mul_f32 v[120:121], v[120:121], v[224:225]
  v_pk_mul_f32 v[122:123], v[122:123], v[226:227]
  v_pk_mul_f32 v[124:125], v[124:125], v[228:229]
  v_pk_mul_f32 v[126:127], v[126:127], v[230:231]
  v_pk_mul_f32 v[128:129], v[128:129], v[232:233]
  v_pk_mul_f32 v[130:131], v[130:131], v[234:235]
  v_pk_mul_f32 v[132:133], v[132:133], v[236:237]
  v_pk_mul_f32 v[134:135], v[134:135], v[238:239]
  v_pk_mul_f32 v[252:253], v[120:121], v[120:121]
  v_pk_add_f32 v[250:251], v[120:121], v[122:123]
  v_pk_fma_f32 v[252:253], v[122:123], v[122:123], v[252:253]
  v_pk_fma_f32 v[252:253], v[124:125], v[124:125], v[252:253]
  v_pk_add_f32 v[250:251], v[250:251], v[124:125]
  v_pk_fma_f32 v[252:253], v[126:127], v[126:127], v[252:253]
  v_pk_add_f32 v[250:251], v[250:251], v[126:127]
  v_pk_fma_f32 v[252:253], v[128:129], v[128:129], v[252:253]
  v_pk_add_f32 v[250:251], v[250:251], v[128:129]
  v_pk_fma_f32 v[252:253], v[130:131], v[130:131], v[252:253]
  v_pk_add_f32 v[250:251], v[250:251], v[130:131]
  v_pk_fma_f32 v[252:253], v[132:133], v[132:133], v[252:253]
  v_pk_add_f32 v[250:251], v[250:251], v[132:133]
  v_pk_fma_f32 v[252:253], v[134:135], v[134:135], v[252:253]
  v_pk_add_f32 v[250:251], v[250:251], v[134:135]
  ds_read_b128 v[208:211], v249 offset:128
  ds_read_b128 v[212:215], v249 offset:160
  ds_read_b128 v[216:219], v249 offset:192
  ds_read_b128 v[220:223], v249 offset:224
  s_waitcnt lgkmcnt(0)
  v_pk_fma_f32 v[136:137], v[208:209], v[240:241], v[136:137] op_sel_hi:[1,0,1]
  v_pk_fma_f32 v[138:139], v[210:211], v[240:241], v[138:139] op_sel_hi:[1,0,1]
  v_pk_fma_f32 v[140:141], v[212:213], v[240:241], v[140:141] op_sel_hi:[1,0,1]
  v_pk_fma_f32 v[142:143], v[214:215], v[240:241], v[142:143] op_sel_hi:[1,0,1]
  v_pk_fma_f32 v[144:145], v[216:217], v[240:241], v[144:145] op_sel_hi:[1,0,1]
  v_pk_fma_f32 v[146:147], v[218:219], v[240:241], v[146:147] op_sel_hi:[1,0,1]
  v_pk_fma_f32 v[148:149], v[220:221], v[240:241], v[148:149] op_sel_hi:[1,0,1]
  v_pk_fma_f32 v[150:151], v[222:223], v[240:241], v[150:151] op_sel_hi:[1,0,1]
  v_pk_mul_f32 v[136:137], v[136:137], v[242:243] op_sel_hi:[1,0]
  v_pk_mul_f32 v[138:139], v[138:139], v[242:243] op_sel_hi:[1,0]
  v_pk_mul_f32 v[140:141], v[140:141], v[242:243] op_sel_hi:[1,0]
  v_pk_mul_f32 v[142:143], v[142:143], v[242:243] op_sel_hi:[1,0]
  v_pk_mul_f32 v[144:145], v[144:145], v[242:243] op_sel_hi:[1,0]
  v_pk_mul_f32 v[146:147], v[146:147], v[242:243] op_sel_hi:[1,0]
  v_pk_mul_f32 v[148:149], v[148:149], v[242:243] op_sel_hi:[1,0]
  v_pk_mul_f32 v[150:151], v[150:151], v[242:243] op_sel_hi:[1,0]
  v_pk_mul_f32 v[224:225], v[136:137], v[136:137]
  v_pk_mul_f32 v[226:227], v[138:139], v[138:139]
  v_pk_mul_f32 v[228:229], v[140:141], v[140:141]
  v_pk_mul_f32 v[230:231], v[142:143], v[142:143]
  v_pk_mul_f32 v[232:233], v[144:145], v[144:145]
  v_pk_mul_f32 v[234:235], v[146:147], v[146:147]
  v_pk_mul_f32 v[236:237], v[148:149], v[148:149]
  v_pk_mul_f32 v[238:239], v[150:151], v[150:151]
  v_pk_fma_f32 v[224:225], v[224:225], v[246:247], v[244:245] op_sel_hi:[1,0,0]
  v_pk_fma_f32 v[226:227], v[226:227], v[246:247], v[244:245] op_sel_hi:[1,0,0]
  v_pk_fma_f32 v[228:229], v[228:229], v[246:247], v[244:245] op_sel_hi:[1,0,0]
  v_pk_fma_f32 v[230:231], v[230:231], v[246:247], v[244:245] op_sel_hi:[1,0,0]
  v_pk_fma_f32 v[232:233], v[232:233], v[246:247], v[244:245] op_sel_hi:[1,0,0]
  v_pk_fma_f32 v[234:235], v[234:235], v[246:247], v[244:245] op_sel_hi:[1,0,0]
  v_pk_fma_f32 v[236:237], v[236:237], v[246:247], v[244:245] op_sel_hi:[1,0,0]
  v_pk_fma_f32 v[238:239], v[238:239], v[246:247], v[244:245] op_sel_hi:[1,0,0]
  v_pk_mul_f32 v[224:225], v[136:137], v[224:225]
  v_pk_mul_f32 v[226:227], v[138:139], v[226:227]
  v_pk_mul_f32 v[228:229], v[140:141], v[228:229]
  v_pk_mul_f32 v[230:231], v[142:143], v[230:231]
  v_pk_mul_f32 v[232:233], v[144:145], v[232:233]
  v_pk_mul_f32 v[234:235], v[146:147], v[234:235]
  v_pk_mul_f32 v[236:237], v[148:149], v[236:237]
  v_pk_mul_f32 v[238:239], v[150:151], v[238:239]
  v_exp_f32 v224, v224
  v_exp_f32 v225, v225
  v_exp_f32 v226, v226
  v_exp_f32 v227, v227
  v_exp_f32 v228, v228
  v_exp_f32 v229, v229
  v_exp_f32 v230, v230
  v_exp_f32 v231, v231
  v_exp_f32 v232, v232
  v_exp_f32 v233, v233
  v_exp_f32 v234, v234
  v_exp_f32 v235, v235
  v_exp_f32 v236, v236
  v_exp_f32 v237, v237
  v_exp_f32 v238, v238
  v_exp_f32 v239, v239
  v_pk_add_f32 v[224:225], v[224:225], v[248:249] op_sel_hi:[1,0]
  v_pk_add_f32 v[226:227], v[226:227], v[248:249] op_sel_hi:[1,0]
  v_pk_add_f32 v[228:229], v[228:229], v[248:249] op_sel_hi:[1,0]
  v_pk_add_f32 v[230:231], v[230:231], v[248:249] op_sel_hi:[1,0]
  v_pk_add_f32 v[232:233], v[232:233], v[248:249] op_sel_hi:[1,0]
  v_pk_add_f32 v[234:235], v[234:235], v[248:249] op_sel_hi:[1,0]
  v_pk_add_f32 v[236:237], v[236:237], v[248:249] op_sel_hi:[1,0]
  v_pk_add_f32 v[238:239], v[238:239], v[248:249] op_sel_hi:[1,0]
  v_rcp_f32 v224, v224
  v_rcp_f32 v225, v225
  v_rcp_f32 v226, v226
  v_rcp_f32 v227, v227
  v_rcp_f32 v228, v228
  v_rcp_f32 v229, v229
  v_rcp_f32 v230, v230
  v_rcp_f32 v231, v231
  v_rcp_f32 v232, v232
  v_rcp_f32 v233, v233
  v_rcp_f32 v234, v234
  v_rcp_f32 v235, v235
  v_rcp_f32 v236, v236
  v_rcp_f32 v237, v237
  v_rcp_f32 v238, v238
  v_rcp_f32 v239, v239
  v_pk_mul_f32 v[136:137], v[136:137], v[224:225]
  v_pk_mul_f32 v[138:139], v[138:139], v[226:227]
  v_pk_mul_f32 v[140:141], v[140:141], v[228:229]
  v_pk_mul_f32 v[142:143], v[142:143], v[230:231]
  v_pk_mul_f32 v[144:145], v[144:145], v[232:233]
  v_pk_mul_f32 v[146:147], v[146:147], v[234:235]
  v_pk_mul_f32 v[148:149], v[148:149], v[236:237]
  v_pk_mul_f32 v[150:151], v[150:151], v[238:239]
  v_pk_fma_f32 v[252:253], v[136:137], v[136:137], v[252:253]
  v_pk_add_f32 v[250:251], v[250:251], v[136:137]
  v_pk_fma_f32 v[252:253], v[138:139], v[138:139], v[252:253]
  v_pk_add_f32 v[250:251], v[250:251], v[138:139]
  v_pk_fma_f32 v[252:253], v[140:141], v[140:141], v[252:253]
  v_pk_add_f32 v[250:251], v[250:251], v[140:141]
  v_pk_fma_f32 v[252:253], v[142:143], v[142:143], v[252:253]
  v_pk_add_f32 v[250:251], v[250:251], v[142:143]
  v_pk_fma_f32 v[252:253], v[144:145], v[144:145], v[252:253]
  v_pk_add_f32 v[250:251], v[250:251], v[144:145]
  v_pk_fma_f32 v[252:253], v[146:147], v[146:147], v[252:253]
  v_pk_add_f32 v[250:251], v[250:251], v[146:147]
  v_pk_fma_f32 v[252:253], v[148:149], v[148:149], v[252:253]
  v_pk_add_f32 v[250:251], v[250:251], v[148:149]
  v_pk_fma_f32 v[252:253], v[150:151], v[150:151], v[252:253]
  v_pk_add_f32 v[250:251], v[250:251], v[150:151]
  v_add_f32 v250, v250, v251
  v_add_f32 v252, v252, v253
  v_mov_b32 v224, v250
  v_mov_b32 v225, v250
  s_nop 1
  v_permlane32_swap_b32 v224, v225
  v_add_f32 v250, v224, v225
  v_mov_b32 v224, v252
  v_mov_b32 v225, v252
  s_nop 1
  v_permlane32_swap_b32 v224, v225
  v_add_f32 v252, v224, v225
  v_mov_b32 v251, v252
  s_mul_i32 s55, s54, 14
  s_add_u32 s55, s55, s53
  s_lshl_b32 s55, s55, 8
  s_add_u32 s55, s55, s46
  s_add_u32 s55, s55, 30932992
  v_and_b32 v224, 31, v0
  v_lshlrev_b32 v224, 3, v224
  buffer_store_dwordx2 v[250:251], v224, s[28:31], s55 offen sc1
  s_mov_b32 s36, s18
  s_mov_b32 s37, s19
  s_mov_b32 s38, 802816
  s_mov_b32 s39, 0x20000
  v_lshrrev_b32 v4, 2, v0
  v_mul_u32_u24 v4, 896, v4
  v_and_b32 v5, 3, v0
  v_lshl_add_u32 v4, v5, 4, v4
  s_mul_i32 s68, s44, 37
  s_lshr_b32 s68, s68, 8
  s_mul_i32 s68, s68, 7
  s_sub_u32 s68, s44, s68
  s_lshl_b32 s68, s68, 7
  ds_read_b64_tr_b16 v[184:185], v241 offset:2048
  ds_read_b64_tr_b16 v[186:187], v241 offset:2560
  ds_read_b64_tr_b16 v[188:189], v241 offset:6144
  ds_read_b64_tr_b16 v[190:191], v241 offset:6656
  ds_read_b64_tr_b16 v[192:193], v241 offset:10240
  ds_read_b64_tr_b16 v[194:195], v241 offset:10752
  ds_read_b64_tr_b16 v[196:197], v241 offset:14336
  ds_read_b64_tr_b16 v[198:199], v241 offset:14848
  ds_read_b64_tr_b16 v[200:201], v241 offset:18432
  ds_read_b64_tr_b16 v[202:203], v241 offset:18944
  ds_read_b64_tr_b16 v[204:205], v241 offset:22528
  ds_read_b64_tr_b16 v[206:207], v241 offset:23040
  s_waitcnt lgkmcnt(8)
  v_mfma_f32_32x32x16_bf16 v[152:167], v[184:187], v[8:11], 0
  ds_read_b64_tr_b16 v[184:185], v241 offset:26624
  ds_read_b64_tr_b16 v[186:187], v241 offset:27136
  v_mfma_f32_32x32x16_bf16 v[152:167], v[188:191], v[12:15], v[152:167]
  ds_read_b64_tr_b16 v[188:189], v241 offset:30720
  ds_read_b64_tr_b16 v[190:191], v241 offset:31232
  s_waitcnt lgkmcnt(8)
  v_mfma_f32_32x32x16_bf16 v[152:167], v[192:195], v[16:19], v[152:167]
  ds_read_b64_tr_b16 v[192:193], v241 offset:34816
  ds_read_b64_tr_b16 v[194:195], v241 offset:35328
  v_mfma_f32_32x32x16_bf16 v[152:167], v[196:199], v[20:23], v[152:167]
  ds_read_b64_tr_b16 v[196:197], v241 offset:38912
  ds_read_b64_tr_b16 v[198:199], v241 offset:39424
  s_waitcnt lgkmcnt(8)
  v_mfma_f32_32x32x16_bf16 v[152:167], v[200:203], v[24:27], v[152:167]
  ds_read_b64_tr_b16 v[200:201], v241 offset:43008
  ds_read_b64_tr_b16 v[202:203], v241 offset:43520
  v_mfma_f32_32x32x16_bf16 v[152:167], v[204:207], v[28:31], v[152:167]
  ds_read_b64_tr_b16 v[204:205], v241 offset:47104
  ds_read_b64_tr_b16 v[206:207], v241 offset:47616
  s_waitcnt lgkmcnt(8)
  v_mfma_f32_32x32x16_bf16 v[152:167], v[184:187], v[32:35], v[152:167]
  ds_read_b64_tr_b16 v[184:185], v241 offset:51200
  ds_read_b64_tr_b16 v[186:187], v241 offset:51712
  v_mfma_f32_32x32x16_bf16 v[152:167], v[188:191], v[36:39], v[152:167]
  ds_read_b64_tr_b16 v[188:189], v241 offset:55296
  ds_read_b64_tr_b16 v[190:191], v241 offset:55808
  s_waitcnt lgkmcnt(8)
  v_mfma_f32_32x32x16_bf16 v[152:167], v[192:195], v[40:43], v[152:167]
  ds_read_b64_tr_b16 v[192:193], v241 offset:59392
  ds_read_b64_tr_b16 v[194:195], v241 offset:59904
  v_mfma_f32_32x32x16_bf16 v[152:167], v[196:199], v[44:47], v[152:167]
  ds_read_b64_tr_b16 v[196:197], v241 offset:63488
  ds_read_b64_tr_b16 v[198:199], v241 offset:64000
  s_waitcnt lgkmcnt(8)
  v_mfma_f32_32x32x16_bf16 v[152:167], v[200:203], v[48:51], v[152:167]
  ds_read_b64_tr_b16 v[200:201], v245 offset:2048
  ds_read_b64_tr_b16 v[202:203], v245 offset:2560
  v_mfma_f32_32x32x16_bf16 v[152:167], v[204:207], v[52:55], v[152:167]
  ds_read_b64_tr_b16 v[204:205], v245 offset:6144
  ds_read_b64_tr_b16 v[206:207], v245 offset:6656
  s_waitcnt lgkmcnt(8)
  v_mfma_f32_32x32x16_bf16 v[152:167], v[184:187], v[56:59], v[152:167]
  ds_read_b64_tr_b16 v[184:185], v245 offset:10240
  ds_read_b64_tr_b16 v[186:187], v245 offset:10752
  v_mfma_f32_32x32x16_bf16 v[152:167], v[188:191], v[60:63], v[152:167]
  ds_read_b64_tr_b16 v[188:189], v245 offset:14336
  ds_read_b64_tr_b16 v[190:191], v245 offset:14848
  s_waitcnt lgkmcnt(8)
  v_mfma_f32_32x32x16_bf16 v[152:167], v[192:195], v[64:67], v[152:167]
  ds_read_b64_tr_b16 v[192:193], v245 offset:18432
  ds_read_b64_tr_b16 v[194:195], v245 offset:18944
  v_mfma_f32_32x32x16_bf16 v[152:167], v[196:199], v[68:71], v[152:167]
  ds_read_b64_tr_b16 v[196:197], v245 offset:22528
  ds_read_b64_tr_b16 v[198:199], v245 offset:23040
  s_waitcnt lgkmcnt(8)
  v_mfma_f32_32x32x16_bf16 v[152:167], v[200:203], v[72:75], v[152:167]
  s_waitcnt vmcnt(0)
  s_barrier
  s_lshl_b32 s55, s52, 7
  s_lshl_b32 s60, s53, 3
  s_add_u32 s55, s55, s60
  s_add_u32 s55, s55, s46
  s_add_u32 s55, s55, 31469568
  s_cmp_lg_u32 s42, 0
  s_cbranch_scc1 L_pub_44
  v_mov_b32 v228, s40
  v_mov_b32 v229, s41
  v_mov_b32 v230, 0
  s_mov_b64 exec, 1
  s_cmp_eq_u32 s47, 0
  s_cbranch_scc1 L_stg_45
  buffer_store_dwordx2 v[228:229], v230, s[28:31], s55 offen
  s_branch L_std_46
L_stg_45:
  buffer_store_dwordx2 v[228:229], v230, s[28:31], s55 offen sc1
L_std_46:
  s_mov_b64 exec, -1
L_pub_44:
  ds_read_b64_tr_b16 v[200:201], v245 offset:26624
  ds_read_b64_tr_b16 v[202:203], v245 offset:27136
  v_mfma_f32_32x32x16_bf16 v[152:167], v[204:207], v[76:79], v[152:167]
  ds_read_b64_tr_b16 v[204:205], v245 offset:30720
  ds_read_b64_tr_b16 v[206:207], v245 offset:31232
  s_waitcnt lgkmcnt(8)
  v_mfma_f32_32x32x16_bf16 v[152:167], v[184:187], v[80:83], v[152:167]
  ds_read_b64_tr_b16 v[184:185], v243 offset:2048
  ds_read_b64_tr_b16 v[186:187], v243 offset:2560
  v_mfma_f32_32x32x16_bf16 v[152:167], v[188:191], v[84:87], v[152:167]
  s_add_u32 s69, s42, 0
  s_mul_i32 s70, s69, 14336
  s_add_u32 s70, s70, s68
  s_mul_i32 s71, s69, 2048
  s_add_u32 m0, s71, 0
  s_add_u32 s72, s70, 0
  buffer_load_dwordx4 v4, s[36:39], s72 offen lds
  ds_read_b64_tr_b16 v[188:189], v243 offset:6144
  ds_read_b64_tr_b16 v[190:191], v243 offset:6656
  s_waitcnt lgkmcnt(8)
  v_mfma_f32_32x32x16_bf16 v[152:167], v[192:195], v[88:91], v[152:167]
  ds_read_b64_tr_b16 v[192:193], v243 offset:10240
  ds_read_b64_tr_b16 v[194:195], v243 offset:10752
  v_mfma_f32_32x32x16_bf16 v[152:167], v[196:199], v[92:95], v[152:167]
  ds_read_b64_tr_b16 v[196:197], v243 offset:14336
  ds_read_b64_tr_b16 v[198:199], v243 offset:14848
  s_waitcnt lgkmcnt(8)
  v_mfma_f32_32x32x16_bf16 v[152:167], v[200:203], v[96:99], v[152:167]
  s_add_u32 m0, s71, 1024
  s_add_u32 s72, s70, 64
  buffer_load_dwordx4 v4, s[36:39], s72 offen lds
  v_mfma_f32_32x32x16_bf16 v[152:167], v[204:207], v[100:103], v[152:167]
  s_waitcnt lgkmcnt(4)
  v_mfma_f32_32x32x16_bf16 v[152:167], v[184:187], v[104:107], v[152:167]
  v_mfma_f32_32x32x16_bf16 v[152:167], v[188:191], v[108:111], v[152:167]
  s_add_u32 s69, s42, 4
  s_mul_i32 s70, s69, 14336
  s_add_u32 s70, s70, s68
  s_mul_i32 s71, s69, 2048
  s_add_u32 m0, s71, 0
  s_add_u32 s72, s70, 0
  buffer_load_dwordx4 v4, s[36:39], s72 offen lds
  s_waitcnt lgkmcnt(0)
  v_mfma_f32_32x32x16_bf16 v[152:167], v[192:195], v[112:115], v[152:167]
  v_mfma_f32_32x32x16_bf16 v[152:167], v[196:199], v[116:119], v[152:167]
  ds_read_b64_tr_b16 v[184:185], v241 offset:3072
  ds_read_b64_tr_b16 v[186:187], v241 offset:3584
  ds_read_b64_tr_b16 v[188:189], v241 offset:7168
  ds_read_b64_tr_b16 v[190:191], v241 offset:7680
  ds_read_b64_tr_b16 v[192:193], v241 offset:11264
  ds_read_b64_tr_b16 v[194:195], v241 offset:11776
  ds_read_b64_tr_b16 v[196:197], v241 offset:15360
  ds_read_b64_tr_b16 v[198:199], v241 offset:15872
  ds_read_b64_tr_b16 v[200:201], v241 offset:19456
  ds_read_b64_tr_b16 v[202:203], v241 offset:19968
  ds_read_b64_tr_b16 v[204:205], v241 offset:23552
  ds_read_b64_tr_b16 v[206:207], v241 offset:24064
  s_waitcnt lgkmcnt(8)
  v_mfma_f32_32x32x16_bf16 v[168:183], v[184:187], v[8:11], 0
  ds_read_b64_tr_b16 v[184:185], v241 offset:27648
  ds_read_b64_tr_b16 v[186:187], v241 offset:28160
  v_mfma_f32_32x32x16_bf16 v[168:183], v[188:191], v[12:15], v[168:183]
  s_add_u32 m0, s71, 1024
  s_add_u32 s72, s70, 64
  buffer_load_dwordx4 v4, s[36:39], s72 offen lds
  ds_read_b64_tr_b16 v[188:189], v241 offset:31744
  ds_read_b64_tr_b16 v[190:191], v241 offset:32256
  s_waitcnt lgkmcnt(8)
  v_mfma_f32_32x32x16_bf16 v[168:183], v[192:195], v[16:19], v[168:183]
  ds_read_b64_tr_b16 v[192:193], v241 offset:35840
  ds_read_b64_tr_b16 v[194:195], v241 offset:36352
  v_mfma_f32_32x32x16_bf16 v[168:183], v[196:199], v[20:23], v[168:183]
  ds_read_b64_tr_b16 v[196:197], v241 offset:39936
  ds_read_b64_tr_b16 v[198:199], v241 offset:40448
  s_waitcnt lgkmcnt(8)
  v_mfma_f32_32x32x16_bf16 v[168:183], v[200:203], v[24:27], v[168:183]
  s_add_u32 s69, s42, 16
  s_mul_i32 s70, s69, 14336
  s_add_u32 s70, s70, s68
  s_mul_i32 s71, s69, 2048
  s_add_u32 m0, s71, 0
  s_add_u32 s72, s70, 0
  buffer_load_dwordx4 v4, s[36:39], s72 offen lds
  ds_read_b64_tr_b16 v[200:201], v241 offset:44032
  ds_read_b64_tr_b16 v[202:203], v241 offset:44544
  v_mfma_f32_32x32x16_bf16 v[168:183], v[204:207], v[28:31], v[168:183]
  ds_read_b64_tr_b16 v[204:205], v241 offset:48128
  ds_read_b64_tr_b16 v[206:207], v241 offset:48640
  s_waitcnt lgkmcnt(8)
  v_mfma_f32_32x32x16_bf16 v[168:183], v[184:187], v[32:35], v[168:183]
  ds_read_b64_tr_b16 v[184:185], v241 offset:52224
  ds_read_b64_tr_b16 v[186:187], v241 offset:52736
  v_mfma_f32_32x32x16_bf16 v[168:183], v[188:191], v[36:39], v[168:183]
  s_add_u32 m0, s71, 1024
  s_add_u32 s72, s70, 64
  buffer_load_dwordx4 v4, s[36:39], s72 offen lds
  ds_read_b64_tr_b16 v[188:189], v241 offset:56320
  ds_read_b64_tr_b16 v[190:191], v241 offset:56832
  s_waitcnt lgkmcnt(8)
  v_mfma_f32_32x32x16_bf16 v[168:183], v[192:195], v[40:43], v[168:183]
  ds_read_b64_tr_b16 v[192:193], v241 offset:60416
  ds_read_b64_tr_b16 v[194:195], v241 offset:60928
  v_mfma_f32_32x32x16_bf16 v[168:183], v[196:199], v[44:47], v[168:183]
  ds_read_b64_tr_b16 v[196:197], v241 offset:64512
  ds_read_b64_tr_b16 v[198:199], v241 offset:65024
  s_waitcnt lgkmcnt(8)
  v_mfma_f32_32x32x16_bf16 v[168:183], v[200:203], v[48:51], v[168:183]
  s_add_u32 s69, s42, 20
  s_mul_i32 s70, s69, 14336
  s_add_u32 s70, s70, s68
  s_mul_i32 s71, s69, 2048
  s_add_u32 m0, s71, 0
  s_add_u32 s72, s70, 0
  buffer_load_dwordx4 v4, s[36:39], s72 offen lds
  ds_read_b64_tr_b16 v[200:201], v245 offset:3072
  ds_read_b64_tr_b16 v[202:203], v245 offset:3584
  v_mfma_f32_32x32x16_bf16 v[168:183], v[204:207], v[52:55], v[168:183]
  ds_read_b64_tr_b16 v[204:205], v245 offset:7168
  ds_read_b64_tr_b16 v[206:207], v245 offset:7680
  s_waitcnt lgkmcnt(8)
  v_mfma_f32_32x32x16_bf16 v[168:183], v[184:187], v[56:59], v[168:183]
  ds_read_b64_tr_b16 v[184:185], v245 offset:11264
  ds_read_b64_tr_b16 v[186:187], v245 offset:11776
  v_mfma_f32_32x32x16_bf16 v[168:183], v[188:191], v[60:63], v[168:183]
  s_add_u32 m0, s71, 1024
  s_add_u32 s72, s70, 64
  buffer_load_dwordx4 v4, s[36:39], s72 offen lds
  ds_read_b64_tr_b16 v[188:189], v245 offset:15360
  ds_read_b64_tr_b16 v[190:191], v245 offset:15872
  s_waitcnt lgkmcnt(8)
  v_mfma_f32_32x32x16_bf16 v[168:183], v[192:195], v[64:67], v[168:183]
  ds_read_b64_tr_b16 v[192:193], v245 offset:19456
  ds_read_b64_tr_b16 v[194:195], v245 offset:19968
  v_mfma_f32_32x32x16_bf16 v[168:183], v[196:199], v[68:71], v[168:183]
  ds_read_b64_tr_b16 v[196:197], v245 offset:23552
  ds_read_b64_tr_b16 v[198:199], v245 offset:24064
  s_waitcnt lgkmcnt(8)
  v_mfma_f32_32x32x16_bf16 v[168:183], v[200:203], v[72:75], v[168:183]
  s_add_u32 s69, s42, 24
  s_mul_i32 s70, s69, 14336
  s_add_u32 s70, s70, s68
  s_mul_i32 s71, s69, 2048
  s_add_u32 m0, s71, 0
  s_add_u32 s72, s70, 0
  buffer_load_dwordx4 v4, s[36:39], s72 offen lds
  ds_read_b64_tr_b16 v[200:201], v245 offset:27648
  ds_read_b64_tr_b16 v[202:203], v245 offset:28160
  v_mfma_f32_32x32x16_bf16 v[168:183], v[204:207], v[76:79], v[168:183]
  ds_read_b64_tr_b16 v[204:205], v245 offset:31744
  ds_read_b64_tr_b16 v[206:207], v245 offset:32256
  s_waitcnt lgkmcnt(8)
  v_mfma_f32_32x32x16_bf16 v[168:183], v[184:187], v[80:83], v[168:183]
  ds_read_b64_tr_b16 v[184:185], v243 offset:3072
  ds_read_b64_tr_b16 v[186:187], v243 offset:3584
  v_mfma_f32_32x32x16_bf16 v[168:183], v[188:191], v[84:87], v[168:183]
  s_add_u32 m0, s71, 1024
  s_add_u32 s72, s70, 64
  buffer_load_dwordx4 v4, s[36:39], s72 offen lds
  ds_read_b64_tr_b16 v[188:189], v243 offset:7168
  ds_read_b64_tr_b16 v[190:191], v243 offset:7680
  s_waitcnt lgkmcnt(8)
  v_mfma_f32_32x32x16_bf16 v[168:183], v[192:195], v[88:91], v[168:183]
  ds_read_b64_tr_b16 v[192:193], v243 offset:11264
  ds_read_b64_tr_b16 v[194:195], v243 offset:11776
  v_mfma_f32_32x32x16_bf16 v[168:183], v[196:199], v[92:95], v[168:183]
  ds_read_b64_tr_b16 v[196:197], v243 offset:15360
  ds_read_b64_tr_b16 v[198:199], v243 offset:15872
  s_waitcnt lgkmcnt(8)
  v_mfma_f32_32x32x16_bf16 v[168:183], v[200:203], v[96:99], v[168:183]
  v_mfma_f32_32x32x16_bf16 v[168:183], v[204:207], v[100:103], v[168:183]
  s_waitcnt lgkmcnt(4)
  v_mfma_f32_32x32x16_bf16 v[168:183], v[184:187], v[104:107], v[168:183]
  v_mfma_f32_32x32x16_bf16 v[168:183], v[188:191], v[108:111], v[168:183]
  s_waitcnt lgkmcnt(0)
  v_mfma_f32_32x32x16_bf16 v[168:183], v[192:195], v[112:115], v[168:183]
  v_mfma_f32_32x32x16_bf16 v[168:183], v[196:199], v[116:119], v[168:183]
  s_barrier
  s_cmp_eq_u32 s42, 0
  s_cbranch_scc1 L_nw0_47
  s_add_u32 s69, s42, 7
  s_cmp_ge_u32 s69, 16
  s_cbranch_scc1 L_wstd_49
L_wst_48:
  s_mul_i32 s70, s69, 14336
  s_add_u32 s70, s70, s68
  s_mul_i32 s71, s69, 2048
  s_add_u32 m0, s71, 0
  s_add_u32 s72, s70, 0
  buffer_load_dwordx4 v4, s[36:39], s72 offen lds
  s_add_u32 m0, s71, 1024
  s_add_u32 s72, s70, 64
  buffer_load_dwordx4 v4, s[36:39], s72 offen lds
  s_add_u32 s69, s69, 3
  s_cmp_lt_u32 s69, 16
  s_cbranch_scc1 L_wst_48
L_wstd_49:
  s_add_u32 s69, s42, 27
  s_cmp_ge_u32 s69, 30
  s_cbranch_scc1 L_wstd_51
L_wst_50:
  s_mul_i32 s70, s69, 14336
  s_add_u32 s70, s70, s68
  s_mul_i32 s71, s69, 2048
  s_add_u32 m0, s71, 0
  s_add_u32 s72, s70, 0
  buffer_load_dwordx4 v4, s[36:39], s72 offen lds
  s_add_u32 m0, s71, 1024
  s_add_u32 s72, s70, 64
  buffer_load_dwordx4 v4, s[36:39], s72 offen lds
  s_add_u32 s69, s69, 3
  s_cmp_lt_u32 s69, 30
  s_cbranch_scc1 L_wst_50
L_wstd_51:
L_nw0_47:
  s_cmp_lg_u32 s42, 0
  s_cbranch_scc1 L_w0_52
  v_min_u32 v8, 13, v0
  v_lshlrev_b32 v8, 3, v8
  s_lshl_b32 s55, s52, 7
  s_add_u32 s55, s55, s46
  s_add_u32 s55, s55, 31469568
  s_mov_b32 s76, 0
L_poll_53:
  buffer_load_dwordx2 v[10:11], v8, s[28:31], s55 offen sc1
  s_waitcnt vmcnt(0)
  v_cmp_eq_u32 vcc, s40, v10
  v_cmp_eq_u32 s[74:75], s41, v11
  s_nop 2
  s_and_b64 vcc, vcc, s[74:75]
  s_cmp_eq_u64 vcc, -1
  s_cbranch_scc1 L_polld_54
  s_add_u32 s76, s76, 1
  s_cmp_lt_u32 s76, 0x40000
  s_cbranch_scc1 L_poll_53
L_polld_54:
L_w0_52:
  s_barrier
  v_and_b32 v8, 31, v0
  v_lshlrev_b32 v8, 3, v8
  v_lshrrev_b32 v9, 5, v0
  v_mul_u32_u24 v9, 1792, v9
  v_add_u32 v8, v8, v9
  s_mul_i32 s60, s54, 3584
  s_add_u32 s60, s60, s46
  s_add_u32 s60, s60, 30932992
  buffer_load_dwordx2 v[40:41], v8, s[28:31], s60 offen offset:0
  buffer_load_dwordx2 v[42:43], v8, s[28:31], s60 offen offset:256
  buffer_load_dwordx2 v[44:45], v8, s[28:31], s60 offen offset:512
  buffer_load_dwordx2 v[46:47], v8, s[28:31], s60 offen offset:768
  buffer_load_dwordx2 v[48:49], v8, s[28:31], s60 offen offset:1024
  buffer_load_dwordx2 v[50:51], v8, s[28:31], s60 offen offset:1280
  buffer_load_dwordx2 v[52:53], v8, s[28:31], s60 offen offset:1536
  v_bfe_u32 v16, v0, 4, 1
  v_lshlrev_b32 v16, 11, v16
  v_bfe_u32 v17, v0, 2, 2
  v_lshl_add_u32 v16, v17, 8, v16
  v_and_b32 v17, 3, v0
  v_lshl_add_u32 v16, v17, 5, v16
  v_lshrrev_b32 v17, 5, v0
  v_lshl_add_u32 v16, v17, 4, v16
  s_lshl_b32 s55, s53, 18
  s_lshl_b32 s56, s54, 12
  s_add_u32 s55, s55, s56
  s_add_u32 s55, s55, s46
  s_add_u32 s55, s55, 17825792
  ds_read_b128 v[208:211], v249 offset:256
  ds_read_b128 v[212:215], v249 offset:288
  ds_read_b128 v[216:219], v249 offset:320
  ds_read_b128 v[220:223], v249 offset:352
  s_waitcnt lgkmcnt(0)
  v_pk_fma_f32 v[152:153], v[208:209], v[240:241], v[152:153] op_sel_hi:[1,0,1]
  v_pk_fma_f32 v[154:155], v[210:211], v[240:241], v[154:155] op_sel_hi:[1,0,1]
  v_pk_fma_f32 v[156:157], v[212:213], v[240:241], v[156:157] op_sel_hi:[1,0,1]
  v_pk_fma_f32 v[158:159], v[214:215], v[240:241], v[158:159] op_sel_hi:[1,0,1]
  v_pk_fma_f32 v[160:161], v[216:217], v[240:241], v[160:161] op_sel_hi:[1,0,1]
  v_pk_fma_f32 v[162:163], v[218:219], v[240:241], v[162:163] op_sel_hi:[1,0,1]
  v_pk_fma_f32 v[164:165], v[220:221], v[240:241], v[164:165] op_sel_hi:[1,0,1]
  v_pk_fma_f32 v[166:167], v[222:223], v[240:241], v[166:167] op_sel_hi:[1,0,1]
  v_pk_mul_f32 v[152:153], v[152:153], v[242:243] op_sel_hi:[1,0]
  v_pk_mul_f32 v[154:155], v[154:155], v[242:243] op_sel_hi:[1,0]
  v_pk_mul_f32 v[156:157], v[156:157], v[242:243] op_sel_hi:[1,0]
  v_pk_mul_f32 v[158:159], v[158:159], v[242:243] op_sel_hi:[1,0]
  v_pk_mul_f32 v[160:161], v[160:161], v[242:243] op_sel_hi:[1,0]
  v_pk_mul_f32 v[162:163], v[162:163], v[242:243] op_sel_hi:[1,0]
  v_pk_mul_f32 v[164:165], v[164:165], v[242:243] op_sel_hi:[1,0]
  v_pk_mul_f32 v[166:167], v[166:167], v[242:243] op_sel_hi:[1,0]
  v_pk_mul_f32 v[224:225], v[152:153], v[152:153]
  v_pk_mul_f32 v[226:227], v[154:155], v[154:155]
  v_pk_mul_f32 v[228:229], v[156:157], v[156:157]
  v_pk_mul_f32 v[230:231], v[158:159], v[158:159]
  v_pk_mul_f32 v[232:233], v[160:161], v[160:161]
  v_pk_mul_f32 v[234:235], v[162:163], v[162:163]
  v_pk_mul_f32 v[236:237], v[164:165], v[164:165]
  v_pk_mul_f32 v[238:239], v[166:167], v[166:167]
  v_pk_fma_f32 v[224:225], v[224:225], v[246:247], v[244:245] op_sel_hi:[1,0,0]
  v_pk_fma_f32 v[226:227], v[226:227], v[246:247], v[244:245] op_sel_hi:[1,0,0]
  v_pk_fma_f32 v[228:229], v[228:229], v[246:247], v[244:245] op_sel_hi:[1,0,0]
  v_pk_fma_f32 v[230:231], v[230:231], v[246:247], v[244:245] op_sel_hi:[1,0,0]
  v_pk_fma_f32 v[232:233], v[232:233], v[246:247], v[244:245] op_sel_hi:[1,0,0]
  v_pk_fma_f32 v[234:235], v[234:235], v[246:247], v[244:245] op_sel_hi:[1,0,0]
  v_pk_fma_f32 v[236:237], v[236:237], v[246:247], v[244:245] op_sel_hi:[1,0,0]
  v_pk_fma_f32 v[238:239], v[238:239], v[246:247], v[244:245] op_sel_hi:[1,0,0]
  v_pk_mul_f32 v[224:225], v[152:153], v[224:225]
  v_pk_mul_f32 v[226:227], v[154:155], v[226:227]
  v_pk_mul_f32 v[228:229], v[156:157], v[228:229]
  v_pk_mul_f32 v[230:231], v[158:159], v[230:231]
  v_pk_mul_f32 v[232:233], v[160:161], v[232:233]
  v_pk_mul_f32 v[234:235], v[162:163], v[234:235]
  v_pk_mul_f32 v[236:237], v[164:165], v[236:237]
  v_pk_mul_f32 v[238:239], v[166:167], v[238:239]
  v_exp_f32 v224, v224
  v_exp_f32 v225, v225
  v_exp_f32 v226, v226
  v_exp_f32 v227, v227
  v_exp_f32 v228, v228
  v_exp_f32 v229, v229
  v_exp_f32 v230, v230
  v_exp_f32 v231, v231
  v_exp_f32 v232, v232
  v_exp_f32 v233, v233
  v_exp_f32 v234, v234
  v_exp_f32 v235, v235
  v_exp_f32 v236, v236
  v_exp_f32 v237, v237
  v_exp_f32 v238, v238
  v_exp_f32 v239, v239
  v_pk_add_f32 v[224:225], v[224:225], v[248:249] op_sel_hi:[1,0]
  v_pk_add_f32 v[226:227], v[226:227], v[248:249] op_sel_hi:[1,0]
  v_pk_add_f32 v[228:229], v[228:229], v[248:249] op_sel_hi:[1,0]
  v_pk_add_f32 v[230:231], v[230:231], v[248:249] op_sel_hi:[1,0]
  v_pk_add_f32 v[232:233], v[232:233], v[248:249] op_sel_hi:[1,0]
  v_pk_add_f32 v[234:235], v[234:235], v[248:249] op_sel_hi:[1,0]
  v_pk_add_f32 v[236:237], v[236:237], v[248:249] op_sel_hi:[1,0]
  v_pk_add_f32 v[238:239], v[238:239], v[248:249] op_sel_hi:[1,0]
  v_rcp_f32 v224, v224
  v_rcp_f32 v225, v225
  v_rcp_f32 v226, v226
  v_rcp_f32 v227, v227
  v_rcp_f32 v228, v228
  v_rcp_f32 v229, v229
  v_rcp_f32 v230, v230
  v_rcp_f32 v231, v231
  v_rcp_f32 v232, v232
  v_rcp_f32 v233, v233
  v_rcp_f32 v234, v234
  v_rcp_f32 v235, v235
  v_rcp_f32 v236, v236
  v_rcp_f32 v237, v237
  v_rcp_f32 v238, v238
  v_rcp_f32 v239, v239
  v_pk_mul_f32 v[152:153], v[152:153], v[224:225]
  v_pk_mul_f32 v[154:155], v[154:155], v[226:227]
  v_pk_mul_f32 v[156:157], v[156:157], v[228:229]
  v_pk_mul_f32 v[158:159], v[158:159], v[230:231]
  v_pk_mul_f32 v[160:161], v[160:161], v[232:233]
  v_pk_mul_f32 v[162:163], v[162:163], v[234:235]
  v_pk_mul_f32 v[164:165], v[164:165], v[236:237]
  v_pk_mul_f32 v[166:167], v[166:167], v[238:239]
  v_cvt_pk_bf16_f32 v96, v152, v153
  v_cvt_pk_bf16_f32 v97, v154, v155
  v_cvt_pk_bf16_f32 v98, v156, v157
  v_cvt_pk_bf16_f32 v99, v158, v159
  v_cvt_pk_bf16_f32 v100, v160, v161
  v_cvt_pk_bf16_f32 v101, v162, v163
  v_cvt_pk_bf16_f32 v102, v164, v165
  v_cvt_pk_bf16_f32 v103, v166, v167
  s_waitcnt vmcnt(0)
  v_pk_add_f32 v[40:41], v[40:41], v[42:43]
  v_pk_add_f32 v[44:45], v[44:45], v[46:47]
  v_pk_add_f32 v[48:49], v[48:49], v[50:51]
  v_pk_add_f32 v[40:41], v[40:41], v[52:53]
  v_pk_add_f32 v[44:45], v[44:45], v[48:49]
  v_pk_add_f32 v[40:41], v[40:41], v[44:45]
  v_mov_b32 v250, v40
  v_mov_b32 v252, v41
  v_mov_b32 v8, v250
  v_mov_b32 v9, v250
  s_nop 1
  v_permlane32_swap_b32 v8, v9
  v_add_f32 v250, v8, v9
  v_mov_b32 v8, v252
  v_mov_b32 v9, v252
  s_nop 1
  v_permlane32_swap_b32 v8, v9
  v_add_f32 v252, v8, v9
  v_mul_f32 v12, 0xba924925, v250
  v_mul_f32 v14, 0x3a924925, v252
  v_fma_f32 v14, -v12, v12, v14
  v_max_f32 v14, 0, v14
  v_add_f32 v14, 0x3727c5ac, v14
  v_rsq_f32 v14, v14
  s_nop 0
  v_mul_f32 v12, v12, v14
  v_pk_fma_f32 v[120:121], v[120:121], v[14:15], v[12:13] op_sel_hi:[1,0,0]
  v_pk_fma_f32 v[122:123], v[122:123], v[14:15], v[12:13] op_sel_hi:[1,0,0]
  v_pk_fma_f32 v[124:125], v[124:125], v[14:15], v[12:13] op_sel_hi:[1,0,0]
  v_pk_fma_f32 v[126:127], v[126:127], v[14:15], v[12:13] op_sel_hi:[1,0,0]
  v_pk_fma_f32 v[128:129], v[128:129], v[14:15], v[12:13] op_sel_hi:[1,0,0]
  v_pk_fma_f32 v[130:131], v[130:131], v[14:15], v[12:13] op_sel_hi:[1,0,0]
  v_pk_fma_f32 v[132:133], v[132:133], v[14:15], v[12:13] op_sel_hi:[1,0,0]
  v_pk_fma_f32 v[134:135], v[134:135], v[14:15], v[12:13] op_sel_hi:[1,0,0]
  v_cvt_pk_bf16_f32 v56, v120, v121
  v_cvt_pk_bf16_f32 v57, v122, v123
  v_cvt_pk_bf16_f32 v58, v124, v125
  v_cvt_pk_bf16_f32 v59, v126, v127
  v_cvt_pk_bf16_f32 v60, v128, v129
  v_cvt_pk_bf16_f32 v61, v130, v131
  v_cvt_pk_bf16_f32 v62, v132, v133
  v_cvt_pk_bf16_f32 v63, v134, v135
  v_permlane32_swap_b32 v56, v58
  v_permlane32_swap_b32 v57, v59
  buffer_store_dwordx4 v[56:59], v16, s[28:31], s55 offen offset:0 sc1
  v_permlane32_swap_b32 v60, v62
  v_permlane32_swap_b32 v61, v63
  buffer_store_dwordx4 v[60:63], v16, s[28:31], s55 offen offset:128 sc1
  v_pk_fma_f32 v[136:137], v[136:137], v[14:15], v[12:13] op_sel_hi:[1,0,0]
  v_pk_fma_f32 v[138:139], v[138:139], v[14:15], v[12:13] op_sel_hi:[1,0,0]
  v_pk_fma_f32 v[140:141], v[140:141], v[14:15], v[12:13] op_sel_hi:[1,0,0]
  v_pk_fma_f32 v[142:143], v[142:143], v[14:15], v[12:13] op_sel_hi:[1,0,0]
  v_pk_fma_f32 v[144:145], v[144:145], v[14:15], v[12:13] op_sel_hi:[1,0,0]
  v_pk_fma_f32 v[146:147], v[146:147], v[14:15], v[12:13] op_sel_hi:[1,0,0]
  v_pk_fma_f32 v[148:149], v[148:149], v[14:15], v[12:13] op_sel_hi:[1,0,0]
  v_pk_fma_f32 v[150:151], v[150:151], v[14:15], v[12:13] op_sel_hi:[1,0,0]
  v_cvt_pk_bf16_f32 v64, v136, v137
  v_cvt_pk_bf16_f32 v65, v138, v139
  v_cvt_pk_bf16_f32 v66, v140, v141
  v_cvt_pk_bf16_f32 v67, v142, v143
  v_cvt_pk_bf16_f32 v68, v144, v145
  v_cvt_pk_bf16_f32 v69, v146, v147
  v_cvt_pk_bf16_f32 v70, v148, v149
  v_cvt_pk_bf16_f32 v71, v150, v151
  v_permlane32_swap_b32 v64, v66
  v_permlane32_swap_b32 v65, v67
  buffer_store_dwordx4 v[64:67], v16, s[28:31], s55 offen offset:1024 sc1
  v_permlane32_swap_b32 v68, v70
  v_permlane32_swap_b32 v69, v71
  buffer_store_dwordx4 v[68:71], v16, s[28:31], s55 offen offset:1152 sc1
  ds_read_b128 v[208:211], v249 offset:384
  ds_read_b128 v[212:215], v249 offset:416
  ds_read_b128 v[216:219], v249 offset:448
  ds_read_b128 v[220:223], v249 offset:480
  s_waitcnt lgkmcnt(0)
  v_pk_fma_f32 v[168:169], v[208:209], v[240:241], v[168:169] op_sel_hi:[1,0,1]
  v_pk_fma_f32 v[170:171], v[210:211], v[240:241], v[170:171] op_sel_hi:[1,0,1]
  v_pk_fma_f32 v[172:173], v[212:213], v[240:241], v[172:173] op_sel_hi:[1,0,1]
  v_pk_fma_f32 v[174:175], v[214:215], v[240:241], v[174:175] op_sel_hi:[1,0,1]
  v_pk_fma_f32 v[176:177], v[216:217], v[240:241], v[176:177] op_sel_hi:[1,0,1]
  v_pk_fma_f32 v[178:179], v[218:219], v[240:241], v[178:179] op_sel_hi:[1,0,1]
  v_pk_fma_f32 v[180:181], v[220:221], v[240:241], v[180:181] op_sel_hi:[1,0,1]
  v_pk_fma_f32 v[182:183], v[222:223], v[240:241], v[182:183] op_sel_hi:[1,0,1]
  v_pk_mul_f32 v[168:169], v[168:169], v[242:243] op_sel_hi:[1,0]
  v_pk_mul_f32 v[170:171], v[170:171], v[242:243] op_sel_hi:[1,0]
  v_pk_mul_f32 v[172:173], v[172:173], v[242:243] op_sel_hi:[1,0]
  v_pk_mul_f32 v[174:175], v[174:175], v[242:243] op_sel_hi:[1,0]
  v_pk_mul_f32 v[176:177], v[176:177], v[242:243] op_sel_hi:[1,0]
  v_pk_mul_f32 v[178:179], v[178:179], v[242:243] op_sel_hi:[1,0]
  v_pk_mul_f32 v[180:181], v[180:181], v[242:243] op_sel_hi:[1,0]
  v_pk_mul_f32 v[182:183], v[182:183], v[242:243] op_sel_hi:[1,0]
  v_pk_mul_f32 v[224:225], v[168:169], v[168:169]
  v_pk_mul_f32 v[226:227], v[170:171], v[170:171]
  v_pk_mul_f32 v[228:229], v[172:173], v[172:173]
  v_pk_mul_f32 v[230:231], v[174:175], v[174:175]
  v_pk_mul_f32 v[232:233], v[176:177], v[176:177]
  v_pk_mul_f32 v[234:235], v[178:179], v[178:179]
  v_pk_mul_f32 v[236:237], v[180:181], v[180:181]
  v_pk_mul_f32 v[238:239], v[182:183], v[182:183]
  v_pk_fma_f32 v[224:225], v[224:225], v[246:247], v[244:245] op_sel_hi:[1,0,0]
  v_pk_fma_f32 v[226:227], v[226:227], v[246:247], v[244:245] op_sel_hi:[1,0,0]
  v_pk_fma_f32 v[228:229], v[228:229], v[246:247], v[244:245] op_sel_hi:[1,0,0]
  v_pk_fma_f32 v[230:231], v[230:231], v[246:247], v[244:245] op_sel_hi:[1,0,0]
  v_pk_fma_f32 v[232:233], v[232:233], v[246:247], v[244:245] op_sel_hi:[1,0,0]
  v_pk_fma_f32 v[234:235], v[234:235], v[246:247], v[244:245] op_sel_hi:[1,0,0]
  v_pk_fma_f32 v[236:237], v[236:237], v[246:247], v[244:245] op_sel_hi:[1,0,0]
  v_pk_fma_f32 v[238:239], v[238:239], v[246:247], v[244:245] op_sel_hi:[1,0,0]
  v_pk_mul_f32 v[224:225], v[168:169], v[224:225]
  v_pk_mul_f32 v[226:227], v[170:171], v[226:227]
  v_pk_mul_f32 v[228:229], v[172:173], v[228:229]
  v_pk_mul_f32 v[230:231], v[174:175], v[230:231]
  v_pk_mul_f32 v[232:233], v[176:177], v[232:233]
  v_pk_mul_f32 v[234:235], v[178:179], v[234:235]
  v_pk_mul_f32 v[236:237], v[180:181], v[236:237]
  v_pk_mul_f32 v[238:239], v[182:183], v[238:239]
  v_exp_f32 v224, v224
  v_exp_f32 v225, v225
  v_exp_f32 v226, v226
  v_exp_f32 v227, v227
  v_exp_f32 v228, v228
  v_exp_f32 v229, v229
  v_exp_f32 v230, v230
  v_exp_f32 v231, v231
  v_exp_f32 v232, v232
  v_exp_f32 v233, v233
  v_exp_f32 v234, v234
  v_exp_f32 v235, v235
  v_exp_f32 v236, v236
  v_exp_f32 v237, v237
  v_exp_f32 v238, v238
  v_exp_f32 v239, v239
  v_pk_add_f32 v[224:225], v[224:225], v[248:249] op_sel_hi:[1,0]
  v_pk_add_f32 v[226:227], v[226:227], v[248:249] op_sel_hi:[1,0]
  v_pk_add_f32 v[228:229], v[228:229], v[248:249] op_sel_hi:[1,0]
  v_pk_add_f32 v[230:231], v[230:231], v[248:249] op_sel_hi:[1,0]
  v_pk_add_f32 v[232:233], v[232:233], v[248:249] op_sel_hi:[1,0]
  v_pk_add_f32 v[234:235], v[234:235], v[248:249] op_sel_hi:[1,0]
  v_pk_add_f32 v[236:237], v[236:237], v[248:249] op_sel_hi:[1,0]
  v_pk_add_f32 v[238:239], v[238:239], v[248:249] op_sel_hi:[1,0]
  v_rcp_f32 v224, v224
  v_rcp_f32 v225, v225
  v_rcp_f32 v226, v226
  v_rcp_f32 v227, v227
  v_rcp_f32 v228, v228
  v_rcp_f32 v229, v229
  v_rcp_f32 v230, v230
  v_rcp_f32 v231, v231
  v_rcp_f32 v232, v232
  v_rcp_f32 v233, v233
  v_rcp_f32 v234, v234
  v_rcp_f32 v235, v235
  v_rcp_f32 v236, v236
  v_rcp_f32 v237, v237
  v_rcp_f32 v238, v238
  v_rcp_f32 v239, v239
  v_pk_mul_f32 v[168:169], v[168:169], v[224:225]
  v_pk_mul_f32 v[170:171], v[170:171], v[226:227]
  v_pk_mul_f32 v[172:173], v[172:173], v[228:229]
  v_pk_mul_f32 v[174:175], v[174:175], v[230:231]
  v_pk_mul_f32 v[176:177], v[176:177], v[232:233]
  v_pk_mul_f32 v[178:179], v[178:179], v[234:235]
  v_pk_mul_f32 v[180:181], v[180:181], v[236:237]
  v_pk_mul_f32 v[182:183], v[182:183], v[238:239]
  v_cvt_pk_bf16_f32 v104, v168, v169
  v_cvt_pk_bf16_f32 v105, v170, v171
  v_cvt_pk_bf16_f32 v106, v172, v173
  v_cvt_pk_bf16_f32 v107, v174, v175
  v_cvt_pk_bf16_f32 v108, v176, v177
  v_cvt_pk_bf16_f32 v109, v178, v179
  v_cvt_pk_bf16_f32 v110, v180, v181
  v_cvt_pk_bf16_f32 v111, v182, v183
  s_waitcnt vmcnt(0) lgkmcnt(0)
  s_barrier
  s_lshl_b32 s55, s53, 7
  s_lshl_b32 s60, s52, 3
  s_add_u32 s55, s55, s60
  s_add_u32 s55, s55, s46
  s_add_u32 s55, s55, 31473664
  s_cmp_lg_u32 s42, 0
  s_cbranch_scc1 L_pub_55
  v_mov_b32 v20, s40
  v_mov_b32 v21, s41
  v_mov_b32 v22, 0
  s_mov_b64 exec, 1
  buffer_store_dwordx2 v[20:21], v22, s[28:31], s55 offen sc1
  s_mov_b64 exec, -1
L_pub_55:
  s_cmp_ge_u32 s44, 14
  s_cselect_b32 s53, 1, 0
  s_cselect_b32 s54, 14, 0
  s_sub_u32 s54, s44, s54
  s_and_b32 s52, s54, 1
  s_lshr_b32 s54, s54, 1
  s_lshl_b32 s77, s43, 1
  s_add_u32 s53, s53, s77
  s_lshl_b32 s55, s53, 2
  s_add_u32 s55, s55, s42
  s_mul_i32 s65, s53, 7
  s_add_u32 s65, s65, s54
  s_lshl_b32 s65, s65, 1
  s_cmp_lg_u32 s42, 0
  s_cbranch_scc1 L_w0_56
  v_bfe_u32 v144, v0, 3, 1
  v_lshlrev_b32 v144, 7, v144
  v_and_b32 v145, 7, v0
  v_lshl_add_u32 v144, v145, 3, v144
  s_lshl_b32 s60, s52, 6
  v_add_u32 v144, s60, v144
  s_lshl_b32 s56, s54, 8
  s_add_u32 s56, s56, s46
  s_add_u32 s56, s56, 31473664
  s_mov_b32 s76, 0
L_poll_57:
  buffer_load_dwordx2 v[146:147], v144, s[28:31], s56 offen sc1
  s_waitcnt vmcnt(0)
  v_cmp_eq_u32 vcc, s40, v146
  v_cmp_eq_u32 s[74:75], s41, v147
  s_nop 2
  s_and_b64 vcc, vcc, s[74:75]
  s_cmp_eq_u64 vcc, -1
  s_cbranch_scc1 L_polld_58
  s_add_u32 s76, s76, 1
  s_cmp_lt_u32 s76, 0x40000
  s_cbranch_scc1 L_poll_57
L_polld_58:
L_w0_56:
  s_barrier
  s_lshl_b32 s56, s54, 19
  s_lshl_b32 s60, s52, 17
  s_add_u32 s56, s56, s60
  s_lshl_b32 s60, s42, 12
  s_add_u32 s56, s56, s60
  s_add_u32 s56, s56, s46
  s_add_u32 s56, s56, 17825792
  s_lshl_b32 s60, s52, 18
  s_add_u32 s59, s56, s60
  s_xor_b32 s60, s60, 262144
  s_add_u32 s58, s56, s60
  s_lshl_b32 s64, s42, 12
  s_add_u32 s64, s64, 61440
  s_add_u32 m0, s64, 32768
  s_add_u32 s66, s58, 0
  buffer_load_dwordx4 v1, s[28:31], s66 offen offset:0 lds
  buffer_load_dwordx4 v1, s[28:31], s66 offen offset:1024 lds
  buffer_load_dwordx4 v1, s[28:31], s66 offen offset:2048 lds
  buffer_load_dwordx4 v1, s[28:31], s66 offen offset:3072 lds
  s_add_u32 m0, s64, 49152
  s_add_u32 s66, s58, 16384
  buffer_load_dwordx4 v1, s[28:31], s66 offen offset:0 lds
  buffer_load_dwordx4 v1, s[28:31], s66 offen offset:1024 lds
  buffer_load_dwordx4 v1, s[28:31], s66 offen offset:2048 lds
  buffer_load_dwordx4 v1, s[28:31], s66 offen offset:3072 lds
  s_add_u32 m0, s64, 65536
  s_add_u32 s66, s58, 32768
  buffer_load_dwordx4 v1, s[28:31], s66 offen offset:0 lds
  buffer_load_dwordx4 v1, s[28:31], s66 offen offset:1024 lds
  buffer_load_dwordx4 v1, s[28:31], s66 offen offset:2048 lds
  buffer_load_dwordx4 v1, s[28:31], s66 offen offset:3072 lds
  v_lshrrev_b32 v148, 5, v0
  v_lshlrev_b32 v148, 9, v148
  v_bfe_u32 v149, v0, 4, 1
  v_lshl_add_u32 v148, v149, 7, v148
  v_bfe_u32 v149, v0, 2, 2
  v_lshl_add_u32 v148, v149, 5, v148
  v_and_b32 v149, 3, v0
  v_lshl_add_u32 v148, v149, 3, v148
  v_add_u32 v148, 61440, v148
  v_add_u32 v149, 65536, v148
  s_mul_i32 s56, s55, 28
  s_lshl_b32 s60, s54, 2
  s_add_u32 s56, s56, s60
  s_lshl_b32 s60, s52, 1
  s_add_u32 s56, s56, s60
  s_lshl_b32 s56, s56, 11
  s_add_u32 s57, s56, s46
  s_waitcnt vmcnt(8)
  s_barrier
  ds_read_b64_tr_b16 v[72:73], v148 offset:32768
  ds_read_b64_tr_b16 v[74:75], v148 offset:33024
  ds_read_b64_tr_b16 v[76:77], v148 offset:33792
  ds_read_b64_tr_b16 v[78:79], v148 offset:34048
  ds_read_b64_tr_b16 v[80:81], v148 offset:34816
  ds_read_b64_tr_b16 v[82:83], v148 offset:35072
  ds_read_b64_tr_b16 v[84:85], v148 offset:35840
  ds_read_b64_tr_b16 v[86:87], v148 offset:36096
  ds_read_b64_tr_b16 v[88:89], v148 offset:36864
  ds_read_b64_tr_b16 v[90:91], v148 offset:37120
  ds_read_b64_tr_b16 v[92:93], v148 offset:37888
  ds_read_b64_tr_b16 v[94:95], v148 offset:38144
  s_waitcnt lgkmcnt(8)
  v_mfma_f32_32x32x16_bf16 v[8:23], v[72:75], a[0:3], 0
  ds_read_b64_tr_b16 v[72:73], v148 offset:38912
  ds_read_b64_tr_b16 v[74:75], v148 offset:39168
  v_mfma_f32_32x32x16_bf16 v[24:39], v[76:79], a[0:3], 0
  s_add_u32 m0, s64, 81920
  s_add_u32 s66, s58, 49152
  buffer_load_dwordx4 v1, s[28:31], s66 offen offset:0 lds
  ds_read_b64_tr_b16 v[76:77], v148 offset:39936
  ds_read_b64_tr_b16 v[78:79], v148 offset:40192
  s_waitcnt lgkmcnt(8)
  v_mfma_f32_32x32x16_bf16 v[8:23], v[80:83], a[4:7], v[8:23]
  buffer_load_dwordx4 v1, s[28:31], s66 offen offset:1024 lds
  ds_read_b64_tr_b16 v[80:81], v148 offset:40960
  ds_read_b64_tr_b16 v[82:83], v148 offset:41216
  v_mfma_f32_32x32x16_bf16 v[24:39], v[84:87], a[4:7], v[24:39]
  buffer_load_dwordx4 v1, s[28:31], s66 offen offset:2048 lds
  ds_read_b64_tr_b16 v[84:85], v148 offset:41984
  ds_read_b64_tr_b16 v[86:87], v148 offset:42240
  s_waitcnt lgkmcnt(8)
  v_mfma_f32_32x32x16_bf16 v[8:23], v[88:91], a[8:11], v[8:23]
  buffer_load_dwordx4 v1, s[28:31], s66 offen offset:3072 lds
  ds_read_b64_tr_b16 v[88:89], v148 offset:43008
  ds_read_b64_tr_b16 v[90:91], v148 offset:43264
  v_mfma_f32_32x32x16_bf16 v[24:39], v[92:95], a[8:11], v[24:39]
  s_add_u32 m0, s64, 0
  s_add_u32 s66, s58, 65536
  buffer_load_dwordx4 v1, s[28:31], s66 offen offset:0 lds
  ds_read_b64_tr_b16 v[92:93], v148 offset:44032
  ds_read_b64_tr_b16 v[94:95], v148 offset:44288
  s_waitcnt lgkmcnt(8)
  v_mfma_f32_32x32x16_bf16 v[8:23], v[72:75], a[12:15], v[8:23]
  buffer_load_dwordx4 v1, s[28:31], s66 offen offset:1024 lds
  ds_read_b64_tr_b16 v[72:73], v148 offset:45056
  ds_read_b64_tr_b16 v[74:75], v148 offset:45312
  v_mfma_f32_32x32x16_bf16 v[24:39], v[76:79], a[12:15], v[24:39]
  buffer_load_dwordx4 v1, s[28:31], s66 offen offset:2048 lds
  ds_read_b64_tr_b16 v[76:77], v148 offset:46080
  ds_read_b64_tr_b16 v[78:79], v148 offset:46336
  s_waitcnt lgkmcnt(8)
  v_mfma_f32_32x32x16_bf16 v[8:23], v[80:83], a[16:19], v[8:23]
  buffer_load_dwordx4 v1, s[28:31], s66 offen offset:3072 lds
  ds_read_b64_tr_b16 v[80:81], v148 offset:47104
  ds_read_b64_tr_b16 v[82:83], v148 offset:47360
  v_mfma_f32_32x32x16_bf16 v[24:39], v[84:87], a[16:19], v[24:39]
  s_waitcnt vmcnt(12)
  s_barrier
  ds_read_b64_tr_b16 v[84:85], v148 offset:48128
  ds_read_b64_tr_b16 v[86:87], v148 offset:48384
  s_waitcnt lgkmcnt(8)
  v_mfma_f32_32x32x16_bf16 v[8:23], v[88:91], a[20:23], v[8:23]
  ds_read_b64_tr_b16 v[88:89], v148 offset:49152
  ds_read_b64_tr_b16 v[90:91], v148 offset:49408
  v_mfma_f32_32x32x16_bf16 v[24:39], v[92:95], a[20:23], v[24:39]
  s_add_u32 m0, s64, 16384
  s_add_u32 s66, s58, 81920
  buffer_load_dwordx4 v1, s[28:31], s66 offen offset:0 lds
  ds_read_b64_tr_b16 v[92:93], v148 offset:50176
  ds_read_b64_tr_b16 v[94:95], v148 offset:50432
  s_waitcnt lgkmcnt(8)
  v_mfma_f32_32x32x16_bf16 v[8:23], v[72:75], a[24:27], v[8:23]
  ds_read_b64_tr_b16 v[72:73], v148 offset:51200
  ds_read_b64_tr_b16 v[74:75], v148 offset:51456
  v_mfma_f32_32x32x16_bf16 v[24:39], v[76:79], a[24:27], v[24:39]
  ds_read_b64_tr_b16 v[76:77], v148 offset:52224
  ds_read_b64_tr_b16 v[78:79], v148 offset:52480
  s_waitcnt lgkmcnt(8)
  v_mfma_f32_32x32x16_bf16 v[8:23], v[80:83], a[28:31], v[8:23]
  buffer_load_dwordx4 v1, s[28:31], s66 offen offset:1024 lds
  ds_read_b64_tr_b16 v[80:81], v148 offset:53248
  ds_read_b64_tr_b16 v[82:83], v148 offset:53504
  v_mfma_f32_32x32x16_bf16 v[24:39], v[84:87], a[28:31], v[24:39]
  ds_read_b64_tr_b16 v[84:85], v148 offset:54272
  ds_read_b64_tr_b16 v[86:87], v148 offset:54528
  s_waitcnt lgkmcnt(8)
  v_mfma_f32_32x32x16_bf16 v[8:23], v[88:91], a[32:35], v[8:23]
  ds_read_b64_tr_b16 v[88:89], v148 offset:55296
  ds_read_b64_tr_b16 v[90:91], v148 offset:55552
  v_mfma_f32_32x32x16_bf16 v[24:39], v[92:95], a[32:35], v[24:39]
  buffer_load_dwordx4 v1, s[28:31], s66 offen offset:2048 lds
  ds_read_b64_tr_b16 v[92:93], v148 offset:56320
  ds_read_b64_tr_b16 v[94:95], v148 offset:56576
  s_waitcnt lgkmcnt(8)
  v_mfma_f32_32x32x16_bf16 v[8:23], v[72:75], a[36:39], v[8:23]
  ds_read_b64_tr_b16 v[72:73], v148 offset:57344
  ds_read_b64_tr_b16 v[74:75], v148 offset:57600
  v_mfma_f32_32x32x16_bf16 v[24:39], v[76:79], a[36:39], v[24:39]
  ds_read_b64_tr_b16 v[76:77], v148 offset:58368
  ds_read_b64_tr_b16 v[78:79], v148 offset:58624
  s_waitcnt lgkmcnt(8)
  v_mfma_f32_32x32x16_bf16 v[8:23], v[80:83], a[40:43], v[8:23]
  buffer_load_dwordx4 v1, s[28:31], s66 offen offset:3072 lds
  ds_read_b64_tr_b16 v[80:81], v148 offset:59392
  ds_read_b64_tr_b16 v[82:83], v148 offset:59648
  v_mfma_f32_32x32x16_bf16 v[24:39], v[84:87], a[40:43], v[24:39]
  ds_read_b64_tr_b16 v[84:85], v148 offset:60416
  ds_read_b64_tr_b16 v[86:87], v148 offset:60672
  s_waitcnt lgkmcnt(8)
  v_mfma_f32_32x32x16_bf16 v[8:23], v[88:91], a[44:47], v[8:23]
  ds_read_b64_tr_b16 v[88:89], v148 offset:61440
  ds_read_b64_tr_b16 v[90:91], v148 offset:61696
  v_mfma_f32_32x32x16_bf16 v[24:39], v[92:95], a[44:47], v[24:39]
  ds_read_b64_tr_b16 v[92:93], v148 offset:62464
  ds_read_b64_tr_b16 v[94:95], v148 offset:62720
  s_waitcnt lgkmcnt(8)
  v_mfma_f32_32x32x16_bf16 v[8:23], v[72:75], a[48:51], v[8:23]
  ds_read_b64_tr_b16 v[72:73], v148 offset:63488
  ds_read_b64_tr_b16 v[74:75], v148 offset:63744
  v_mfma_f32_32x32x16_bf16 v[24:39], v[76:79], a[48:51], v[24:39]
  s_waitcnt vmcnt(12)
  s_barrier
  ds_read_b64_tr_b16 v[76:77], v148 offset:64512
  ds_read_b64_tr_b16 v[78:79], v148 offset:64768
  s_waitcnt lgkmcnt(8)
  v_mfma_f32_32x32x16_bf16 v[8:23], v[80:83], a[52:55], v[8:23]
  ds_read_b64_tr_b16 v[80:81], v149 offset:0
  ds_read_b64_tr_b16 v[82:83], v149 offset:256
  v_mfma_f32_32x32x16_bf16 v[24:39], v[84:87], a[52:55], v[24:39]
  s_add_u32 m0, s64, 32768
  s_add_u32 s66, s58, 98304
  buffer_load_dwordx4 v1, s[28:31], s66 offen offset:0 lds
  ds_read_b64_tr_b16 v[84:85], v149 offset:1024
  ds_read_b64_tr_b16 v[86:87], v149 offset:1280
  s_waitcnt lgkmcnt(8)
  v_mfma_f32_32x32x16_bf16 v[8:23], v[88:91], a[56:59], v[8:23]
  ds_read_b64_tr_b16 v[88:89], v149 offset:2048
  ds_read_b64_tr_b16 v[90:91], v149 offset:2304
  v_mfma_f32_32x32x16_bf16 v[24:39], v[92:95], a[56:59], v[24:39]
  ds_read_b64_tr_b16 v[92:93], v149 offset:3072
  ds_read_b64_tr_b16 v[94:95], v149 offset:3328
  s_waitcnt lgkmcnt(8)
  v_mfma_f32_32x32x16_bf16 v[8:23], v[72:75], a[60:63], v[8:23]
  buffer_load_dwordx4 v1, s[28:31], s66 offen offset:1024 lds
  ds_read_b64_tr_b16 v[72:73], v149 offset:4096
  ds_read_b64_tr_b16 v[74:75], v149 offset:4352
  v_mfma_f32_32x32x16_bf16 v[24:39], v[76:79], a[60:63], v[24:39]
  ds_read_b64_tr_b16 v[76:77], v149 offset:5120
  ds_read_b64_tr_b16 v[78:79], v149 offset:5376
  s_waitcnt lgkmcnt(8)
  v_mfma_f32_32x32x16_bf16 v[8:23], v[80:83], a[64:67], v[8:23]
  ds_read_b64_tr_b16 v[80:81], v149 offset:6144
  ds_read_b64_tr_b16 v[82:83], v149 offset:6400
  v_mfma_f32_32x32x16_bf16 v[24:39], v[84:87], a[64:67], v[24:39]
  buffer_load_dwordx4 v1, s[28:31], s66 offen offset:2048 lds
  ds_read_b64_tr_b16 v[84:85], v149 offset:7168
  ds_read_b64_tr_b16 v[86:87], v149 offset:7424
  s_waitcnt lgkmcnt(8)
  v_mfma_f32_32x32x16_bf16 v[8:23], v[88:91], a[68:71], v[8:23]
  ds_read_b64_tr_b16 v[88:89], v149 offset:8192
  ds_read_b64_tr_b16 v[90:91], v149 offset:8448
  v_mfma_f32_32x32x16_bf16 v[24:39], v[92:95], a[68:71], v[24:39]
  ds_read_b64_tr_b16 v[92:93], v149 offset:9216
  ds_read_b64_tr_b16 v[94:95], v149 offset:9472
  s_waitcnt lgkmcnt(8)
  v_mfma_f32_32x32x16_bf16 v[8:23], v[72:75], a[72:75], v[8:23]
  buffer_load_dwordx4 v1, s[28:31], s66 offen offset:3072 lds
  ds_read_b64_tr_b16 v[72:73], v149 offset:10240
  ds_read_b64_tr_b16 v[74:75], v149 offset:10496
  v_mfma_f32_32x32x16_bf16 v[24:39], v[76:79], a[72:75], v[24:39]
  ds_read_b64_tr_b16 v[76:77], v149 offset:11264
  ds_read_b64_tr_b16 v[78:79], v149 offset:11520
  s_waitcnt lgkmcnt(8)
  v_mfma_f32_32x32x16_bf16 v[8:23], v[80:83], a[76:79], v[8:23]
  ds_read_b64_tr_b16 v[80:81], v149 offset:12288
  ds_read_b64_tr_b16 v[82:83], v149 offset:12544
  v_mfma_f32_32x32x16_bf16 v[24:39], v[84:87], a[76:79], v[24:39]
  ds_read_b64_tr_b16 v[84:85], v149 offset:13312
  ds_read_b64_tr_b16 v[86:87], v149 offset:13568
  s_waitcnt lgkmcnt(8)
  v_mfma_f32_32x32x16_bf16 v[8:23], v[88:91], a[80:83], v[8:23]
  ds_read_b64_tr_b16 v[88:89], v149 offset:14336
  ds_read_b64_tr_b16 v[90:91], v149 offset:14592
  v_mfma_f32_32x32x16_bf16 v[24:39], v[92:95], a[80:83], v[24:39]
  s_waitcnt vmcnt(12)
  s_barrier
  ds_read_b64_tr_b16 v[92:93], v149 offset:15360
  ds_read_b64_tr_b16 v[94:95], v149 offset:15616
  s_waitcnt lgkmcnt(8)
  v_mfma_f32_32x32x16_bf16 v[8:23], v[72:75], a[84:87], v[8:23]
  ds_read_b64_tr_b16 v[72:73], v149 offset:16384
  ds_read_b64_tr_b16 v[74:75], v149 offset:16640
  v_mfma_f32_32x32x16_bf16 v[24:39], v[76:79], a[84:87], v[24:39]
  s_add_u32 m0, s64, 49152
  s_add_u32 s66, s58, 114688
  buffer_load_dwordx4 v1, s[28:31], s66 offen offset:0 lds
  ds_read_b64_tr_b16 v[76:77], v149 offset:17408
  ds_read_b64_tr_b16 v[78:79], v149 offset:17664
  s_waitcnt lgkmcnt(8)
  v_mfma_f32_32x32x16_bf16 v[8:23], v[80:83], a[88:91], v[8:23]
  ds_read_b64_tr_b16 v[80:81], v149 offset:18432
  ds_read_b64_tr_b16 v[82:83], v149 offset:18688
  v_mfma_f32_32x32x16_bf16 v[24:39], v[84:87], a[88:91], v[24:39]
  ds_read_b64_tr_b16 v[84:85], v149 offset:19456
  ds_read_b64_tr_b16 v[86:87], v149 offset:19712
  s_waitcnt lgkmcnt(8)
  v_mfma_f32_32x32x16_bf16 v[8:23], v[88:91], a[92:95], v[8:23]
  buffer_load_dwordx4 v1, s[28:31], s66 offen offset:1024 lds
  ds_read_b64_tr_b16 v[88:89], v149 offset:20480
  ds_read_b64_tr_b16 v[90:91], v149 offset:20736
  v_mfma_f32_32x32x16_bf16 v[24:39], v[92:95], a[92:95], v[24:39]
  ds_read_b64_tr_b16 v[92:93], v149 offset:21504
  ds_read_b64_tr_b16 v[94:95], v149 offset:21760
  s_waitcnt lgkmcnt(8)
  v_mfma_f32_32x32x16_bf16 v[8:23], v[72:75], a[96:99], v[8:23]
  ds_read_b64_tr_b16 v[72:73], v149 offset:22528
  ds_read_b64_tr_b16 v[74:75], v149 offset:22784
  v_mfma_f32_32x32x16_bf16 v[24:39], v[76:79], a[96:99], v[24:39]
  buffer_load_dwordx4 v1, s[28:31], s66 offen offset:2048 lds
  ds_read_b64_tr_b16 v[76:77], v149 offset:23552
  ds_read_b64_tr_b16 v[78:79], v149 offset:23808
  s_waitcnt lgkmcnt(8)
  v_mfma_f32_32x32x16_bf16 v[8:23], v[80:83], a[100:103], v[8:23]
  ds_read_b64_tr_b16 v[80:81], v149 offset:24576
  ds_read_b64_tr_b16 v[82:83], v149 offset:24832
  v_mfma_f32_32x32x16_bf16 v[24:39], v[84:87], a[100:103], v[24:39]
  ds_read_b64_tr_b16 v[84:85], v149 offset:25600
  ds_read_b64_tr_b16 v[86:87], v149 offset:25856
  s_waitcnt lgkmcnt(8)
  v_mfma_f32_32x32x16_bf16 v[8:23], v[88:91], a[104:107], v[8:23]
  buffer_load_dwordx4 v1, s[28:31], s66 offen offset:3072 lds
  ds_read_b64_tr_b16 v[88:89], v149 offset:26624
  ds_read_b64_tr_b16 v[90:91], v149 offset:26880
  v_mfma_f32_32x32x16_bf16 v[24:39], v[92:95], a[104:107], v[24:39]
  ds_read_b64_tr_b16 v[92:93], v149 offset:27648
  ds_read_b64_tr_b16 v[94:95], v149 offset:27904
  s_waitcnt lgkmcnt(8)
  v_mfma_f32_32x32x16_bf16 v[8:23], v[72:75], a[108:111], v[8:23]
  ds_read_b64_tr_b16 v[72:73], v149 offset:28672
  ds_read_b64_tr_b16 v[74:75], v149 offset:28928
  v_mfma_f32_32x32x16_bf16 v[24:39], v[76:79], a[108:111], v[24:39]
  ds_read_b64_tr_b16 v[76:77], v149 offset:29696
  ds_read_b64_tr_b16 v[78:79], v149 offset:29952
  s_waitcnt lgkmcnt(8)
  v_mfma_f32_32x32x16_bf16 v[8:23], v[80:83], a[112:115], v[8:23]
  ds_read_b64_tr_b16 v[80:81], v149 offset:30720
  ds_read_b64_tr_b16 v[82:83], v149 offset:30976
  v_mfma_f32_32x32x16_bf16 v[24:39], v[84:87], a[112:115], v[24:39]
  s_waitcnt vmcnt(12)
  s_barrier
  ds_read_b64_tr_b16 v[84:85], v149 offset:31744
  ds_read_b64_tr_b16 v[86:87], v149 offset:32000
  s_waitcnt lgkmcnt(8)
  v_mfma_f32_32x32x16_bf16 v[8:23], v[88:91], a[116:119], v[8:23]
  ds_read_b64_tr_b16 v[88:89], v148 offset:0
  ds_read_b64_tr_b16 v[90:91], v148 offset:256
  v_mfma_f32_32x32x16_bf16 v[24:39], v[92:95], a[116:119], v[24:39]
  s_add_u32 m0, s64, 65536
  s_add_u32 s66, s59, 0
  buffer_load_dwordx4 v1, s[28:31], s66 offen offset:0 lds
  ds_read_b64_tr_b16 v[92:93], v148 offset:1024
  ds_read_b64_tr_b16 v[94:95], v148 offset:1280
  s_waitcnt lgkmcnt(8)
  v_mfma_f32_32x32x16_bf16 v[8:23], v[72:75], a[120:123], v[8:23]
  ds_read_b64_tr_b16 v[72:73], v148 offset:2048
  ds_read_b64_tr_b16 v[74:75], v148 offset:2304
  v_mfma_f32_32x32x16_bf16 v[24:39], v[76:79], a[120:123], v[24:39]
  ds_read_b64_tr_b16 v[76:77], v148 offset:3072
  ds_read_b64_tr_b16 v[78:79], v148 offset:3328
  s_waitcnt lgkmcnt(8)
  v_mfma_f32_32x32x16_bf16 v[8:23], v[80:83], a[124:127], v[8:23]
  buffer_load_dwordx4 v1, s[28:31], s66 offen offset:1024 lds
  ds_read_b64_tr_b16 v[80:81], v148 offset:4096
  ds_read_b64_tr_b16 v[82:83], v148 offset:4352
  v_mfma_f32_32x32x16_bf16 v[24:39], v[84:87], a[124:127], v[24:39]
  ds_read_b64_tr_b16 v[84:85], v148 offset:5120
  ds_read_b64_tr_b16 v[86:87], v148 offset:5376
  s_waitcnt lgkmcnt(8)
  v_mfma_f32_32x32x16_bf16 v[8:23], v[88:91], a[128:131], v[8:23]
  ds_read_b64_tr_b16 v[88:89], v148 offset:6144
  ds_read_b64_tr_b16 v[90:91], v148 offset:6400
  v_mfma_f32_32x32x16_bf16 v[24:39], v[92:95], a[128:131], v[24:39]
  buffer_load_dwordx4 v1, s[28:31], s66 offen offset:2048 lds
  ds_read_b64_tr_b16 v[92:93], v148 offset:7168
  ds_read_b64_tr_b16 v[94:95], v148 offset:7424
  s_waitcnt lgkmcnt(8)
  v_mfma_f32_32x32x16_bf16 v[8:23], v[72:75], a[132:135], v[8:23]
  ds_read_b64_tr_b16 v[72:73], v148 offset:8192
  ds_read_b64_tr_b16 v[74:75], v148 offset:8448
  v_mfma_f32_32x32x16_bf16 v[24:39], v[76:79], a[132:135], v[24:39]
  ds_read_b64_tr_b16 v[76:77], v148 offset:9216
  ds_read_b64_tr_b16 v[78:79], v148 offset:9472
  s_waitcnt lgkmcnt(8)
  v_mfma_f32_32x32x16_bf16 v[8:23], v[80:83], a[136:139], v[8:23]
  buffer_load_dwordx4 v1, s[28:31], s66 offen offset:3072 lds
  ds_read_b64_tr_b16 v[80:81], v148 offset:10240
  ds_read_b64_tr_b16 v[82:83], v148 offset:10496
  v_mfma_f32_32x32x16_bf16 v[24:39], v[84:87], a[136:139], v[24:39]
  ds_read_b64_tr_b16 v[84:85], v148 offset:11264
  ds_read_b64_tr_b16 v[86:87], v148 offset:11520
  s_waitcnt lgkmcnt(8)
  v_mfma_f32_32x32x16_bf16 v[8:23], v[88:91], a[140:143], v[8:23]
  ds_read_b64_tr_b16 v[88:89], v148 offset:12288
  ds_read_b64_tr_b16 v[90:91], v148 offset:12544
  v_mfma_f32_32x32x16_bf16 v[24:39], v[92:95], a[140:143], v[24:39]
  ds_read_b64_tr_b16 v[92:93], v148 offset:13312
  ds_read_b64_tr_b16 v[94:95], v148 offset:13568
  s_waitcnt lgkmcnt(8)
  v_mfma_f32_32x32x16_bf16 v[8:23], v[72:75], a[144:147], v[8:23]
  ds_read_b64_tr_b16 v[72:73], v148 offset:14336
  ds_read_b64_tr_b16 v[74:75], v148 offset:14592
  v_mfma_f32_32x32x16_bf16 v[24:39], v[76:79], a[144:147], v[24:39]
  s_waitcnt vmcnt(12)
  s_barrier
  ds_read_b64_tr_b16 v[76:77], v148 offset:15360
  ds_read_b64_tr_b16 v[78:79], v148 offset:15616
  s_waitcnt lgkmcnt(8)
  v_mfma_f32_32x32x16_bf16 v[8:23], v[80:83], a[148:151], v[8:23]
  ds_read_b64_tr_b16 v[80:81], v148 offset:16384
  ds_read_b64_tr_b16 v[82:83], v148 offset:16640
  v_mfma_f32_32x32x16_bf16 v[24:39], v[84:87], a[148:151], v[24:39]
  s_add_u32 m0, s64, 81920
  s_add_u32 s66, s59, 16384
  buffer_load_dwordx4 v1, s[28:31], s66 offen offset:0 lds
  ds_read_b64_tr_b16 v[84:85], v148 offset:17408
  ds_read_b64_tr_b16 v[86:87], v148 offset:17664
  s_waitcnt lgkmcnt(8)
  v_mfma_f32_32x32x16_bf16 v[8:23], v[88:91], a[152:155], v[8:23]
  ds_read_b64_tr_b16 v[88:89], v148 offset:18432
  ds_read_b64_tr_b16 v[90:91], v148 offset:18688
  v_mfma_f32_32x32x16_bf16 v[24:39], v[92:95], a[152:155], v[24:39]
  ds_read_b64_tr_b16 v[92:93], v148 offset:19456
  ds_read_b64_tr_b16 v[94:95], v148 offset:19712
  s_waitcnt lgkmcnt(8)
  v_mfma_f32_32x32x16_bf16 v[8:23], v[72:75], a[156:159], v[8:23]
  buffer_load_dwordx4 v1, s[28:31], s66 offen offset:1024 lds
  ds_read_b64_tr_b16 v[72:73], v148 offset:20480
  ds_read_b64_tr_b16 v[74:75], v148 offset:20736
  v_mfma_f32_32x32x16_bf16 v[24:39], v[76:79], a[156:159], v[24:39]
  ds_read_b64_tr_b16 v[76:77], v148 offset:21504
  ds_read_b64_tr_b16 v[78:79], v148 offset:21760
  s_waitcnt lgkmcnt(8)
  v_mfma_f32_32x32x16_bf16 v[8:23], v[80:83], a[160:163], v[8:23]
  ds_read_b64_tr_b16 v[80:81], v148 offset:22528
  ds_read_b64_tr_b16 v[82:83], v148 offset:22784
  v_mfma_f32_32x32x16_bf16 v[24:39], v[84:87], a[160:163], v[24:39]
  buffer_load_dwordx4 v1, s[28:31], s66 offen offset:2048 lds
  ds_read_b64_tr_b16 v[84:85], v148 offset:23552
  ds_read_b64_tr_b16 v[86:87], v148 offset:23808
  s_waitcnt lgkmcnt(8)
  v_mfma_f32_32x32x16_bf16 v[8:23], v[88:91], a[164:167], v[8:23]
  ds_read_b64_tr_b16 v[88:89], v148 offset:24576
  ds_read_b64_tr_b16 v[90:91], v148 offset:24832
  v_mfma_f32_32x32x16_bf16 v[24:39], v[92:95], a[164:167], v[24:39]
  ds_read_b64_tr_b16 v[92:93], v148 offset:25600
  ds_read_b64_tr_b16 v[94:95], v148 offset:25856
  s_waitcnt lgkmcnt(8)
  v_mfma_f32_32x32x16_bf16 v[8:23], v[72:75], a[168:171], v[8:23]
  buffer_load_dwordx4 v1, s[28:31], s66 offen offset:3072 lds
  ds_read_b64_tr_b16 v[72:73], v148 offset:26624
  ds_read_b64_tr_b16 v[74:75], v148 offset:26880
  v_mfma_f32_32x32x16_bf16 v[24:39], v[76:79], a[168:171], v[24:39]
  ds_read_b64_tr_b16 v[76:77], v148 offset:27648
  ds_read_b64_tr_b16 v[78:79], v148 offset:27904
  s_waitcnt lgkmcnt(8)
  v_mfma_f32_32x32x16_bf16 v[8:23], v[80:83], a[172:175], v[8:23]
  ds_read_b64_tr_b16 v[80:81], v148 offset:28672
  ds_read_b64_tr_b16 v[82:83], v148 offset:28928
  v_mfma_f32_32x32x16_bf16 v[24:39], v[84:87], a[172:175], v[24:39]
  ds_read_b64_tr_b16 v[84:85], v148 offset:29696
  ds_read_b64_tr_b16 v[86:87], v148 offset:29952
  s_waitcnt lgkmcnt(8)
  v_mfma_f32_32x32x16_bf16 v[8:23], v[88:91], a[176:179], v[8:23]
  ds_read_b64_tr_b16 v[88:89], v148 offset:30720
  ds_read_b64_tr_b16 v[90:91], v148 offset:30976
  v_mfma_f32_32x32x16_bf16 v[24:39], v[92:95], a[176:179], v[24:39]
  s_waitcnt vmcnt(12)
  s_barrier
  ds_read_b64_tr_b16 v[92:93], v148 offset:31744
  ds_read_b64_tr_b16 v[94:95], v148 offset:32000
  s_waitcnt lgkmcnt(8)
  v_mfma_f32_32x32x16_bf16 v[8:23], v[72:75], a[180:183], v[8:23]
  ds_read_b64_tr_b16 v[72:73], v148 offset:32768
  ds_read_b64_tr_b16 v[74:75], v148 offset:33024
  v_mfma_f32_32x32x16_bf16 v[24:39], v[76:79], a[180:183], v[24:39]
  s_add_u32 m0, s64, 0
  s_add_u32 s66, s59, 32768
  buffer_load_dwordx4 v1, s[28:31], s66 offen offset:0 lds
  ds_read_b64_tr_b16 v[76:77], v148 offset:33792
  ds_read_b64_tr_b16 v[78:79], v148 offset:34048
  s_waitcnt lgkmcnt(8)
  v_mfma_f32_32x32x16_bf16 v[8:23], v[80:83], a[184:187], v[8:23]
  ds_read_b64_tr_b16 v[80:81], v148 offset:34816
  ds_read_b64_tr_b16 v[82:83], v148 offset:35072
  v_mfma_f32_32x32x16_bf16 v[24:39], v[84:87], a[184:187], v[24:39]
  ds_read_b64_tr_b16 v[84:85], v148 offset:35840
  ds_read_b64_tr_b16 v[86:87], v148 offset:36096
  s_waitcnt lgkmcnt(8)
  v_mfma_f32_32x32x16_bf16 v[8:23], v[88:91], a[188:191], v[8:23]
  buffer_load_dwordx4 v1, s[28:31], s66 offen offset:1024 lds
  ds_read_b64_tr_b16 v[88:89], v148 offset:36864
  ds_read_b64_tr_b16 v[90:91], v148 offset:37120
  v_mfma_f32_32x32x16_bf16 v[24:39], v[92:95], a[188:191], v[24:39]
  ds_read_b64_tr_b16 v[92:93], v148 offset:37888
  ds_read_b64_tr_b16 v[94:95], v148 offset:38144
  s_waitcnt lgkmcnt(8)
  v_mfma_f32_32x32x16_bf16 v[8:23], v[72:75], a[192:195], v[8:23]
  ds_read_b64_tr_b16 v[72:73], v148 offset:38912
  ds_read_b64_tr_b16 v[74:75], v148 offset:39168
  v_mfma_f32_32x32x16_bf16 v[24:39], v[76:79], a[192:195], v[24:39]
  buffer_load_dwordx4 v1, s[28:31], s66 offen offset:2048 lds
  ds_read_b64_tr_b16 v[76:77], v148 offset:39936
  ds_read_b64_tr_b16 v[78:79], v148 offset:40192
  s_waitcnt lgkmcnt(8)
  v_mfma_f32_32x32x16_bf16 v[8:23], v[80:83], a[196:199], v[8:23]
  ds_read_b64_tr_b16 v[80:81], v148 offset:40960
  ds_read_b64_tr_b16 v[82:83], v148 offset:41216
  v_mfma_f32_32x32x16_bf16 v[24:39], v[84:87], a[196:199], v[24:39]
  ds_read_b64_tr_b16 v[84:85], v148 offset:41984
  ds_read_b64_tr_b16 v[86:87], v148 offset:42240
  s_waitcnt lgkmcnt(8)
  v_mfma_f32_32x32x16_bf16 v[8:23], v[88:91], a[200:203], v[8:23]
  buffer_load_dwordx4 v1, s[28:31], s66 offen offset:3072 lds
  ds_read_b64_tr_b16 v[88:89], v148 offset:43008
  ds_read_b64_tr_b16 v[90:91], v148 offset:43264
  v_mfma_f32_32x32x16_bf16 v[24:39], v[92:95], a[200:203], v[24:39]
  ds_read_b64_tr_b16 v[92:93], v148 offset:44032
  ds_read_b64_tr_b16 v[94:95], v148 offset:44288
  s_waitcnt lgkmcnt(8)
  v_mfma_f32_32x32x16_bf16 v[8:23], v[72:75], a[204:207], v[8:23]
  ds_read_b64_tr_b16 v[72:73], v148 offset:45056
  ds_read_b64_tr_b16 v[74:75], v148 offset:45312
  v_mfma_f32_32x32x16_bf16 v[24:39], v[76:79], a[204:207], v[24:39]
  ds_read_b64_tr_b16 v[76:77], v148 offset:46080
  ds_read_b64_tr_b16 v[78:79], v148 offset:46336
  s_waitcnt lgkmcnt(8)
  v_mfma_f32_32x32x16_bf16 v[8:23], v[80:83], a[208:211], v[8:23]
  ds_read_b64_tr_b16 v[80:81], v148 offset:47104
  ds_read_b64_tr_b16 v[82:83], v148 offset:47360
  v_mfma_f32_32x32x16_bf16 v[24:39], v[84:87], a[208:211], v[24:39]
  s_waitcnt vmcnt(12)
  s_barrier
  ds_read_b64_tr_b16 v[84:85], v148 offset:48128
  ds_read_b64_tr_b16 v[86:87], v148 offset:48384
  s_waitcnt lgkmcnt(8)
  v_mfma_f32_32x32x16_bf16 v[8:23], v[88:91], a[212:215], v[8:23]
  ds_read_b64_tr_b16 v[88:89], v148 offset:49152
  ds_read_b64_tr_b16 v[90:91], v148 offset:49408
  v_mfma_f32_32x32x16_bf16 v[24:39], v[92:95], a[212:215], v[24:39]
  s_add_u32 m0, s64, 16384
  s_add_u32 s66, s59, 49152
  buffer_load_dwordx4 v1, s[28:31], s66 offen offset:0 lds
  ds_read_b64_tr_b16 v[92:93], v148 offset:50176
  ds_read_b64_tr_b16 v[94:95], v148 offset:50432
  s_waitcnt lgkmcnt(8)
  v_mfma_f32_32x32x16_bf16 v[8:23], v[72:75], a[216:219], v[8:23]
  ds_read_b64_tr_b16 v[72:73], v148 offset:51200
  ds_read_b64_tr_b16 v[74:75], v148 offset:51456
  v_mfma_f32_32x32x16_bf16 v[24:39], v[76:79], a[216:219], v[24:39]
  ds_read_b64_tr_b16 v[76:77], v148 offset:52224
  ds_read_b64_tr_b16 v[78:79], v148 offset:52480
  s_waitcnt lgkmcnt(8)
  v_mfma_f32_32x32x16_bf16 v[8:23], v[80:83], a[220:223], v[8:23]
  buffer_load_dwordx4 v1, s[28:31], s66 offen offset:1024 lds
  ds_read_b64_tr_b16 v[80:81], v148 offset:53248
  ds_read_b64_tr_b16 v[82:83], v148 offset:53504
  v_mfma_f32_32x32x16_bf16 v[24:39], v[84:87], a[220:223], v[24:39]
  ds_read_b64_tr_b16 v[84:85], v148 offset:54272
  ds_read_b64_tr_b16 v[86:87], v148 offset:54528
  s_waitcnt lgkmcnt(8)
  v_mfma_f32_32x32x16_bf16 v[8:23], v[88:91], a[224:227], v[8:23]
  ds_read_b64_tr_b16 v[88:89], v148 offset:55296
  ds_read_b64_tr_b16 v[90:91], v148 offset:55552
  v_mfma_f32_32x32x16_bf16 v[24:39], v[92:95], a[224:227], v[24:39]
  buffer_load_dwordx4 v1, s[28:31], s66 offen offset:2048 lds
  ds_read_b64_tr_b16 v[92:93], v148 offset:56320
  ds_read_b64_tr_b16 v[94:95], v148 offset:56576
  s_waitcnt lgkmcnt(8)
  v_mfma_f32_32x32x16_bf16 v[8:23], v[72:75], a[228:231], v[8:23]
  ds_read_b64_tr_b16 v[72:73], v148 offset:57344
  ds_read_b64_tr_b16 v[74:75], v148 offset:57600
  v_mfma_f32_32x32x16_bf16 v[24:39], v[76:79], a[228:231], v[24:39]
  ds_read_b64_tr_b16 v[76:77], v148 offset:58368
  ds_read_b64_tr_b16 v[78:79], v148 offset:58624
  s_waitcnt lgkmcnt(8)
  v_mfma_f32_32x32x16_bf16 v[8:23], v[80:83], a[232:235], v[8:23]
  buffer_load_dwordx4 v1, s[28:31], s66 offen offset:3072 lds
  ds_read_b64_tr_b16 v[80:81], v148 offset:59392
  ds_read_b64_tr_b16 v[82:83], v148 offset:59648
  v_mfma_f32_32x32x16_bf16 v[24:39], v[84:87], a[232:235], v[24:39]
  ds_read_b64_tr_b16 v[84:85], v148 offset:60416
  ds_read_b64_tr_b16 v[86:87], v148 offset:60672
  s_waitcnt lgkmcnt(8)
  v_mfma_f32_32x32x16_bf16 v[8:23], v[88:91], a[236:239], v[8:23]
  ds_read_b64_tr_b16 v[88:89], v148 offset:61440
  ds_read_b64_tr_b16 v[90:91], v148 offset:61696
  v_mfma_f32_32x32x16_bf16 v[24:39], v[92:95], a[236:239], v[24:39]
  ds_read_b64_tr_b16 v[92:93], v148 offset:62464
  ds_read_b64_tr_b16 v[94:95], v148 offset:62720
  s_waitcnt lgkmcnt(8)
  v_mfma_f32_32x32x16_bf16 v[8:23], v[72:75], a[240:243], v[8:23]
  ds_read_b64_tr_b16 v[72:73], v148 offset:63488
  ds_read_b64_tr_b16 v[74:75], v148 offset:63744
  v_mfma_f32_32x32x16_bf16 v[24:39], v[76:79], a[240:243], v[24:39]
  s_waitcnt vmcnt(12)
  s_barrier
  ds_read_b64_tr_b16 v[76:77], v148 offset:64512
  ds_read_b64_tr_b16 v[78:79], v148 offset:64768
  s_waitcnt lgkmcnt(8)
  v_mfma_f32_32x32x16_bf16 v[8:23], v[80:83], a[244:247], v[8:23]
  ds_read_b64_tr_b16 v[80:81], v149 offset:0
  ds_read_b64_tr_b16 v[82:83], v149 offset:256
  v_mfma_f32_32x32x16_bf16 v[24:39], v[84:87], a[244:247], v[24:39]
  s_add_u32 m0, s64, 32768
  s_add_u32 s66, s59, 65536
  buffer_load_dwordx4 v1, s[28:31], s66 offen offset:0 lds
  ds_read_b64_tr_b16 v[84:85], v149 offset:1024
  ds_read_b64_tr_b16 v[86:87], v149 offset:1280
  s_waitcnt lgkmcnt(8)
  v_mfma_f32_32x32x16_bf16 v[8:23], v[88:91], a[248:251], v[8:23]
  ds_read_b64_tr_b16 v[88:89], v149 offset:2048
  ds_read_b64_tr_b16 v[90:91], v149 offset:2304
  v_mfma_f32_32x32x16_bf16 v[24:39], v[92:95], a[248:251], v[24:39]
  ds_read_b64_tr_b16 v[92:93], v149 offset:3072
  ds_read_b64_tr_b16 v[94:95], v149 offset:3328
  s_waitcnt lgkmcnt(8)
  v_mfma_f32_32x32x16_bf16 v[8:23], v[72:75], a[252:255], v[8:23]
  buffer_load_dwordx4 v1, s[28:31], s66 offen offset:1024 lds
  ds_read_b64_tr_b16 v[72:73], v149 offset:4096
  ds_read_b64_tr_b16 v[74:75], v149 offset:4352
  v_mfma_f32_32x32x16_bf16 v[24:39], v[76:79], a[252:255], v[24:39]
  ds_read_b64_tr_b16 v[76:77], v149 offset:5120
  ds_read_b64_tr_b16 v[78:79], v149 offset:5376
  s_waitcnt lgkmcnt(8)
  v_mfma_f32_32x32x16_bf16 v[40:55], v[80:83], a[0:3], 0
  ds_read_b64_tr_b16 v[80:81], v149 offset:6144
  ds_read_b64_tr_b16 v[82:83], v149 offset:6400
  v_mfma_f32_32x32x16_bf16 v[56:71], v[84:87], a[0:3], 0
  buffer_load_dwordx4 v1, s[28:31], s66 offen offset:2048 lds
  ds_read_b64_tr_b16 v[84:85], v149 offset:7168
  ds_read_b64_tr_b16 v[86:87], v149 offset:7424
  s_waitcnt lgkmcnt(8)
  v_mfma_f32_32x32x16_bf16 v[40:55], v[88:91], a[4:7], v[40:55]
  ds_read_b64_tr_b16 v[88:89], v149 offset:8192
  ds_read_b64_tr_b16 v[90:91], v149 offset:8448
  v_mfma_f32_32x32x16_bf16 v[56:71], v[92:95], a[4:7], v[56:71]
  ds_read_b64_tr_b16 v[92:93], v149 offset:9216
  ds_read_b64_tr_b16 v[94:95], v149 offset:9472
  s_waitcnt lgkmcnt(8)
  v_mfma_f32_32x32x16_bf16 v[40:55], v[72:75], a[8:11], v[40:55]
  buffer_load_dwordx4 v1, s[28:31], s66 offen offset:3072 lds
  ds_read_b64_tr_b16 v[72:73], v149 offset:10240
  ds_read_b64_tr_b16 v[74:75], v149 offset:10496
  v_mfma_f32_32x32x16_bf16 v[56:71], v[76:79], a[8:11], v[56:71]
  ds_read_b64_tr_b16 v[76:77], v149 offset:11264
  ds_read_b64_tr_b16 v[78:79], v149 offset:11520
  v_cvt_pk_bf16_f32 v128, v8, v9
  v_cvt_pk_bf16_f32 v129, v10, v11
  v_cvt_pk_bf16_f32 v130, v12, v13
  v_cvt_pk_bf16_f32 v131, v14, v15
  v_cvt_pk_bf16_f32 v132, v16, v17
  v_cvt_pk_bf16_f32 v133, v18, v19
  v_cvt_pk_bf16_f32 v134, v20, v21
  v_cvt_pk_bf16_f32 v135, v22, v23
  v_cvt_pk_bf16_f32 v136, v24, v25
  v_cvt_pk_bf16_f32 v137, v26, v27
  v_cvt_pk_bf16_f32 v138, v28, v29
  v_cvt_pk_bf16_f32 v139, v30, v31
  v_cvt_pk_bf16_f32 v140, v32, v33
  v_cvt_pk_bf16_f32 v141, v34, v35
  v_cvt_pk_bf16_f32 v142, v36, v37
  v_cvt_pk_bf16_f32 v143, v38, v39
  s_xor_b32 s60, s52, 1
  s_add_u32 s56, s65, s60
  s_lshl_b32 s56, s56, 14
  s_lshl_b32 s60, s42, 12
  s_add_u32 s56, s56, s60
  s_add_u32 s56, s56, s46
  s_add_u32 s56, s56, 26214400
  buffer_store_dwordx4 v[128:131], v1, s[28:31], s56 offen offset:0 sc1
  buffer_store_dwordx4 v[132:135], v1, s[28:31], s56 offen offset:1024 sc1
  buffer_store_dwordx4 v[136:139], v1, s[28:31], s56 offen offset:2048 sc1
  buffer_store_dwordx4 v[140:143], v1, s[28:31], s56 offen offset:3072 sc1
  s_waitcnt lgkmcnt(8)
  v_mfma_f32_32x32x16_bf16 v[40:55], v[80:83], a[12:15], v[40:55]
  ds_read_b64_tr_b16 v[80:81], v149 offset:12288
  ds_read_b64_tr_b16 v[82:83], v149 offset:12544
  v_mfma_f32_32x32x16_bf16 v[56:71], v[84:87], a[12:15], v[56:71]
  ds_read_b64_tr_b16 v[84:85], v149 offset:13312
  ds_read_b64_tr_b16 v[86:87], v149 offset:13568
  s_waitcnt lgkmcnt(8)
  v_mfma_f32_32x32x16_bf16 v[40:55], v[88:91], a[16:19], v[40:55]
  ds_read_b64_tr_b16 v[88:89], v149 offset:14336
  ds_read_b64_tr_b16 v[90:91], v149 offset:14592
  v_mfma_f32_32x32x16_bf16 v[56:71], v[92:95], a[16:19], v[56:71]
  s_waitcnt vmcnt(16)
  s_barrier
  ds_read_b64_tr_b16 v[92:93], v149 offset:15360
  ds_read_b64_tr_b16 v[94:95], v149 offset:15616
  s_waitcnt lgkmcnt(8)
  v_mfma_f32_32x32x16_bf16 v[40:55], v[72:75], a[20:23], v[40:55]
  ds_read_b64_tr_b16 v[72:73], v149 offset:16384
  ds_read_b64_tr_b16 v[74:75], v149 offset:16640
  v_mfma_f32_32x32x16_bf16 v[56:71], v[76:79], a[20:23], v[56:71]
  s_add_u32 m0, s64, 49152
  s_add_u32 s66, s59, 81920
  buffer_load_dwordx4 v1, s[28:31], s66 offen offset:0 lds
  ds_read_b64_tr_b16 v[76:77], v149 offset:17408
  ds_read_b64_tr_b16 v[78:79], v149 offset:17664
  s_waitcnt lgkmcnt(8)
  v_mfma_f32_32x32x16_bf16 v[40:55], v[80:83], a[24:27], v[40:55]
  ds_read_b64_tr_b16 v[80:81], v149 offset:18432
  ds_read_b64_tr_b16 v[82:83], v149 offset:18688
  v_mfma_f32_32x32x16_bf16 v[56:71], v[84:87], a[24:27], v[56:71]
  ds_read_b64_tr_b16 v[84:85], v149 offset:19456
  ds_read_b64_tr_b16 v[86:87], v149 offset:19712
  s_waitcnt lgkmcnt(8)
  v_mfma_f32_32x32x16_bf16 v[40:55], v[88:91], a[28:31], v[40:55]
  buffer_load_dwordx4 v1, s[28:31], s66 offen offset:1024 lds
  ds_read_b64_tr_b16 v[88:89], v149 offset:20480
  ds_read_b64_tr_b16 v[90:91], v149 offset:20736
  v_mfma_f32_32x32x16_bf16 v[56:71], v[92:95], a[28:31], v[56:71]
  ds_read_b64_tr_b16 v[92:93], v149 offset:21504
  ds_read_b64_tr_b16 v[94:95], v149 offset:21760
  s_waitcnt lgkmcnt(8)
  v_mfma_f32_32x32x16_bf16 v[40:55], v[72:75], a[32:35], v[40:55]
  ds_read_b64_tr_b16 v[72:73], v149 offset:22528
  ds_read_b64_tr_b16 v[74:75], v149 offset:22784
  v_mfma_f32_32x32x16_bf16 v[56:71], v[76:79], a[32:35], v[56:71]
  buffer_load_dwordx4 v1, s[28:31], s66 offen offset:2048 lds
  ds_read_b64_tr_b16 v[76:77], v149 offset:23552
  ds_read_b64_tr_b16 v[78:79], v149 offset:23808
  s_waitcnt lgkmcnt(8)
  v_mfma_f32_32x32x16_bf16 v[40:55], v[80:83], a[36:39], v[40:55]
  ds_read_b64_tr_b16 v[80:81], v149 offset:24576
  ds_read_b64_tr_b16 v[82:83], v149 offset:24832
  v_mfma_f32_32x32x16_bf16 v[56:71], v[84:87], a[36:39], v[56:71]
  ds_read_b64_tr_b16 v[84:85], v149 offset:25600
  ds_read_b64_tr_b16 v[86:87], v149 offset:25856
  s_waitcnt lgkmcnt(8)
  v_mfma_f32_32x32x16_bf16 v[40:55], v[88:91], a[40:43], v[40:55]
  buffer_load_dwordx4 v1, s[28:31], s66 offen offset:3072 lds
  ds_read_b64_tr_b16 v[88:89], v149 offset:26624
  ds_read_b64_tr_b16 v[90:91], v149 offset:26880
  v_mfma_f32_32x32x16_bf16 v[56:71], v[92:95], a[40:43], v[56:71]
  ds_read_b64_tr_b16 v[92:93], v149 offset:27648
  ds_read_b64_tr_b16 v[94:95], v149 offset:27904
  s_waitcnt lgkmcnt(8)
  v_mfma_f32_32x32x16_bf16 v[40:55], v[72:75], a[44:47], v[40:55]
  ds_read_b64_tr_b16 v[72:73], v149 offset:28672
  ds_read_b64_tr_b16 v[74:75], v149 offset:28928
  v_mfma_f32_32x32x16_bf16 v[56:71], v[76:79], a[44:47], v[56:71]
  ds_read_b64_tr_b16 v[76:77], v149 offset:29696
  ds_read_b64_tr_b16 v[78:79], v149 offset:29952
  s_waitcnt lgkmcnt(8)
  v_mfma_f32_32x32x16_bf16 v[40:55], v[80:83], a[48:51], v[40:55]
  ds_read_b64_tr_b16 v[80:81], v149 offset:30720
  ds_read_b64_tr_b16 v[82:83], v149 offset:30976
  v_mfma_f32_32x32x16_bf16 v[56:71], v[84:87], a[48:51], v[56:71]
  s_waitcnt vmcnt(16)
  s_barrier
  ds_read_b64_tr_b16 v[84:85], v149 offset:31744
  ds_read_b64_tr_b16 v[86:87], v149 offset:32000
  s_waitcnt lgkmcnt(8)
  v_mfma_f32_32x32x16_bf16 v[40:55], v[88:91], a[52:55], v[40:55]
  ds_read_b64_tr_b16 v[88:89], v148 offset:0
  ds_read_b64_tr_b16 v[90:91], v148 offset:256
  v_mfma_f32_32x32x16_bf16 v[56:71], v[92:95], a[52:55], v[56:71]
  s_add_u32 m0, s64, 65536
  s_add_u32 s66, s59, 98304
  buffer_load_dwordx4 v1, s[28:31], s66 offen offset:0 lds
  ds_read_b64_tr_b16 v[92:93], v148 offset:1024
  ds_read_b64_tr_b16 v[94:95], v148 offset:1280
  s_waitcnt lgkmcnt(8)
  v_mfma_f32_32x32x16_bf16 v[40:55], v[72:75], a[56:59], v[40:55]
  ds_read_b64_tr_b16 v[72:73], v148 offset:2048
  ds_read_b64_tr_b16 v[74:75], v148 offset:2304
  v_mfma_f32_32x32x16_bf16 v[56:71], v[76:79], a[56:59], v[56:71]
  ds_read_b64_tr_b16 v[76:77], v148 offset:3072
  ds_read_b64_tr_b16 v[78:79], v148 offset:3328
  s_waitcnt lgkmcnt(8)
  v_mfma_f32_32x32x16_bf16 v[40:55], v[80:83], a[60:63], v[40:55]
  buffer_load_dwordx4 v1, s[28:31], s66 offen offset:1024 lds
  ds_read_b64_tr_b16 v[80:81], v148 offset:4096
  ds_read_b64_tr_b16 v[82:83], v148 offset:4352
  v_mfma_f32_32x32x16_bf16 v[56:71], v[84:87], a[60:63], v[56:71]
  ds_read_b64_tr_b16 v[84:85], v148 offset:5120
  ds_read_b64_tr_b16 v[86:87], v148 offset:5376
  s_waitcnt lgkmcnt(8)
  v_mfma_f32_32x32x16_bf16 v[40:55], v[88:91], a[64:67], v[40:55]
  ds_read_b64_tr_b16 v[88:89], v148 offset:6144
  ds_read_b64_tr_b16 v[90:91], v148 offset:6400
  v_mfma_f32_32x32x16_bf16 v[56:71], v[92:95], a[64:67], v[56:71]
  buffer_load_dwordx4 v1, s[28:31], s66 offen offset:2048 lds
  ds_read_b64_tr_b16 v[92:93], v148 offset:7168
  ds_read_b64_tr_b16 v[94:95], v148 offset:7424
  s_waitcnt lgkmcnt(8)
  v_mfma_f32_32x32x16_bf16 v[40:55], v[72:75], a[68:71], v[40:55]
  ds_read_b64_tr_b16 v[72:73], v148 offset:8192
  ds_read_b64_tr_b16 v[74:75], v148 offset:8448
  v_mfma_f32_32x32x16_bf16 v[56:71], v[76:79], a[68:71], v[56:71]
  ds_read_b64_tr_b16 v[76:77], v148 offset:9216
  ds_read_b64_tr_b16 v[78:79], v148 offset:9472
  s_waitcnt lgkmcnt(8)
  v_mfma_f32_32x32x16_bf16 v[40:55], v[80:83], a[72:75], v[40:55]
  buffer_load_dwordx4 v1, s[28:31], s66 offen offset:3072 lds
  ds_read_b64_tr_b16 v[80:81], v148 offset:10240
  ds_read_b64_tr_b16 v[82:83], v148 offset:10496
  v_mfma_f32_32x32x16_bf16 v[56:71], v[84:87], a[72:75], v[56:71]
  ds_read_b64_tr_b16 v[84:85], v148 offset:11264
  ds_read_b64_tr_b16 v[86:87], v148 offset:11520
  s_waitcnt lgkmcnt(8)
  v_mfma_f32_32x32x16_bf16 v[40:55], v[88:91], a[76:79], v[40:55]
  ds_read_b64_tr_b16 v[88:89], v148 offset:12288
  ds_read_b64_tr_b16 v[90:91], v148 offset:12544
  v_mfma_f32_32x32x16_bf16 v[56:71], v[92:95], a[76:79], v[56:71]
  ds_read_b64_tr_b16 v[92:93], v148 offset:13312
  ds_read_b64_tr_b16 v[94:95], v148 offset:13568
  s_waitcnt lgkmcnt(8)
  v_mfma_f32_32x32x16_bf16 v[40:55], v[72:75], a[80:83], v[40:55]
  ds_read_b64_tr_b16 v[72:73], v148 offset:14336
  ds_read_b64_tr_b16 v[74:75], v148 offset:14592
  v_mfma_f32_32x32x16_bf16 v[56:71], v[76:79], a[80:83], v[56:71]
  s_waitcnt vmcnt(16)
  s_waitcnt vmcnt(8)
  s_barrier
  s_add_u32 s56, s65, s52
  s_lshl_b32 s56, s56, 6
  s_add_u32 s56, s56, s46
  s_add_u32 s56, s56, 31477760
  s_cmp_lg_u32 s42, 0
  s_cbranch_scc1 L_pub_59
  v_mov_b32 v152, s40
  v_mov_b32 v153, s41
  v_mov_b32 v154, 0
  s_mov_b64 exec, 1
  s_cmp_eq_u32 s47, 0
  s_cbranch_scc1 L_stg_60
  buffer_store_dwordx2 v[152:153], v154, s[28:31], s56 offen
  s_branch L_std_61
L_stg_60:
  buffer_store_dwordx2 v[152:153], v154, s[28:31], s56 offen sc1
L_std_61:
  s_mov_b64 exec, -1
L_pub_59:
  ds_read_b64_tr_b16 v[76:77], v148 offset:15360
  ds_read_b64_tr_b16 v[78:79], v148 offset:15616
  s_waitcnt lgkmcnt(8)
  v_mfma_f32_32x32x16_bf16 v[40:55], v[80:83], a[84:87], v[40:55]
  ds_read_b64_tr_b16 v[80:81], v148 offset:16384
  ds_read_b64_tr_b16 v[82:83], v148 offset:16640
  v_mfma_f32_32x32x16_bf16 v[56:71], v[84:87], a[84:87], v[56:71]
  s_add_u32 m0, s64, 81920
  s_add_u32 s66, s59, 114688
  buffer_load_dwordx4 v1, s[28:31], s66 offen offset:0 lds
  ds_read_b64_tr_b16 v[84:85], v148 offset:17408
  ds_read_b64_tr_b16 v[86:87], v148 offset:17664
  s_waitcnt lgkmcnt(8)
  v_mfma_f32_32x32x16_bf16 v[40:55], v[88:91], a[88:91], v[40:55]
  ds_read_b64_tr_b16 v[88:89], v148 offset:18432
  ds_read_b64_tr_b16 v[90:91], v148 offset:18688
  v_mfma_f32_32x32x16_bf16 v[56:71], v[92:95], a[88:91], v[56:71]
  ds_read_b64_tr_b16 v[92:93], v148 offset:19456
  ds_read_b64_tr_b16 v[94:95], v148 offset:19712
  s_waitcnt lgkmcnt(8)
  v_mfma_f32_32x32x16_bf16 v[40:55], v[72:75], a[92:95], v[40:55]
  buffer_load_dwordx4 v1, s[28:31], s66 offen offset:1024 lds
  ds_read_b64_tr_b16 v[72:73], v148 offset:20480
  ds_read_b64_tr_b16 v[74:75], v148 offset:20736
  v_mfma_f32_32x32x16_bf16 v[56:71], v[76:79], a[92:95], v[56:71]
  ds_read_b64_tr_b16 v[76:77], v148 offset:21504
  ds_read_b64_tr_b16 v[78:79], v148 offset:21760
  s_waitcnt lgkmcnt(8)
  v_mfma_f32_32x32x16_bf16 v[40:55], v[80:83], a[96:99], v[40:55]
  ds_read_b64_tr_b16 v[80:81], v148 offset:22528
  ds_read_b64_tr_b16 v[82:83], v148 offset:22784
  v_mfma_f32_32x32x16_bf16 v[56:71], v[84:87], a[96:99], v[56:71]
  buffer_load_dwordx4 v1, s[28:31], s66 offen offset:2048 lds
  ds_read_b64_tr_b16 v[84:85], v148 offset:23552
  ds_read_b64_tr_b16 v[86:87], v148 offset:23808
  s_waitcnt lgkmcnt(8)
  v_mfma_f32_32x32x16_bf16 v[40:55], v[88:91], a[100:103], v[40:55]
  ds_read_b64_tr_b16 v[88:89], v148 offset:24576
  ds_read_b64_tr_b16 v[90:91], v148 offset:24832
  v_mfma_f32_32x32x16_bf16 v[56:71], v[92:95], a[100:103], v[56:71]
  ds_read_b64_tr_b16 v[92:93], v148 offset:25600
  ds_read_b64_tr_b16 v[94:95], v148 offset:25856
  s_waitcnt lgkmcnt(8)
  v_mfma_f32_32x32x16_bf16 v[40:55], v[72:75], a[104:107], v[40:55]
  buffer_load_dwordx4 v1, s[28:31], s66 offen offset:3072 lds
  ds_read_b64_tr_b16 v[72:73], v148 offset:26624
  ds_read_b64_tr_b16 v[74:75], v148 offset:26880
  v_mfma_f32_32x32x16_bf16 v[56:71], v[76:79], a[104:107], v[56:71]
  ds_read_b64_tr_b16 v[76:77], v148 offset:27648
  ds_read_b64_tr_b16 v[78:79], v148 offset:27904
  s_waitcnt lgkmcnt(8)
  v_mfma_f32_32x32x16_bf16 v[40:55], v[80:83], a[108:111], v[40:55]
  ds_read_b64_tr_b16 v[80:81], v148 offset:28672
  ds_read_b64_tr_b16 v[82:83], v148 offset:28928
  v_mfma_f32_32x32x16_bf16 v[56:71], v[84:87], a[108:111], v[56:71]
  ds_read_b64_tr_b16 v[84:85], v148 offset:29696
  ds_read_b64_tr_b16 v[86:87], v148 offset:29952
  s_waitcnt lgkmcnt(8)
  v_mfma_f32_32x32x16_bf16 v[40:55], v[88:91], a[112:115], v[40:55]
  ds_read_b64_tr_b16 v[88:89], v148 offset:30720
  ds_read_b64_tr_b16 v[90:91], v148 offset:30976
  v_mfma_f32_32x32x16_bf16 v[56:71], v[92:95], a[112:115], v[56:71]
  s_barrier
  ds_read_b64_tr_b16 v[92:93], v148 offset:31744
  ds_read_b64_tr_b16 v[94:95], v148 offset:32000
  s_waitcnt lgkmcnt(8)
  v_mfma_f32_32x32x16_bf16 v[40:55], v[72:75], a[116:119], v[40:55]
  ds_read_b64_tr_b16 v[72:73], v148 offset:32768
  ds_read_b64_tr_b16 v[74:75], v148 offset:33024
  v_mfma_f32_32x32x16_bf16 v[56:71], v[76:79], a[116:119], v[56:71]
  s_add_u32 s69, s42, 30
  s_mul_i32 s70, s69, 14336
  s_add_u32 s70, s70, s68
  s_mul_i32 s71, s69, 2048
  s_add_u32 m0, s71, 0
  s_add_u32 s72, s70, 0
  buffer_load_dwordx4 v4, s[36:39], s72 offen lds
  ds_read_b64_tr_b16 v[76:77], v148 offset:33792
  ds_read_b64_tr_b16 v[78:79], v148 offset:34048
  s_waitcnt lgkmcnt(8)
  v_mfma_f32_32x32x16_bf16 v[40:55], v[80:83], a[120:123], v[40:55]
  ds_read_b64_tr_b16 v[80:81], v148 offset:34816
  ds_read_b64_tr_b16 v[82:83], v148 offset:35072
  v_mfma_f32_32x32x16_bf16 v[56:71], v[84:87], a[120:123], v[56:71]
  ds_read_b64_tr_b16 v[84:85], v148 offset:35840
  ds_read_b64_tr_b16 v[86:87], v148 offset:36096
  s_waitcnt lgkmcnt(8)
  v_mfma_f32_32x32x16_bf16 v[40:55], v[88:91], a[124:127], v[40:55]
  s_add_u32 m0, s71, 1024
  s_add_u32 s72, s70, 64
  buffer_load_dwordx4 v4, s[36:39], s72 offen lds
  ds_read_b64_tr_b16 v[88:89], v148 offset:36864
  ds_read_b64_tr_b16 v[90:91], v148 offset:37120
  v_mfma_f32_32x32x16_bf16 v[56:71], v[92:95], a[124:127], v[56:71]
  ds_read_b64_tr_b16 v[92:93], v148 offset:37888
  ds_read_b64_tr_b16 v[94:95], v148 offset:38144
  s_waitcnt lgkmcnt(8)
  v_mfma_f32_32x32x16_bf16 v[40:55], v[72:75], a[128:131], v[40:55]
  ds_read_b64_tr_b16 v[72:73], v148 offset:38912
  ds_read_b64_tr_b16 v[74:75], v148 offset:39168
  v_mfma_f32_32x32x16_bf16 v[56:71], v[76:79], a[128:131], v[56:71]
  s_add_u32 s69, s42, 34
  s_mul_i32 s70, s69, 14336
  s_add_u32 s70, s70, s68
  s_mul_i32 s71, s69, 2048
  s_add_u32 m0, s71, 0
  s_add_u32 s72, s70, 0
  buffer_load_dwordx4 v4, s[36:39], s72 offen lds
  ds_read_b64_tr_b16 v[76:77], v148 offset:39936
  ds_read_b64_tr_b16 v[78:79], v148 offset:40192
  s_waitcnt lgkmcnt(8)
  v_mfma_f32_32x32x16_bf16 v[40:55], v[80:83], a[132:135], v[40:55]
  ds_read_b64_tr_b16 v[80:81], v148 offset:40960
  ds_read_b64_tr_b16 v[82:83], v148 offset:41216
  v_mfma_f32_32x32x16_bf16 v[56:71], v[84:87], a[132:135], v[56:71]
  ds_read_b64_tr_b16 v[84:85], v148 offset:41984
  ds_read_b64_tr_b16 v[86:87], v148 offset:42240
  s_waitcnt lgkmcnt(8)
  v_mfma_f32_32x32x16_bf16 v[40:55], v[88:91], a[136:139], v[40:55]
  s_add_u32 m0, s71, 1024
  s_add_u32 s72, s70, 64
  buffer_load_dwordx4 v4, s[36:39], s72 offen lds
  ds_read_b64_tr_b16 v[88:89], v148 offset:43008
  ds_read_b64_tr_b16 v[90:91], v148 offset:43264
  v_mfma_f32_32x32x16_bf16 v[56:71], v[92:95], a[136:139], v[56:71]
  ds_read_b64_tr_b16 v[92:93], v148 offset:44032
  ds_read_b64_tr_b16 v[94:95], v148 offset:44288
  s_waitcnt lgkmcnt(8)
  v_mfma_f32_32x32x16_bf16 v[40:55], v[72:75], a[140:143], v[40:55]
  ds_read_b64_tr_b16 v[72:73], v148 offset:45056
  ds_read_b64_tr_b16 v[74:75], v148 offset:45312
  v_mfma_f32_32x32x16_bf16 v[56:71], v[76:79], a[140:143], v[56:71]
  ds_read_b64_tr_b16 v[76:77], v148 offset:46080
  ds_read_b64_tr_b16 v[78:79], v148 offset:46336
  s_waitcnt lgkmcnt(8)
  v_mfma_f32_32x32x16_bf16 v[40:55], v[80:83], a[144:147], v[40:55]
  ds_read_b64_tr_b16 v[80:81], v148 offset:47104
  ds_read_b64_tr_b16 v[82:83], v148 offset:47360
  v_mfma_f32_32x32x16_bf16 v[56:71], v[84:87], a[144:147], v[56:71]
  s_waitcnt vmcnt(12)
  s_barrier
  s_mov_b32 s32, s16
  s_mov_b32 s33, s17
  s_mov_b32 s34, 4096
  s_mov_b32 s35, 0x20000
  v_and_b32 v150, 31, v0
  v_lshlrev_b32 v150, 1, v150
  s_lshl_b32 s56, s55, 6
  buffer_load_ushort v151, v150, s[32:35], s56 offen
  s_xor_b32 s60, s52, 1
  s_add_u32 s67, s65, s60
  s_lshl_b32 s67, s67, 6
  s_add_u32 s67, s67, s46
  s_add_u32 s67, s67, 31477760
  v_mov_b32 v158, 0
  buffer_load_dwordx2 v[156:157], v158, s[28:31], s67 offen sc1
  ds_read_b64_tr_b16 v[84:85], v148 offset:48128
  ds_read_b64_tr_b16 v[86:87], v148 offset:48384
  s_waitcnt lgkmcnt(8)
  v_mfma_f32_32x32x16_bf16 v[40:55], v[88:91], a[148:151], v[40:55]
  ds_read_b64_tr_b16 v[88:89], v148 offset:49152
  ds_read_b64_tr_b16 v[90:91], v148 offset:49408
  v_mfma_f32_32x32x16_bf16 v[56:71], v[92:95], a[148:151], v[56:71]
  s_add_u32 s69, s42, 38
  s_mul_i32 s70, s69, 14336
  s_add_u32 s70, s70, s68
  s_mul_i32 s71, s69, 2048
  s_add_u32 m0, s71, 0
  s_add_u32 s72, s70, 0
  buffer_load_dwordx4 v4, s[36:39], s72 offen lds
  ds_read_b64_tr_b16 v[92:93], v148 offset:50176
  ds_read_b64_tr_b16 v[94:95], v148 offset:50432
  s_waitcnt lgkmcnt(8)
  v_mfma_f32_32x32x16_bf16 v[40:55], v[72:75], a[152:155], v[40:55]
  ds_read_b64_tr_b16 v[72:73], v148 offset:51200
  ds_read_b64_tr_b16 v[74:75], v148 offset:51456
  v_mfma_f32_32x32x16_bf16 v[56:71], v[76:79], a[152:155], v[56:71]
  ds_read_b64_tr_b16 v[76:77], v148 offset:52224
  ds_read_b64_tr_b16 v[78:79], v148 offset:52480
  s_waitcnt lgkmcnt(8)
  v_mfma_f32_32x32x16_bf16 v[40:55], v[80:83], a[156:159], v[40:55]
  s_add_u32 m0, s71, 1024
  s_add_u32 s72, s70, 64
  buffer_load_dwordx4 v4, s[36:39], s72 offen lds
  ds_read_b64_tr_b16 v[80:81], v148 offset:53248
  ds_read_b64_tr_b16 v[82:83], v148 offset:53504
  v_mfma_f32_32x32x16_bf16 v[56:71], v[84:87], a[156:159], v[56:71]
  ds_read_b64_tr_b16 v[84:85], v148 offset:54272
  ds_read_b64_tr_b16 v[86:87], v148 offset:54528
  s_waitcnt lgkmcnt(8)
  v_mfma_f32_32x32x16_bf16 v[40:55], v[88:91], a[160:163], v[40:55]
  ds_read_b64_tr_b16 v[88:89], v148 offset:55296
  ds_read_b64_tr_b16 v[90:91], v148 offset:55552
  v_mfma_f32_32x32x16_bf16 v[56:71], v[92:95], a[160:163], v[56:71]
  s_add_u32 s69, s42, 42
  s_mul_i32 s70, s69, 14336
  s_add_u32 s70, s70, s68
  s_mul_i32 s71, s69, 2048
  s_add_u32 m0, s71, 0
  s_add_u32 s72, s70, 0
  buffer_load_dwordx4 v4, s[36:39], s72 offen lds
  ds_read_b64_tr_b16 v[92:93], v148 offset:56320
  ds_read_b64_tr_b16 v[94:95], v148 offset:56576
  s_waitcnt lgkmcnt(8)
  v_mfma_f32_32x32x16_bf16 v[40:55], v[72:75], a[164:167], v[40:55]
  ds_read_b64_tr_b16 v[72:73], v148 offset:57344
  ds_read_b64_tr_b16 v[74:75], v148 offset:57600
  v_mfma_f32_32x32x16_bf16 v[56:71], v[76:79], a[164:167], v[56:71]
  ds_read_b64_tr_b16 v[76:77], v148 offset:58368
  ds_read_b64_tr_b16 v[78:79], v148 offset:58624
  s_waitcnt lgkmcnt(8)
  v_mfma_f32_32x32x16_bf16 v[40:55], v[80:83], a[168:171], v[40:55]
  s_add_u32 m0, s71, 1024
  s_add_u32 s72, s70, 64
  buffer_load_dwordx4 v4, s[36:39], s72 offen lds
  ds_read_b64_tr_b16 v[80:81], v148 offset:59392
  ds_read_b64_tr_b16 v[82:83], v148 offset:59648
  v_mfma_f32_32x32x16_bf16 v[56:71], v[84:87], a[168:171], v[56:71]
  ds_read_b64_tr_b16 v[84:85], v148 offset:60416
  ds_read_b64_tr_b16 v[86:87], v148 offset:60672
  s_waitcnt lgkmcnt(8)
  v_mfma_f32_32x32x16_bf16 v[40:55], v[88:91], a[172:175], v[40:55]
  ds_read_b64_tr_b16 v[88:89], v148 offset:61440
  ds_read_b64_tr_b16 v[90:91], v148 offset:61696
  v_mfma_f32_32x32x16_bf16 v[56:71], v[92:95], a[172:175], v[56:71]
  ds_read_b64_tr_b16 v[92:93], v148 offset:62464
  ds_read_b64_tr_b16 v[94:95], v148 offset:62720
  s_waitcnt lgkmcnt(8)
  v_mfma_f32_32x32x16_bf16 v[40:55], v[72:75], a[176:179], v[40:55]
  ds_read_b64_tr_b16 v[72:73], v148 offset:63488
  ds_read_b64_tr_b16 v[74:75], v148 offset:63744
  v_mfma_f32_32x32x16_bf16 v[56:71], v[76:79], a[176:179], v[56:71]
  s_waitcnt vmcnt(14)
  s_barrier
  ds_read_b64_tr_b16 v[76:77], v148 offset:64512
  ds_read_b64_tr_b16 v[78:79], v148 offset:64768
  s_waitcnt lgkmcnt(8)
  v_mfma_f32_32x32x16_bf16 v[40:55], v[80:83], a[180:183], v[40:55]
  ds_read_b64_tr_b16 v[80:81], v149 offset:0
  ds_read_b64_tr_b16 v[82:83], v149 offset:256
  v_mfma_f32_32x32x16_bf16 v[56:71], v[84:87], a[180:183], v[56:71]
  s_add_u32 s69, s42, 46
  s_mul_i32 s70, s69, 14336
  s_add_u32 s70, s70, s68
  s_mul_i32 s71, s69, 2048
  s_add_u32 m0, s71, 0
  s_add_u32 s72, s70, 0
  buffer_load_dwordx4 v4, s[36:39], s72 offen lds
  ds_read_b64_tr_b16 v[84:85], v149 offset:1024
  ds_read_b64_tr_b16 v[86:87], v149 offset:1280
  s_waitcnt lgkmcnt(8)
  v_mfma_f32_32x32x16_bf16 v[40:55], v[88:91], a[184:187], v[40:55]
  ds_read_b64_tr_b16 v[88:89], v149 offset:2048
  ds_read_b64_tr_b16 v[90:91], v149 offset:2304
  v_mfma_f32_32x32x16_bf16 v[56:71], v[92:95], a[184:187], v[56:71]
  ds_read_b64_tr_b16 v[92:93], v149 offset:3072
  ds_read_b64_tr_b16 v[94:95], v149 offset:3328
  s_waitcnt lgkmcnt(8)
  v_mfma_f32_32x32x16_bf16 v[40:55], v[72:75], a[188:191], v[40:55]
  s_add_u32 m0, s71, 1024
  s_add_u32 s72, s70, 64
  buffer_load_dwordx4 v4, s[36:39], s72 offen lds
  ds_read_b64_tr_b16 v[72:73], v149 offset:4096
  ds_read_b64_tr_b16 v[74:75], v149 offset:4352
  v_mfma_f32_32x32x16_bf16 v[56:71], v[76:79], a[188:191], v[56:71]
  ds_read_b64_tr_b16 v[76:77], v149 offset:5120
  ds_read_b64_tr_b16 v[78:79], v149 offset:5376
  s_waitcnt lgkmcnt(8)
  v_mfma_f32_32x32x16_bf16 v[40:55], v[80:83], a[192:195], v[40:55]
  ds_read_b64_tr_b16 v[80:81], v149 offset:6144
  ds_read_b64_tr_b16 v[82:83], v149 offset:6400
  v_mfma_f32_32x32x16_bf16 v[56:71], v[84:87], a[192:195], v[56:71]
  s_add_u32 s69, s42, 50
  s_mul_i32 s70, s69, 14336
  s_add_u32 s70, s70, s68
  s_mul_i32 s71, s69, 2048
  s_add_u32 m0, s71, 0
  s_add_u32 s72, s70, 0
  buffer_load_dwordx4 v4, s[36:39], s72 offen lds
  ds_read_b64_tr_b16 v[84:85], v149 offset:7168
  ds_read_b64_tr_b16 v[86:87], v149 offset:7424
  s_waitcnt lgkmcnt(8)
  v_mfma_f32_32x32x16_bf16 v[40:55], v[88:91], a[196:199], v[40:55]
  ds_read_b64_tr_b16 v[88:89], v149 offset:8192
  ds_read_b64_tr_b16 v[90:91], v149 offset:8448
  v_mfma_f32_32x32x16_bf16 v[56:71], v[92:95], a[196:199], v[56:71]
  ds_read_b64_tr_b16 v[92:93], v149 offset:9216
  ds_read_b64_tr_b16 v[94:95], v149 offset:9472
  s_waitcnt lgkmcnt(8)
  v_mfma_f32_32x32x16_bf16 v[40:55], v[72:75], a[200:203], v[40:55]
  s_add_u32 m0, s71, 1024
  s_add_u32 s72, s70, 64
  buffer_load_dwordx4 v4, s[36:39], s72 offen lds
  ds_read_b64_tr_b16 v[72:73], v149 offset:10240
  ds_read_b64_tr_b16 v[74:75], v149 offset:10496
  v_mfma_f32_32x32x16_bf16 v[56:71], v[76:79], a[200:203], v[56:71]
  ds_read_b64_tr_b16 v[76:77], v149 offset:11264
  ds_read_b64_tr_b16 v[78:79], v149 offset:11520
  s_waitcnt lgkmcnt(8)
  v_mfma_f32_32x32x16_bf16 v[40:55], v[80:83], a[204:207], v[40:55]
  ds_read_b64_tr_b16 v[80:81], v149 offset:12288
  ds_read_b64_tr_b16 v[82:83], v149 offset:12544
  v_mfma_f32_32x32x16_bf16 v[56:71], v[84:87], a[204:207], v[56:71]
  ds_read_b64_tr_b16 v[84:85], v149 offset:13312
  ds_read_b64_tr_b16 v[86:87], v149 offset:13568
  s_waitcnt lgkmcnt(8)
  v_mfma_f32_32x32x16_bf16 v[40:55], v[88:91], a[208:211], v[40:55]
  ds_read_b64_tr_b16 v[88:89], v149 offset:14336
  ds_read_b64_tr_b16 v[90:91], v149 offset:14592
  v_mfma_f32_32x32x16_bf16 v[56:71], v[92:95], a[208:211], v[56:71]
  s_waitcnt vmcnt(14)
  s_barrier
  s_waitcnt vmcnt(8)
  v_cmp_eq_u32 vcc, s40, v156
  v_cmp_eq_u32 s[74:75], s41, v157
  s_nop 2
  s_and_b64 vcc, vcc, s[74:75]
  s_cmp_eq_u64 vcc, -1
  s_cbranch_scc1 L_fx_62
  s_mov_b32 s76, 0
L_poll_63:
  buffer_load_dwordx2 v[156:157], v158, s[28:31], s67 offen sc1
  s_waitcnt vmcnt(0)
  v_cmp_eq_u32 vcc, s40, v156
  v_cmp_eq_u32 s[74:75], s41, v157
  s_nop 2
  s_and_b64 vcc, vcc, s[74:75]
  s_cmp_eq_u64 vcc, -1
  s_cbranch_scc1 L_polld_64
  s_add_u32 s76, s76, 1
  s_cmp_lt_u32 s76, 0x40000
  s_cbranch_scc1 L_poll_63
L_polld_64:
L_fx_62:
  s_add_u32 s56, s65, s52
  s_lshl_b32 s56, s56, 14
  s_lshl_b32 s60, s42, 12
  s_add_u32 s56, s56, s60
  s_add_u32 s56, s56, s46
  s_add_u32 s56, s56, 26214400
  buffer_load_dwordx4 v[112:115], v1, s[28:31], s56 offen offset:0
  buffer_load_dwordx4 v[116:119], v1, s[28:31], s56 offen offset:1024
  buffer_load_dwordx4 v[120:123], v1, s[28:31], s56 offen offset:2048
  buffer_load_dwordx4 v[124:127], v1, s[28:31], s56 offen offset:3072
  ds_read_b64_tr_b16 v[92:93], v149 offset:15360
  ds_read_b64_tr_b16 v[94:95], v149 offset:15616
  s_waitcnt lgkmcnt(8)
  v_mfma_f32_32x32x16_bf16 v[40:55], v[72:75], a[212:215], v[40:55]
  ds_read_b64_tr_b16 v[72:73], v149 offset:16384
  ds_read_b64_tr_b16 v[74:75], v149 offset:16640
  v_mfma_f32_32x32x16_bf16 v[56:71], v[76:79], a[212:215], v[56:71]
  s_add_u32 s69, s42, 52
  s_mul_i32 s70, s69, 14336
  s_add_u32 s70, s70, s68
  s_mul_i32 s71, s69, 2048
  s_add_u32 m0, s71, 0
  s_add_u32 s72, s70, 0
  buffer_load_dwordx4 v4, s[36:39], s72 offen lds
  ds_read_b64_tr_b16 v[76:77], v149 offset:17408
  ds_read_b64_tr_b16 v[78:79], v149 offset:17664
  s_waitcnt lgkmcnt(8)
  v_mfma_f32_32x32x16_bf16 v[40:55], v[80:83], a[216:219], v[40:55]
  ds_read_b64_tr_b16 v[80:81], v149 offset:18432
  ds_read_b64_tr_b16 v[82:83], v149 offset:18688
  v_mfma_f32_32x32x16_bf16 v[56:71], v[84:87], a[216:219], v[56:71]
  ds_read_b64_tr_b16 v[84:85], v149 offset:19456
  ds_read_b64_tr_b16 v[86:87], v149 offset:19712
  s_waitcnt lgkmcnt(8)
  v_mfma_f32_32x32x16_bf16 v[40:55], v[88:91], a[220:223], v[40:55]
  s_add_u32 m0, s71, 1024
  s_add_u32 s72, s70, 64
  buffer_load_dwordx4 v4, s[36:39], s72 offen lds
  ds_read_b64_tr_b16 v[88:89], v149 offset:20480
  ds_read_b64_tr_b16 v[90:91], v149 offset:20736
  v_mfma_f32_32x32x16_bf16 v[56:71], v[92:95], a[220:223], v[56:71]
  ds_read_b64_tr_b16 v[92:93], v149 offset:21504
  ds_read_b64_tr_b16 v[94:95], v149 offset:21760
  s_waitcnt lgkmcnt(8)
  v_mfma_f32_32x32x16_bf16 v[40:55], v[72:75], a[224:227], v[40:55]
  ds_read_b64_tr_b16 v[72:73], v149 offset:22528
  ds_read_b64_tr_b16 v[74:75], v149 offset:22784
  v_mfma_f32_32x32x16_bf16 v[56:71], v[76:79], a[224:227], v[56:71]
  ds_read_b64_tr_b16 v[76:77], v149 offset:23552
  ds_read_b64_tr_b16 v[78:79], v149 offset:23808
  s_waitcnt lgkmcnt(8)
  v_mfma_f32_32x32x16_bf16 v[40:55], v[80:83], a[228:231], v[40:55]
  ds_read_b64_tr_b16 v[80:81], v149 offset:24576
  ds_read_b64_tr_b16 v[82:83], v149 offset:24832
  v_mfma_f32_32x32x16_bf16 v[56:71], v[84:87], a[228:231], v[56:71]
  ds_read_b64_tr_b16 v[84:85], v149 offset:25600
  ds_read_b64_tr_b16 v[86:87], v149 offset:25856
  s_waitcnt lgkmcnt(8)
  v_mfma_f32_32x32x16_bf16 v[40:55], v[88:91], a[232:235], v[40:55]
  ds_read_b64_tr_b16 v[88:89], v149 offset:26624
  ds_read_b64_tr_b16 v[90:91], v149 offset:26880
  v_mfma_f32_32x32x16_bf16 v[56:71], v[92:95], a[232:235], v[56:71]
  ds_read_b64_tr_b16 v[92:93], v149 offset:27648
  ds_read_b64_tr_b16 v[94:95], v149 offset:27904
  s_waitcnt lgkmcnt(8)
  v_mfma_f32_32x32x16_bf16 v[40:55], v[72:75], a[236:239], v[40:55]
  ds_read_b64_tr_b16 v[72:73], v149 offset:28672
  ds_read_b64_tr_b16 v[74:75], v149 offset:28928
  v_mfma_f32_32x32x16_bf16 v[56:71], v[76:79], a[236:239], v[56:71]
  ds_read_b64_tr_b16 v[76:77], v149 offset:29696
  ds_read_b64_tr_b16 v[78:79], v149 offset:29952
  s_waitcnt lgkmcnt(8)
  v_mfma_f32_32x32x16_bf16 v[40:55], v[80:83], a[240:243], v[40:55]
  ds_read_b64_tr_b16 v[80:81], v149 offset:30720
  ds_read_b64_tr_b16 v[82:83], v149 offset:30976
  v_mfma_f32_32x32x16_bf16 v[56:71], v[84:87], a[240:243], v[56:71]
  ds_read_b64_tr_b16 v[84:85], v149 offset:31744
  ds_read_b64_tr_b16 v[86:87], v149 offset:32000
  s_waitcnt lgkmcnt(8)
  v_mfma_f32_32x32x16_bf16 v[40:55], v[88:91], a[244:247], v[40:55]
  v_mfma_f32_32x32x16_bf16 v[56:71], v[92:95], a[244:247], v[56:71]
  s_waitcnt lgkmcnt(4)
  v_mfma_f32_32x32x16_bf16 v[40:55], v[72:75], a[248:251], v[40:55]
  v_mfma_f32_32x32x16_bf16 v[56:71], v[76:79], a[248:251], v[56:71]
  s_waitcnt lgkmcnt(0)
  v_mfma_f32_32x32x16_bf16 v[40:55], v[80:83], a[252:255], v[40:55]
  v_mfma_f32_32x32x16_bf16 v[56:71], v[84:87], a[252:255], v[56:71]
  s_barrier
  v_lshlrev_b32 v154, 16, v151
  s_nop 8
  v_pk_add_f32 v[40:41], v[40:41], v[154:155] op_sel_hi:[1,0]
  v_pk_add_f32 v[42:43], v[42:43], v[154:155] op_sel_hi:[1,0]
  v_pk_add_f32 v[44:45], v[44:45], v[154:155] op_sel_hi:[1,0]
  v_pk_add_f32 v[46:47], v[46:47], v[154:155] op_sel_hi:[1,0]
  v_pk_add_f32 v[48:49], v[48:49], v[154:155] op_sel_hi:[1,0]
  v_pk_add_f32 v[50:51], v[50:51], v[154:155] op_sel_hi:[1,0]
  v_pk_add_f32 v[52:53], v[52:53], v[154:155] op_sel_hi:[1,0]
  v_pk_add_f32 v[54:55], v[54:55], v[154:155] op_sel_hi:[1,0]
  v_pk_add_f32 v[56:57], v[56:57], v[154:155] op_sel_hi:[1,0]
  v_pk_add_f32 v[58:59], v[58:59], v[154:155] op_sel_hi:[1,0]
  v_pk_add_f32 v[60:61], v[60:61], v[154:155] op_sel_hi:[1,0]
  v_pk_add_f32 v[62:63], v[62:63], v[154:155] op_sel_hi:[1,0]
  v_pk_add_f32 v[64:65], v[64:65], v[154:155] op_sel_hi:[1,0]
  v_pk_add_f32 v[66:67], v[66:67], v[154:155] op_sel_hi:[1,0]
  v_pk_add_f32 v[68:69], v[68:69], v[154:155] op_sel_hi:[1,0]
  v_pk_add_f32 v[70:71], v[70:71], v[154:155] op_sel_hi:[1,0]
  s_waitcnt vmcnt(4)
  v_lshlrev_b32 v160, 16, v112
  v_and_b32 v161, 0xffff0000, v112
  v_lshlrev_b32 v162, 16, v113
  v_and_b32 v163, 0xffff0000, v113
  v_lshlrev_b32 v164, 16, v114
  v_and_b32 v165, 0xffff0000, v114
  v_lshlrev_b32 v166, 16, v115
  v_and_b32 v167, 0xffff0000, v115
  v_lshlrev_b32 v168, 16, v116
  v_and_b32 v169, 0xffff0000, v116
  v_lshlrev_b32 v170, 16, v117
  v_and_b32 v171, 0xffff0000, v117
  v_lshlrev_b32 v172, 16, v118
  v_and_b32 v173, 0xffff0000, v118
  v_lshlrev_b32 v174, 16, v119
  v_and_b32 v175, 0xffff0000, v119
  v_pk_add_f32 v[40:41], v[40:41], v[160:161]
  v_pk_add_f32 v[42:43], v[42:43], v[162:163]
  v_pk_add_f32 v[44:45], v[44:45], v[164:165]
  v_pk_add_f32 v[46:47], v[46:47], v[166:167]
  v_pk_add_f32 v[48:49], v[48:49], v[168:169]
  v_pk_add_f32 v[50:51], v[50:51], v[170:171]
  v_pk_add_f32 v[52:53], v[52:53], v[172:173]
  v_pk_add_f32 v[54:55], v[54:55], v[174:175]
  v_lshlrev_b32 v160, 16, v96
  v_and_b32 v161, 0xffff0000, v96
  v_lshlrev_b32 v162, 16, v97
  v_and_b32 v163, 0xffff0000, v97
  v_lshlrev_b32 v164, 16, v98
  v_and_b32 v165, 0xffff0000, v98
  v_lshlrev_b32 v166, 16, v99
  v_and_b32 v167, 0xffff0000, v99
  v_lshlrev_b32 v168, 16, v100
  v_and_b32 v169, 0xffff0000, v100
  v_lshlrev_b32 v170, 16, v101
  v_and_b32 v171, 0xffff0000, v101
  v_lshlrev_b32 v172, 16, v102
  v_and_b32 v173, 0xffff0000, v102
  v_lshlrev_b32 v174, 16, v103
  v_and_b32 v175, 0xffff0000, v103
  v_pk_mul_f32 v[40:41], v[40:41], v[160:161]
  v_pk_mul_f32 v[42:43], v[42:43], v[162:163]
  v_pk_mul_f32 v[44:45], v[44:45], v[164:165]
  v_pk_mul_f32 v[46:47], v[46:47], v[166:167]
  v_pk_mul_f32 v[48:49], v[48:49], v[168:169]
  v_pk_mul_f32 v[50:51], v[50:51], v[170:171]
  v_pk_mul_f32 v[52:53], v[52:53], v[172:173]
  v_pk_mul_f32 v[54:55], v[54:55], v[174:175]
  v_cvt_pk_bf16_f32 v128, v40, v41
  v_cvt_pk_bf16_f32 v129, v42, v43
  v_cvt_pk_bf16_f32 v130, v44, v45
  v_cvt_pk_bf16_f32 v131, v46, v47
  v_cvt_pk_bf16_f32 v132, v48, v49
  v_cvt_pk_bf16_f32 v133, v50, v51
  v_cvt_pk_bf16_f32 v134, v52, v53
  v_cvt_pk_bf16_f32 v135, v54, v55
  s_waitcnt vmcnt(2)
  v_lshlrev_b32 v160, 16, v120
  v_and_b32 v161, 0xffff0000, v120
  v_lshlrev_b32 v162, 16, v121
  v_and_b32 v163, 0xffff0000, v121
  v_lshlrev_b32 v164, 16, v122
  v_and_b32 v165, 0xffff0000, v122
  v_lshlrev_b32 v166, 16, v123
  v_and_b32 v167, 0xffff0000, v123
  v_lshlrev_b32 v168, 16, v124
  v_and_b32 v169, 0xffff0000, v124
  v_lshlrev_b32 v170, 16, v125
  v_and_b32 v171, 0xffff0000, v125
  v_lshlrev_b32 v172, 16, v126
  v_and_b32 v173, 0xffff0000, v126
  v_lshlrev_b32 v174, 16, v127
  v_and_b32 v175, 0xffff0000, v127
  v_pk_add_f32 v[56:57], v[56:57], v[160:161]
  v_pk_add_f32 v[58:59], v[58:59], v[162:163]
  v_pk_add_f32 v[60:61], v[60:61], v[164:165]
  v_pk_add_f32 v[62:63], v[62:63], v[166:167]
  v_pk_add_f32 v[64:65], v[64:65], v[168:169]
  v_pk_add_f32 v[66:67], v[66:67], v[170:171]
  v_pk_add_f32 v[68:69], v[68:69], v[172:173]
  v_pk_add_f32 v[70:71], v[70:71], v[174:175]
  v_lshlrev_b32 v160, 16, v104
  v_and_b32 v161, 0xffff0000, v104
  v_lshlrev_b32 v162, 16, v105
  v_and_b32 v163, 0xffff0000, v105
  v_lshlrev_b32 v164, 16, v106
  v_and_b32 v165, 0xffff0000, v106
  v_lshlrev_b32 v166, 16, v107
  v_and_b32 v167, 0xffff0000, v107
  v_lshlrev_b32 v168, 16, v108
  v_and_b32 v169, 0xffff0000, v108
  v_lshlrev_b32 v170, 16, v109
  v_and_b32 v171, 0xffff0000, v109
  v_lshlrev_b32 v172, 16, v110
  v_and_b32 v173, 0xffff0000, v110
  v_lshlrev_b32 v174, 16, v111
  v_and_b32 v175, 0xffff0000, v111
  v_pk_mul_f32 v[56:57], v[56:57], v[160:161]
  v_pk_mul_f32 v[58:59], v[58:59], v[162:163]
  v_pk_mul_f32 v[60:61], v[60:61], v[164:165]
  v_pk_mul_f32 v[62:63], v[62:63], v[166:167]
  v_pk_mul_f32 v[64:65], v[64:65], v[168:169]
  v_pk_mul_f32 v[66:67], v[66:67], v[170:171]
  v_pk_mul_f32 v[68:69], v[68:69], v[172:173]
  v_pk_mul_f32 v[70:71], v[70:71], v[174:175]
  v_cvt_pk_bf16_f32 v136, v56, v57
  v_cvt_pk_bf16_f32 v137, v58, v59
  v_cvt_pk_bf16_f32 v138, v60, v61
  v_cvt_pk_bf16_f32 v139, v62, v63
  v_cvt_pk_bf16_f32 v140, v64, v65
  v_cvt_pk_bf16_f32 v141, v66, v67
  v_cvt_pk_bf16_f32 v142, v68, v69
  v_cvt_pk_bf16_f32 v143, v70, v71
  s_add_u32 s56, s57, 22020096
  buffer_store_dwordx4 v[128:131], v1, s[28:31], s56 offen offset:0 sc1
  buffer_store_dwordx4 v[132:135], v1, s[28:31], s56 offen offset:1024 sc1
  buffer_store_dwordx4 v[136:139], v1, s[28:31], s56 offen offset:2048 sc1
  buffer_store_dwordx4 v[140:143], v1, s[28:31], s56 offen offset:3072 sc1
  s_cmp_lg_u32 s45, 0
  s_cbranch_scc1 L_noq5_65
  s_mov_b32 s36, s24
  s_mov_b32 s37, s25
  s_mov_b32 s38, 268435456
  s_mov_b32 s39, 0x20000
  v_mov_b32 v4, v1
  s_and_b32 s68, s44, 15
  s_mul_i32 s68, s68, 86016
  s_add_u32 s68, s68, 0
  s_add_u32 s69, s42, 0
L_wst_67:
  s_mul_i32 s70, s69, 3072
  s_add_u32 s70, s70, s68
  s_mul_i32 s71, s69, 3072
  s_add_u32 m0, s71, 114688
  s_add_u32 s72, s70, 0
  buffer_load_dwordx4 v4, s[36:39], s72 offen lds
  s_add_u32 m0, s71, 115712
  s_add_u32 s72, s70, 1024
  buffer_load_dwordx4 v4, s[36:39], s72 offen lds
  s_add_u32 m0, s71, 116736
  s_add_u32 s72, s70, 2048
  buffer_load_dwordx4 v4, s[36:39], s72 offen lds
  s_add_u32 s69, s69, 4
  s_cmp_lt_u32 s69, 12
  s_cbranch_scc1 L_wst_67
L_wstd_68:
  s_waitcnt vmcnt(9)
  s_branch L_noq5d_66
L_noq5_65:
  s_waitcnt vmcnt(0)
L_noq5d_66:
  s_waitcnt lgkmcnt(0)
  s_barrier
  s_lshl_b32 s56, s53, 7
  s_lshl_b32 s60, s54, 1
  s_add_u32 s60, s60, s52
  s_lshl_b32 s60, s60, 3
  s_add_u32 s56, s56, s60
  s_add_u32 s56, s56, s46
  s_add_u32 s56, s56, 31494144
  s_cmp_lg_u32 s42, 0
  s_cbranch_scc1 L_pub_69
  v_mov_b32 v144, s40
  v_mov_b32 v145, s41
  v_mov_b32 v146, 0
  s_mov_b64 exec, 1
  s_cmp_eq_u32 s47, 0
  s_cbranch_scc1 L_stg_70
  buffer_store_dwordx2 v[144:145], v146, s[28:31], s56 offen
  s_branch L_std_71
L_stg_70:
  buffer_store_dwordx2 v[144:145], v146, s[28:31], s56 offen sc1
L_std_71:
  s_mov_b64 exec, -1
L_pub_69:
  s_mul_i32 s52, s44, 37
  s_lshr_b32 s52, s52, 8
  s_mul_i32 s53, s52, 7
  s_sub_u32 s53, s44, s53
  s_lshl_b32 s77, s43, 2
  s_add_u32 s52, s52, s77
  s_and_b32 s54, s42, 1
  s_lshl_b32 s56, s52, 1
  s_add_u32 s54, s54, s56
  s_lshr_b32 s55, s42, 1
  s_lshl_b32 s57, s53, 1
  s_add_u32 s57, s57, s55
  s_mul_i32 s59, s54, 57344
  s_mul_i32 s60, s55, 28672
  s_add_u32 s59, s59, s60
  s_add_u32 s59, s59, 22020096
  s_add_u32 s59, s59, s46
  s_mul_i32 s64, s54, 28672
  s_lshl_b32 s60, s57, 11
  s_add_u32 s64, s64, s60
  s_add_u32 s64, s64, s46
  s_add_u32 s64, s64, 9437184
  s_mul_i32 s60, s55, 57344
  s_lshl_b32 s61, s55, 10
  s_add_u32 s62, s60, s61
  s_sub_u32 s63, s60, s61
  s_add_u32 s63, s63, 1024
  v_add_u32 v190, s62, v3
  v_add_u32 v191, s63, v3
  s_cmp_lg_u32 s42, 0
  s_cbranch_scc1 L_w0_72
  v_min_u32 v184, 13, v0
  v_lshlrev_b32 v184, 3, v184
  s_lshr_b32 s56, s52, 1
  s_lshl_b32 s56, s56, 7
  s_add_u32 s56, s56, s46
  s_add_u32 s56, s56, 31494144
  s_mov_b32 s76, 0
L_poll_73:
  buffer_load_dwordx2 v[186:187], v184, s[28:31], s56 offen sc1
  s_waitcnt vmcnt(0)
  v_cmp_eq_u32 vcc, s40, v186
  v_cmp_eq_u32 s[74:75], s41, v187
  s_nop 2
  s_and_b64 vcc, vcc, s[74:75]
  s_cmp_eq_u64 vcc, -1
  s_cbranch_scc1 L_polld_74
  s_add_u32 s76, s76, 1
  s_cmp_lt_u32 s76, 0x40000
  s_cbranch_scc1 L_poll_73
L_polld_74:
L_w0_72:
  s_barrier
  buffer_load_dwordx4 v[8:11], v1, s[28:31], s59 offen offset:0
  buffer_load_dwordx4 v[12:15], v1, s[28:31], s59 offen offset:1024
  buffer_load_dwordx4 v[16:19], v1, s[28:31], s59 offen offset:2048
  buffer_load_dwordx4 v[20:23], v1, s[28:31], s59 offen offset:3072
  s_add_u32 s59, s59, 4096
  buffer_load_dwordx4 v[24:27], v1, s[28:31], s59 offen offset:0
  buffer_load_dwordx4 v[28:31], v1, s[28:31], s59 offen offset:1024
  buffer_load_dwordx4 v[32:35], v1, s[28:31], s59 offen offset:2048
  buffer_load_dwordx4 v[36:39], v1, s[28:31], s59 offen offset:3072
  s_add_u32 s59, s59, 4096
  buffer_load_dwordx4 v[40:43], v1, s[28:31], s59 offen offset:0
  buffer_load_dwordx4 v[44:47], v1, s[28:31], s59 offen offset:1024
  buffer_load_dwordx4 v[48:51], v1, s[28:31], s59 offen offset:2048
  buffer_load_dwordx4 v[52:55], v1, s[28:31], s59 offen offset:3072
  ds_read_b64_tr_b16 v[152:153], v190 offset:0
  ds_read_b64_tr_b16 v[154:155], v190 offset:512
  ds_read_b64_tr_b16 v[156:157], v191 offset:0
  ds_read_b64_tr_b16 v[158:159], v191 offset:512
  ds_read_b64_tr_b16 v[160:161], v190 offset:2048
  ds_read_b64_tr_b16 v[162:163], v190 offset:2560
  ds_read_b64_tr_b16 v[164:165], v191 offset:2048
  ds_read_b64_tr_b16 v[166:167], v191 offset:2560
  ds_read_b64_tr_b16 v[168:169], v190 offset:4096
  ds_read_b64_tr_b16 v[170:171], v190 offset:4608
  ds_read_b64_tr_b16 v[172:173], v191 offset:4096
  ds_read_b64_tr_b16 v[174:175], v191 offset:4608
  s_waitcnt vmcnt(11)
  s_waitcnt lgkmcnt(8)
  v_mfma_f32_32x32x16_bf16 v[120:135], v[152:155], v[8:11], 0
  ds_read_b64_tr_b16 v[152:153], v190 offset:6144
  ds_read_b64_tr_b16 v[154:155], v190 offset:6656
  v_mfma_f32_32x32x16_bf16 v[136:151], v[156:159], v[8:11], 0
  s_add_u32 s59, s59, 4096
  buffer_load_dwordx4 v[56:59], v1, s[28:31], s59 offen offset:0
  ds_read_b64_tr_b16 v[156:157], v191 offset:6144
  ds_read_b64_tr_b16 v[158:159], v191 offset:6656
  s_waitcnt vmcnt(11)
  s_waitcnt lgkmcnt(8)
  v_mfma_f32_32x32x16_bf16 v[120:135], v[160:163], v[12:15], v[120:135]
  ds_read_b64_tr_b16 v[160:161], v190 offset:8192
  ds_read_b64_tr_b16 v[162:163], v190 offset:8704
  v_mfma_f32_32x32x16_bf16 v[136:151], v[164:167], v[12:15], v[136:151]
  buffer_load_dwordx4 v[60:63], v1, s[28:31], s59 offen offset:1024
  ds_read_b64_tr_b16 v[164:165], v191 offset:8192
  ds_read_b64_tr_b16 v[166:167], v191 offset:8704
  s_waitcnt vmcnt(11)
  s_waitcnt lgkmcnt(8)
  v_mfma_f32_32x32x16_bf16 v[120:135], v[168:171], v[16:19], v[120:135]
  ds_read_b64_tr_b16 v[168:169], v190 offset:10240
  ds_read_b64_tr_b16 v[170:171], v190 offset:10752
  v_mfma_f32_32x32x16_bf16 v[136:151], v[172:175], v[16:19], v[136:151]
  buffer_load_dwordx4 v[64:67], v1, s[28:31], s59 offen offset:2048
  ds_read_b64_tr_b16 v[172:173], v191 offset:10240
  ds_read_b64_tr_b16 v[174:175], v191 offset:10752
  s_waitcnt vmcnt(11)
  s_waitcnt lgkmcnt(8)
  v_mfma_f32_32x32x16_bf16 v[120:135], v[152:155], v[20:23], v[120:135]
  ds_read_b64_tr_b16 v[152:153], v190 offset:12288
  ds_read_b64_tr_b16 v[154:155], v190 offset:12800
  v_mfma_f32_32x32x16_bf16 v[136:151], v[156:159], v[20:23], v[136:151]
  buffer_load_dwordx4 v[68:71], v1, s[28:31], s59 offen offset:3072
  ds_read_b64_tr_b16 v[156:157], v191 offset:12288
  ds_read_b64_tr_b16 v[158:159], v191 offset:12800
  s_waitcnt vmcnt(11)
  s_waitcnt lgkmcnt(8)
  v_mfma_f32_32x32x16_bf16 v[120:135], v[160:163], v[24:27], v[120:135]
  ds_read_b64_tr_b16 v[160:161], v190 offset:14336
  ds_read_b64_tr_b16 v[162:163], v190 offset:14848
  v_mfma_f32_32x32x16_bf16 v[136:151], v[164:167], v[24:27], v[136:151]
  s_add_u32 s59, s59, 4096
  buffer_load_dwordx4 v[72:75], v1, s[28:31], s59 offen offset:0
  ds_read_b64_tr_b16 v[164:165], v191 offset:14336
  ds_read_b64_tr_b16 v[166:167], v191 offset:14848
  s_waitcnt vmcnt(11)
  s_waitcnt lgkmcnt(8)
  v_mfma_f32_32x32x16_bf16 v[120:135], v[168:171], v[28:31], v[120:135]
  ds_read_b64_tr_b16 v[168:169], v190 offset:16384
  ds_read_b64_tr_b16 v[170:171], v190 offset:16896
  v_mfma_f32_32x32x16_bf16 v[136:151], v[172:175], v[28:31], v[136:151]
  buffer_load_dwordx4 v[76:79], v1, s[28:31], s59 offen offset:1024
  ds_read_b64_tr_b16 v[172:173], v191 offset:16384
  ds_read_b64_tr_b16 v[174:175], v191 offset:16896
  s_waitcnt vmcnt(11)
  s_waitcnt lgkmcnt(8)
  v_mfma_f32_32x32x16_bf16 v[120:135], v[152:155], v[32:35], v[120:135]
  ds_read_b64_tr_b16 v[152:153], v190 offset:18432
  ds_read_b64_tr_b16 v[154:155], v190 offset:18944
  v_mfma_f32_32x32x16_bf16 v[136:151], v[156:159], v[32:35], v[136:151]
  buffer_load_dwordx4 v[80:83], v1, s[28:31], s59 offen offset:2048
  ds_read_b64_tr_b16 v[156:157], v191 offset:18432
  ds_read_b64_tr_b16 v[158:159], v191 offset:18944
  s_waitcnt vmcnt(11)
  s_waitcnt lgkmcnt(8)
  v_mfma_f32_32x32x16_bf16 v[120:135], v[160:163], v[36:39], v[120:135]
  ds_read_b64_tr_b16 v[160:161], v190 offset:20480
  ds_read_b64_tr_b16 v[162:163], v190 offset:20992
  v_mfma_f32_32x32x16_bf16 v[136:151], v[164:167], v[36:39], v[136:151]
  buffer_load_dwordx4 v[84:87], v1, s[28:31], s59 offen offset:3072
  ds_read_b64_tr_b16 v[164:165], v191 offset:20480
  ds_read_b64_tr_b16 v[166:167], v191 offset:20992
  s_waitcnt vmcnt(11)
  s_waitcnt lgkmcnt(8)
  v_mfma_f32_32x32x16_bf16 v[120:135], v[168:171], v[40:43], v[120:135]
  ds_read_b64_tr_b16 v[168:169], v190 offset:22528
  ds_read_b64_tr_b16 v[170:171], v190 offset:23040
  v_mfma_f32_32x32x16_bf16 v[136:151], v[172:175], v[40:43], v[136:151]
  s_add_u32 s59, s59, 4096
  buffer_load_dwordx4 v[88:91], v1, s[28:31], s59 offen offset:0
  ds_read_b64_tr_b16 v[172:173], v191 offset:22528
  ds_read_b64_tr_b16 v[174:175], v191 offset:23040
  s_waitcnt vmcnt(11)
  s_waitcnt lgkmcnt(8)
  v_mfma_f32_32x32x16_bf16 v[120:135], v[152:155], v[44:47], v[120:135]
  ds_read_b64_tr_b16 v[152:153], v190 offset:24576
  ds_read_b64_tr_b16 v[154:155], v190 offset:25088
  v_mfma_f32_32x32x16_bf16 v[136:151], v[156:159], v[44:47], v[136:151]
  buffer_load_dwordx4 v[92:95], v1, s[28:31], s59 offen offset:1024
  ds_read_b64_tr_b16 v[156:157], v191 offset:24576
  ds_read_b64_tr_b16 v[158:159], v191 offset:25088
  s_waitcnt vmcnt(11)
  s_waitcnt lgkmcnt(8)
  v_mfma_f32_32x32x16_bf16 v[120:135], v[160:163], v[48:51], v[120:135]
  ds_read_b64_tr_b16 v[160:161], v190 offset:26624
  ds_read_b64_tr_b16 v[162:163], v190 offset:27136
  v_mfma_f32_32x32x16_bf16 v[136:151], v[164:167], v[48:51], v[136:151]
  buffer_load_dwordx4 v[96:99], v1, s[28:31], s59 offen offset:2048
  ds_read_b64_tr_b16 v[164:165], v191 offset:26624
  ds_read_b64_tr_b16 v[166:167], v191 offset:27136
  s_waitcnt vmcnt(11)
  s_waitcnt lgkmcnt(8)
  v_mfma_f32_32x32x16_bf16 v[120:135], v[168:171], v[52:55], v[120:135]
  ds_read_b64_tr_b16 v[168:169], v190 offset:28672
  ds_read_b64_tr_b16 v[170:171], v190 offset:29184
  v_mfma_f32_32x32x16_bf16 v[136:151], v[172:175], v[52:55], v[136:151]
  buffer_load_dwordx4 v[100:103], v1, s[28:31], s59 offen offset:3072
  ds_read_b64_tr_b16 v[172:173], v191 offset:28672
  ds_read_b64_tr_b16 v[174:175], v191 offset:29184
  s_waitcnt vmcnt(11)
  s_waitcnt lgkmcnt(8)
  v_mfma_f32_32x32x16_bf16 v[120:135], v[152:155], v[56:59], v[120:135]
  ds_read_b64_tr_b16 v[152:153], v190 offset:30720
  ds_read_b64_tr_b16 v[154:155], v190 offset:31232
  v_mfma_f32_32x32x16_bf16 v[136:151], v[156:159], v[56:59], v[136:151]
  s_add_u32 s59, s59, 4096
  buffer_load_dwordx4 v[104:107], v1, s[28:31], s59 offen offset:0
  ds_read_b64_tr_b16 v[156:157], v191 offset:30720
  ds_read_b64_tr_b16 v[158:159], v191 offset:31232
  s_waitcnt vmcnt(11)
  s_waitcnt lgkmcnt(8)
  v_mfma_f32_32x32x16_bf16 v[120:135], v[160:163], v[60:63], v[120:135]
  ds_read_b64_tr_b16 v[160:161], v190 offset:32768
  ds_read_b64_tr_b16 v[162:163], v190 offset:33280
  v_mfma_f32_32x32x16_bf16 v[136:151], v[164:167], v[60:63], v[136:151]
  buffer_load_dwordx4 v[108:111], v1, s[28:31], s59 offen offset:1024
  ds_read_b64_tr_b16 v[164:165], v191 offset:32768
  ds_read_b64_tr_b16 v[166:167], v191 offset:33280
  s_waitcnt vmcnt(11)
  s_waitcnt lgkmcnt(8)
  v_mfma_f32_32x32x16_bf16 v[120:135], v[168:171], v[64:67], v[120:135]
  ds_read_b64_tr_b16 v[168:169], v190 offset:34816
  ds_read_b64_tr_b16 v[170:171], v190 offset:35328
  v_mfma_f32_32x32x16_bf16 v[136:151], v[172:175], v[64:67], v[136:151]
  buffer_load_dwordx4 v[112:115], v1, s[28:31], s59 offen offset:2048
  ds_read_b64_tr_b16 v[172:173], v191 offset:34816
  ds_read_b64_tr_b16 v[174:175], v191 offset:35328
  s_waitcnt vmcnt(11)
  s_waitcnt lgkmcnt(8)
  v_mfma_f32_32x32x16_bf16 v[120:135], v[152:155], v[68:71], v[120:135]
  ds_read_b64_tr_b16 v[152:153], v190 offset:36864
  ds_read_b64_tr_b16 v[154:155], v190 offset:37376
  v_mfma_f32_32x32x16_bf16 v[136:151], v[156:159], v[68:71], v[136:151]
  buffer_load_dwordx4 v[116:119], v1, s[28:31], s59 offen offset:3072
  ds_read_b64_tr_b16 v[156:157], v191 offset:36864
  ds_read_b64_tr_b16 v[158:159], v191 offset:37376
  s_waitcnt vmcnt(11)
  s_waitcnt lgkmcnt(8)
  v_mfma_f32_32x32x16_bf16 v[120:135], v[160:163], v[72:75], v[120:135]
  ds_read_b64_tr_b16 v[160:161], v190 offset:38912
  ds_read_b64_tr_b16 v[162:163], v190 offset:39424
  v_mfma_f32_32x32x16_bf16 v[136:151], v[164:167], v[72:75], v[136:151]
  buffer_load_dwordx4 v[176:179], v1, s[28:31], s64 offen offset:0
  buffer_load_dwordx4 v[180:183], v1, s[28:31], s64 offen offset:1024
  ds_read_b64_tr_b16 v[164:165], v191 offset:38912
  ds_read_b64_tr_b16 v[166:167], v191 offset:39424
  s_waitcnt vmcnt(12)
  s_waitcnt lgkmcnt(8)
  v_mfma_f32_32x32x16_bf16 v[120:135], v[168:171], v[76:79], v[120:135]
  ds_read_b64_tr_b16 v[168:169], v190 offset:40960
  ds_read_b64_tr_b16 v[170:171], v190 offset:41472
  v_mfma_f32_32x32x16_bf16 v[136:151], v[172:175], v[76:79], v[136:151]
  ds_read_b64_tr_b16 v[172:173], v191 offset:40960
  ds_read_b64_tr_b16 v[174:175], v191 offset:41472
  s_waitcnt vmcnt(11)
  s_waitcnt lgkmcnt(8)
  v_mfma_f32_32x32x16_bf16 v[120:135], v[152:155], v[80:83], v[120:135]
  ds_read_b64_tr_b16 v[152:153], v190 offset:43008
  ds_read_b64_tr_b16 v[154:155], v190 offset:43520
  v_mfma_f32_32x32x16_bf16 v[136:151], v[156:159], v[80:83], v[136:151]
  ds_read_b64_tr_b16 v[156:157], v191 offset:43008
  ds_read_b64_tr_b16 v[158:159], v191 offset:43520
  s_waitcnt vmcnt(10)
  s_waitcnt lgkmcnt(8)
  v_mfma_f32_32x32x16_bf16 v[120:135], v[160:163], v[84:87], v[120:135]
  ds_read_b64_tr_b16 v[160:161], v190 offset:45056
  ds_read_b64_tr_b16 v[162:163], v190 offset:45568
  v_mfma_f32_32x32x16_bf16 v[136:151], v[164:167], v[84:87], v[136:151]
  ds_read_b64_tr_b16 v[164:165], v191 offset:45056
  ds_read_b64_tr_b16 v[166:167], v191 offset:45568
  s_waitcnt vmcnt(9)
  s_waitcnt lgkmcnt(8)
  v_mfma_f32_32x32x16_bf16 v[120:135], v[168:171], v[88:91], v[120:135]
  ds_read_b64_tr_b16 v[168:169], v190 offset:47104
  ds_read_b64_tr_b16 v[170:171], v190 offset:47616
  v_mfma_f32_32x32x16_bf16 v[136:151], v[172:175], v[88:91], v[136:151]
  ds_read_b64_tr_b16 v[172:173], v191 offset:47104
  ds_read_b64_tr_b16 v[174:175], v191 offset:47616
  s_waitcnt vmcnt(8)
  s_waitcnt lgkmcnt(8)
  v_mfma_f32_32x32x16_bf16 v[120:135], v[152:155], v[92:95], v[120:135]
  ds_read_b64_tr_b16 v[152:153], v190 offset:49152
  ds_read_b64_tr_b16 v[154:155], v190 offset:49664
  v_mfma_f32_32x32x16_bf16 v[136:151], v[156:159], v[92:95], v[136:151]
  ds_read_b64_tr_b16 v[156:157], v191 offset:49152
  ds_read_b64_tr_b16 v[158:159], v191 offset:49664
  s_waitcnt vmcnt(7)
  s_waitcnt lgkmcnt(8)
  v_mfma_f32_32x32x16_bf16 v[120:135], v[160:163], v[96:99], v[120:135]
  ds_read_b64_tr_b16 v[160:161], v190 offset:51200
  ds_read_b64_tr_b16 v[162:163], v190 offset:51712
  v_mfma_f32_32x32x16_bf16 v[136:151], v[164:167], v[96:99], v[136:151]
  ds_read_b64_tr_b16 v[164:165], v191 offset:51200
  ds_read_b64_tr_b16 v[166:167], v191 offset:51712
  s_waitcnt vmcnt(6)
  s_waitcnt lgkmcnt(8)
  v_mfma_f32_32x32x16_bf16 v[120:135], v[168:171], v[100:103], v[120:135]
  ds_read_b64_tr_b16 v[168:169], v190 offset:53248
  ds_read_b64_tr_b16 v[170:171], v190 offset:53760
  v_mfma_f32_32x32x16_bf16 v[136:151], v[172:175], v[100:103], v[136:151]
  ds_read_b64_tr_b16 v[172:173], v191 offset:53248
  ds_read_b64_tr_b16 v[174:175], v191 offset:53760
  s_waitcnt vmcnt(5)
  s_waitcnt lgkmcnt(8)
  v_mfma_f32_32x32x16_bf16 v[120:135], v[152:155], v[104:107], v[120:135]
  ds_read_b64_tr_b16 v[152:153], v190 offset:55296
  ds_read_b64_tr_b16 v[154:155], v190 offset:55808
  v_mfma_f32_32x32x16_bf16 v[136:151], v[156:159], v[104:107], v[136:151]
  ds_read_b64_tr_b16 v[156:157], v191 offset:55296
  ds_read_b64_tr_b16 v[158:159], v191 offset:55808
  s_waitcnt vmcnt(4)
  s_waitcnt lgkmcnt(8)
  v_mfma_f32_32x32x16_bf16 v[120:135], v[160:163], v[108:111], v[120:135]
  v_mfma_f32_32x32x16_bf16 v[136:151], v[164:167], v[108:111], v[136:151]
  s_waitcnt vmcnt(3)
  s_waitcnt lgkmcnt(4)
  v_mfma_f32_32x32x16_bf16 v[120:135], v[168:171], v[112:115], v[120:135]
  v_mfma_f32_32x32x16_bf16 v[136:151], v[172:175], v[112:115], v[136:151]
  s_waitcnt vmcnt(2)
  s_waitcnt lgkmcnt(0)
  v_mfma_f32_32x32x16_bf16 v[120:135], v[152:155], v[116:119], v[120:135]
  v_mfma_f32_32x32x16_bf16 v[136:151], v[156:159], v[116:119], v[136:151]
  s_barrier
  s_xor_b32 s60, s42, 2
  s_lshl_b32 s60, s60, 12
  v_add_u32 v184, s60, v1
  s_nop 7
  ds_write_b128 v184, v[136:139] offset:0
  ds_write_b128 v184, v[140:143] offset:1024
  ds_write_b128 v184, v[144:147] offset:2048
  ds_write_b128 v184, v[148:151] offset:3072
  s_waitcnt vmcnt(0)
  v_lshlrev_b32 v8, 16, v176
  v_and_b32 v9, 0xffff0000, v176
  v_lshlrev_b32 v10, 16, v177
  v_and_b32 v11, 0xffff0000, v177
  v_lshlrev_b32 v12, 16, v178
  v_and_b32 v13, 0xffff0000, v178
  v_lshlrev_b32 v14, 16, v179
  v_and_b32 v15, 0xffff0000, v179
  v_lshlrev_b32 v16, 16, v180
  v_and_b32 v17, 0xffff0000, v180
  v_lshlrev_b32 v18, 16, v181
  v_and_b32 v19, 0xffff0000, v181
  v_lshlrev_b32 v20, 16, v182
  v_and_b32 v21, 0xffff0000, v182
  v_lshlrev_b32 v22, 16, v183
  v_and_b32 v23, 0xffff0000, v183
  s_waitcnt lgkmcnt(0)
  s_barrier
  s_lshl_b32 s60, s42, 12
  v_add_u32 v184, s60, v1
  ds_read_b128 v[136:139], v184 offset:0
  ds_read_b128 v[140:143], v184 offset:1024
  ds_read_b128 v[144:147], v184 offset:2048
  ds_read_b128 v[148:151], v184 offset:3072
  v_pk_add_f32 v[120:121], v[120:121], v[8:9]
  v_pk_add_f32 v[122:123], v[122:123], v[10:11]
  v_pk_add_f32 v[124:125], v[124:125], v[12:13]
  v_pk_add_f32 v[126:127], v[126:127], v[14:15]
  v_pk_add_f32 v[128:129], v[128:129], v[16:17]
  v_pk_add_f32 v[130:131], v[130:131], v[18:19]
  v_pk_add_f32 v[132:133], v[132:133], v[20:21]
  v_pk_add_f32 v[134:135], v[134:135], v[22:23]
  s_waitcnt lgkmcnt(0)
  v_pk_add_f32 v[120:121], v[120:121], v[136:137]
  v_pk_add_f32 v[122:123], v[122:123], v[138:139]
  v_pk_add_f32 v[124:125], v[124:125], v[140:141]
  v_pk_add_f32 v[126:127], v[126:127], v[142:143]
  v_pk_add_f32 v[128:129], v[128:129], v[144:145]
  v_pk_add_f32 v[130:131], v[130:131], v[146:147]
  v_pk_add_f32 v[132:133], v[132:133], v[148:149]
  v_pk_add_f32 v[134:135], v[134:135], v[150:151]
  v_cvt_pk_bf16_f32 v24, v120, v121
  v_cvt_pk_bf16_f32 v25, v122, v123
  v_cvt_pk_bf16_f32 v26, v124, v125
  v_cvt_pk_bf16_f32 v27, v126, v127
  v_cvt_pk_bf16_f32 v28, v128, v129
  v_cvt_pk_bf16_f32 v29, v130, v131
  v_cvt_pk_bf16_f32 v30, v132, v133
  v_cvt_pk_bf16_f32 v31, v134, v135
  v_pk_add_f32 v[32:33], v[120:121], v[122:123]
  v_pk_mul_f32 v[34:35], v[120:121], v[120:121]
  v_pk_add_f32 v[32:33], v[32:33], v[124:125]
  v_pk_add_f32 v[32:33], v[32:33], v[126:127]
  v_pk_add_f32 v[32:33], v[32:33], v[128:129]
  v_pk_add_f32 v[32:33], v[32:33], v[130:131]
  v_pk_add_f32 v[32:33], v[32:33], v[132:133]
  v_pk_add_f32 v[32:33], v[32:33], v[134:135]
  v_pk_fma_f32 v[34:35], v[122:123], v[122:123], v[34:35]
  v_pk_fma_f32 v[34:35], v[124:125], v[124:125], v[34:35]
  v_pk_fma_f32 v[34:35], v[126:127], v[126:127], v[34:35]
  v_pk_fma_f32 v[34:35], v[128:129], v[128:129], v[34:35]
  v_pk_fma_f32 v[34:35], v[130:131], v[130:131], v[34:35]
  v_pk_fma_f32 v[34:35], v[132:133], v[132:133], v[34:35]
  v_pk_fma_f32 v[34:35], v[134:135], v[134:135], v[34:35]
  v_add_f32 v32, v32, v33
  v_add_f32 v34, v34, v35
  v_mov_b32 v36, v32
  v_mov_b32 v37, v32
  s_nop 1
  v_permlane32_swap_b32 v36, v37
  v_add_f32 v32, v36, v37
  v_mov_b32 v36, v34
  v_mov_b32 v37, v34
  s_nop 1
  v_permlane32_swap_b32 v36, v37
  v_add_f32 v34, v36, v37
  v_mov_b32 v33, v34
  s_cmp_lg_u32 s45, 0
  s_cbranch_scc1 L_out_75
  s_mul_i32 s56, s54, 28672
  s_lshl_b32 s60, s57, 11
  s_add_u32 s56, s56, s60
  s_add_u32 s56, s56, s46
  s_add_u32 s56, s56, 11534336
  s_mul_i32 s60, s54, 14
  s_add_u32 s60, s60, s57
  s_lshl_b32 s60, s60, 8
  s_add_u32 s60, s60, s46
  s_add_u32 s60, s60, 30670848
  v_and_b32 v36, 31, v0
  v_lshlrev_b32 v36, 3, v36
  buffer_store_dwordx4 v[24:27], v1, s[28:31], s56 offen offset:0 sc1
  buffer_store_dwordx4 v[28:31], v1, s[28:31], s56 offen offset:1024 sc1
  buffer_store_dwordx2 v[32:33], v36, s[28:31], s60 offen sc1
  s_branch L_outd_76
L_out_75:
  s_mov_b32 s32, s20
  s_mov_b32 s33, s21
  s_mov_b32 s34, 1835008
  s_mov_b32 s35, 0x20000
  v_permlane32_swap_b32 v24, v26
  v_permlane32_swap_b32 v25, v27
  v_permlane32_swap_b32 v28, v30
  v_permlane32_swap_b32 v29, v31
  s_and_b32 s60, s42, 1
  s_lshl_b32 s60, s60, 5
  v_and_b32 v36, 31, v0
  v_add_u32 v36, s60, v36
  v_mul_u32_u24 v36, 144, v36
  v_lshrrev_b32 v37, 5, v0
  v_lshl_add_u32 v36, v37, 4, v36
  s_lshl_b32 s60, s55, 6
  s_add_u32 s60, s60, 32768
  v_add_u32 v36, s60, v36
  ds_write_b128 v36, v[24:27] offset:0
  ds_write_b128 v36, v[28:31] offset:32
  s_waitcnt lgkmcnt(0)
  s_barrier
  v_lshrrev_b32 v36, 3, v0
  s_lshl_b32 s60, s42, 4
  v_add_u32 v36, s60, v36
  v_and_b32 v37, 7, v0
  v_lshlrev_b32 v37, 4, v37
  v_mul_u32_u24 v8, 144, v36
  v_add3_u32 v8, v8, v37, 0
  v_add_u32 v8, 32768, v8
  ds_read_b128 v[24:27], v8
  ds_read_b128 v[28:31], v8 offset:1152
  v_mul_u32_u24 v36, 896, v36
  v_add_u32 v36, v36, v37
  s_mul_i32 s56, s52, 57344
  s_lshl_b32 s60, s53, 7
  s_add_u32 s56, s56, s60
  s_add_u32 s60, s56, 7168
  s_waitcnt lgkmcnt(0)
  buffer_store_dwordx4 v[24:27], v36, s[32:35], s56 offen sc1
  buffer_store_dwordx4 v[28:31], v36, s[32:35], s60 offen sc1
  s_branch L_last
L_outd_76:
  s_cmp_lg_u32 s45, 0
  s_cbranch_scc1 L_noq6_77
  s_mov_b32 s36, s24
  s_mov_b32 s37, s25
  s_mov_b32 s38, 268435456
  s_mov_b32 s39, 0x20000
  v_mov_b32 v4, v1
  s_and_b32 s68, s44, 15
  s_mul_i32 s68, s68, 86016
  s_add_u32 s68, s68, 0
  s_add_u32 s69, s42, 12
L_wst_79:
  s_mul_i32 s70, s69, 3072
  s_add_u32 s70, s70, s68
  s_mul_i32 s71, s69, 3072
  s_add_u32 m0, s71, -20480
  s_add_u32 s72, s70, 0
  buffer_load_dwordx4 v4, s[36:39], s72 offen lds
  s_add_u32 m0, s71, -19456
  s_add_u32 s72, s70, 1024
  buffer_load_dwordx4 v4, s[36:39], s72 offen lds
  s_add_u32 m0, s71, -18432
  s_add_u32 s72, s70, 2048
  buffer_load_dwordx4 v4, s[36:39], s72 offen lds
  s_add_u32 s69, s69, 4
  s_cmp_lt_u32 s69, 28
  s_cbranch_scc1 L_wst_79
L_wstd_80:
  s_waitcnt vmcnt(12)
  s_branch L_noq6d_78
L_noq6_77:
  s_waitcnt vmcnt(0)
L_noq6d_78:
  s_waitcnt lgkmcnt(0)
  s_barrier
  s_lshr_b32 s56, s52, 1
  s_lshl_b32 s56, s56, 7
  s_and_b32 s60, s52, 1
  s_mul_i32 s60, s60, 7
  s_add_u32 s60, s60, s53
  s_lshl_b32 s60, s60, 3
  s_add_u32 s56, s56, s60
  s_add_u32 s56, s56, s46
  s_add_u32 s56, s56, 31498240
  s_cmp_lg_u32 s42, 0
  s_cbranch_scc1 L_pub_81
  v_mov_b32 v184, s40
  v_mov_b32 v185, s41
  v_mov_b32 v186, 0
  s_mov_b64 exec, 1
  s_cmp_eq_u32 s47, 0
  s_cbranch_scc1 L_stg_82
  buffer_store_dwordx2 v[184:185], v186, s[28:31], s56 offen
  s_branch L_std_83
L_stg_82:
  buffer_store_dwordx2 v[184:185], v186, s[28:31], s56 offen sc1
L_std_83:
  s_mov_b64 exec, -1
L_pub_81:
  s_cmp_lg_u32 s45, 0
  s_cbranch_scc1 L_last
  s_branch L_next
L_last:
  s_cmp_lg_u32 s2, 0
  s_cbranch_scc1 L_fin
  s_cmp_lg_u32 s42, 0
  s_cbranch_scc1 L_w0_84
  v_mov_b32 v8, s40
  v_mov_b32 v9, 0
  s_mov_b32 s52, 33554176
  s_mov_b64 exec, 1
  buffer_store_dword v8, v9, s[28:31], s52 offen
  s_mov_b64 exec, -1
L_w0_84:
  s_branch L_fin
L_idle:
  s_cmp_lg_u32 s45, 0
  s_cbranch_scc1 L_nocs_85
  s_lshl_b32 s52, s43, 2
  s_add_u32 s52, s52, s44
  s_sub_u32 s52, s52, 28
  s_cmp_ge_u32 s52, 28
  s_cbranch_scc1 L_nocs_85
  s_mov_b32 s36, s12
  s_mov_b32 s37, s13
  s_mov_b32 s38, 1605632
  s_mov_b32 s39, 0x20000
  v_lshrrev_b32 v4, 2, v0
  v_mul_u32_u24 v4, 3584, v4
  v_and_b32 v5, 3, v0
  v_lshl_add_u32 v4, v5, 4, v4
  s_lshl_b32 s68, s52, 7
  s_add_u32 s69, s42, 0
L_wst_86:
  s_mul_i32 s70, s69, 57344
  s_add_u32 s70, s70, s68
  s_mul_i32 s71, s69, 2048
  s_add_u32 m0, s71, 0
  s_add_u32 s72, s70, 0
  buffer_load_dwordx4 v4, s[36:39], s72 offen lds
  s_add_u32 m0, s71, 1024
  s_add_u32 s72, s70, 64
  buffer_load_dwordx4 v4, s[36:39], s72 offen lds
  s_add_u32 s69, s69, 4
  s_cmp_lt_u32 s69, 28
  s_cbranch_scc1 L_wst_86
L_wstd_87:
  s_waitcnt vmcnt(0)
  s_barrier
  s_mul_i32 s53, s42, 14336
  v_add_u32 v8, s53, v3
  v_mov_b32 v12, 0x3f803f80
  v_mov_b32 v13, 0x3f803f80
  v_mov_b32 v14, 0x3f803f80
  v_mov_b32 v15, 0x3f803f80
  ds_read_b64_tr_b16 v[48:49], v8 offset:0
  ds_read_b64_tr_b16 v[50:51], v8 offset:512
  ds_read_b64_tr_b16 v[52:53], v8 offset:1024
  ds_read_b64_tr_b16 v[54:55], v8 offset:1536
  ds_read_b64_tr_b16 v[56:57], v8 offset:2048
  ds_read_b64_tr_b16 v[58:59], v8 offset:2560
  ds_read_b64_tr_b16 v[60:61], v8 offset:3072
  ds_read_b64_tr_b16 v[62:63], v8 offset:3584
  ds_read_b64_tr_b16 v[64:65], v8 offset:4096
  ds_read_b64_tr_b16 v[66:67], v8 offset:4608
  ds_read_b64_tr_b16 v[68:69], v8 offset:5120
  ds_read_b64_tr_b16 v[70:71], v8 offset:5632
  s_waitcnt lgkmcnt(8)
  v_mfma_f32_32x32x16_bf16 v[16:31], v[12:15], v[48:51], 0
  ds_read_b64_tr_b16 v[48:49], v8 offset:6144
  ds_read_b64_tr_b16 v[50:51], v8 offset:6656
  v_mfma_f32_32x32x16_bf16 v[32:47], v[12:15], v[52:55], 0
  ds_read_b64_tr_b16 v[52:53], v8 offset:7168
  ds_read_b64_tr_b16 v[54:55], v8 offset:7680
  s_waitcnt lgkmcnt(8)
  v_mfma_f32_32x32x16_bf16 v[16:31], v[12:15], v[56:59], v[16:31]
  ds_read_b64_tr_b16 v[56:57], v8 offset:8192
  ds_read_b64_tr_b16 v[58:59], v8 offset:8704
  v_mfma_f32_32x32x16_bf16 v[32:47], v[12:15], v[60:63], v[32:47]
  ds_read_b64_tr_b16 v[60:61], v8 offset:9216
  ds_read_b64_tr_b16 v[62:63], v8 offset:9728
  s_waitcnt lgkmcnt(8)
  v_mfma_f32_32x32x16_bf16 v[16:31], v[12:15], v[64:67], v[16:31]
  ds_read_b64_tr_b16 v[64:65], v8 offset:10240
  ds_read_b64_tr_b16 v[66:67], v8 offset:10752
  v_mfma_f32_32x32x16_bf16 v[32:47], v[12:15], v[68:71], v[32:47]
  ds_read_b64_tr_b16 v[68:69], v8 offset:11264
  ds_read_b64_tr_b16 v[70:71], v8 offset:11776
  s_waitcnt lgkmcnt(8)
  v_mfma_f32_32x32x16_bf16 v[16:31], v[12:15], v[48:51], v[16:31]
  ds_read_b64_tr_b16 v[48:49], v8 offset:12288
  ds_read_b64_tr_b16 v[50:51], v8 offset:12800
  v_mfma_f32_32x32x16_bf16 v[32:47], v[12:15], v[52:55], v[32:47]
  ds_read_b64_tr_b16 v[52:53], v8 offset:13312
  ds_read_b64_tr_b16 v[54:55], v8 offset:13824
  s_waitcnt lgkmcnt(8)
  v_mfma_f32_32x32x16_bf16 v[16:31], v[12:15], v[56:59], v[16:31]
  v_mfma_f32_32x32x16_bf16 v[32:47], v[12:15], v[60:63], v[32:47]
  s_waitcnt lgkmcnt(4)
  v_mfma_f32_32x32x16_bf16 v[16:31], v[12:15], v[64:67], v[16:31]
  v_mfma_f32_32x32x16_bf16 v[32:47], v[12:15], v[68:71], v[32:47]
  s_waitcnt lgkmcnt(0)
  v_mfma_f32_32x32x16_bf16 v[16:31], v[12:15], v[48:51], v[16:31]
  v_mfma_f32_32x32x16_bf16 v[32:47], v[12:15], v[52:55], v[32:47]
  s_lshl_b32 s53, s42, 8
  s_add_u32 s53, s53, 160768
  v_and_b32 v9, 31, v0
  v_lshlrev_b32 v9, 2, v9
  v_add_u32 v9, s53, v9
  s_nop 5
  ds_write_b32 v9, v16 offset:0
  ds_write_b32 v9, v32 offset:128
  s_waitcnt lgkmcnt(0)
  s_barrier
  v_lshlrev_b32 v9, 2, v0
  v_add_u32 v9, 160768, v9
  ds_read_b32 v16, v9 offset:0
  ds_read_b32 v17, v9 offset:256
  ds_read_b32 v18, v9 offset:512
  ds_read_b32 v19, v9 offset:768
  s_waitcnt lgkmcnt(0)
  v_add_f32 v16, v16, v17
  v_add_f32 v18, v18, v19
  v_add_f32 v16, v16, v18
  s_lshl_b32 s53, s40, 1
  s_or_b32 s53, s53, 1
  v_xor_b32 v17, s53, v16
  v_lshlrev_b32 v9, 3, v0
  s_lshl_b32 s53, s52, 9
  s_add_u32 s53, s53, 31260672
  s_cmp_lg_u32 s42, 0
  s_cbranch_scc1 L_w0_88
  buffer_store_dwordx2 v[16:17], v9, s[28:31], s53 offen sc1
L_w0_88:
L_nocs_85:
  s_cmp_lg_u32 s45, 0
  s_cbranch_scc1 L_fin
  s_cmp_lg_u32 s45, 0
  s_cbranch_scc1 L_fin
  s_mov_b32 s36, s24
  s_mov_b32 s37, s25
  s_mov_b32 s38, 268435456
  s_mov_b32 s39, 0x20000
  v_mov_b32 v4, v1
  s_and_b32 s68, s44, 15
  s_mul_i32 s68, s68, 86016
  s_add_u32 s68, s68, 0
  s_add_u32 s69, s42, 0
L_wst_89:
  s_mul_i32 s70, s69, 3072
  s_add_u32 s70, s70, s68
  s_mul_i32 s71, s69, 3072
  s_add_u32 m0, s71, 114688
  s_add_u32 s72, s70, 0
  buffer_load_dwordx4 v4, s[36:39], s72 offen lds
  s_add_u32 m0, s71, 115712
  s_add_u32 s72, s70, 1024
  buffer_load_dwordx4 v4, s[36:39], s72 offen lds
  s_add_u32 m0, s71, 116736
  s_add_u32 s72, s70, 2048
  buffer_load_dwordx4 v4, s[36:39], s72 offen lds
  s_add_u32 s69, s69, 4
  s_cmp_lt_u32 s69, 12
  s_cbranch_scc1 L_wst_89
L_wstd_90:
  s_add_u32 s69, s42, 12
L_wst_91:
  s_mul_i32 s70, s69, 3072
  s_add_u32 s70, s70, s68
  s_mul_i32 s71, s69, 3072
  s_add_u32 m0, s71, -20480
  s_add_u32 s72, s70, 0
  buffer_load_dwordx4 v4, s[36:39], s72 offen lds
  s_add_u32 m0, s71, -19456
  s_add_u32 s72, s70, 1024
  buffer_load_dwordx4 v4, s[36:39], s72 offen lds
  s_add_u32 m0, s71, -18432
  s_add_u32 s72, s70, 2048
  buffer_load_dwordx4 v4, s[36:39], s72 offen lds
  s_add_u32 s69, s69, 4
  s_cmp_lt_u32 s69, 28
  s_cbranch_scc1 L_wst_91
L_wstd_92:
  s_waitcnt vmcnt(0) lgkmcnt(0)
L_next:
  s_mov_b32 s45, 1
  s_mov_b32 s46, 41943040
  s_lshr_b32 s52, s44, 4
  s_lshl_b32 s55, s43, 1
  s_add_u32 s52, s52, s55
  s_and_b32 s53, s44, 15
  s_lshl_b32 s54, s52, 2
  s_add_u32 s54, s54, s42
  s_sub_u32 s58, s46, 41943040
  s_mul_i32 s59, s54, 28672
  s_add_u32 s59, s59, s58
  s_add_u32 s59, s59, 11534336
  v_add_u32 v212, 114688, v3
  v_add_u32 v213, 16384, v3
  s_cmp_eq_u32 s42, 0
  s_cbranch_scc1 L_nw0_93
  s_waitcnt vmcnt(0)
L_nw0_93:
  s_cmp_lg_u32 s42, 0
  s_cbranch_scc1 L_w0_94
  v_min_u32 v192, 13, v0
  v_lshlrev_b32 v192, 3, v192
  s_lshl_b32 s55, s52, 7
  s_add_u32 s55, s55, s58
  s_add_u32 s55, s55, 31498240
  s_mov_b32 s76, 0
L_poll_95:
  buffer_load_dwordx2 v[194:195], v192, s[28:31], s55 offen sc1
  s_waitcnt vmcnt(0)
  v_cmp_eq_u32 vcc, s40, v194
  v_cmp_eq_u32 s[74:75], s41, v195
  s_nop 2
  s_and_b64 vcc, vcc, s[74:75]
  s_cmp_eq_u64 vcc, -1
  s_cbranch_scc1 L_polld_96
  s_add_u32 s76, s76, 1
  s_cmp_lt_u32 s76, 0x40000
  s_cbranch_scc1 L_poll_95
L_polld_96:
L_w0_94:
  s_barrier
  buffer_load_dwordx4 v[8:11], v1, s[28:31], s59 offen offset:0
  buffer_load_dwordx4 v[12:15], v1, s[28:31], s59 offen offset:1024
  buffer_load_dwordx4 v[16:19], v1, s[28:31], s59 offen offset:2048
  buffer_load_dwordx4 v[20:23], v1, s[28:31], s59 offen offset:3072
  s_add_u32 s59, s59, 4096
  buffer_load_dwordx4 v[24:27], v1, s[28:31], s59 offen offset:0
  buffer_load_dwordx4 v[28:31], v1, s[28:31], s59 offen offset:1024
  buffer_load_dwordx4 v[32:35], v1, s[28:31], s59 offen offset:2048
  buffer_load_dwordx4 v[36:39], v1, s[28:31], s59 offen offset:3072
  s_add_u32 s59, s59, 4096
  buffer_load_dwordx4 v[40:43], v1, s[28:31], s59 offen offset:0
  buffer_load_dwordx4 v[44:47], v1, s[28:31], s59 offen offset:1024
  buffer_load_dwordx4 v[48:51], v1, s[28:31], s59 offen offset:2048
  buffer_load_dwordx4 v[52:55], v1, s[28:31], s59 offen offset:3072
  ds_read_b64_tr_b16 v[168:169], v212 offset:0
  ds_read_b64_tr_b16 v[170:171], v212 offset:512
  ds_read_b64_tr_b16 v[172:173], v212 offset:1024
  ds_read_b64_tr_b16 v[174:175], v212 offset:1536
  ds_read_b64_tr_b16 v[176:177], v212 offset:2048
  ds_read_b64_tr_b16 v[178:179], v212 offset:2560
  ds_read_b64_tr_b16 v[180:181], v212 offset:3072
  ds_read_b64_tr_b16 v[182:183], v212 offset:3584
  ds_read_b64_tr_b16 v[184:185], v212 offset:4096
  ds_read_b64_tr_b16 v[186:187], v212 offset:4608
  ds_read_b64_tr_b16 v[188:189], v212 offset:5120
  ds_read_b64_tr_b16 v[190:191], v212 offset:5632
  s_waitcnt vmcnt(11)
  s_waitcnt lgkmcnt(8)
  v_mfma_f32_32x32x16_bf16 v[120:135], v[168:171], v[8:11], 0
  ds_read_b64_tr_b16 v[168:169], v212 offset:6144
  ds_read_b64_tr_b16 v[170:171], v212 offset:6656
  v_mfma_f32_32x32x16_bf16 v[136:151], v[172:175], v[8:11], 0
  ds_read_b64_tr_b16 v[172:173], v212 offset:7168
  ds_read_b64_tr_b16 v[174:175], v212 offset:7680
  s_waitcnt lgkmcnt(8)
  v_mfma_f32_32x32x16_bf16 v[152:167], v[8:11], v[176:179], 0
  s_add_u32 s59, s59, 4096
  buffer_load_dwordx4 v[56:59], v1, s[28:31], s59 offen offset:0
  ds_read_b64_tr_b16 v[176:177], v212 offset:8192
  ds_read_b64_tr_b16 v[178:179], v212 offset:8704
  s_waitcnt vmcnt(11)
  v_mfma_f32_32x32x16_bf16 v[120:135], v[180:183], v[12:15], v[120:135]
  ds_read_b64_tr_b16 v[180:181], v212 offset:9216
  ds_read_b64_tr_b16 v[182:183], v212 offset:9728
  s_waitcnt lgkmcnt(8)
  v_mfma_f32_32x32x16_bf16 v[136:151], v[184:187], v[12:15], v[136:151]
  ds_read_b64_tr_b16 v[184:185], v212 offset:10240
  ds_read_b64_tr_b16 v[186:187], v212 offset:10752
  v_mfma_f32_32x32x16_bf16 v[152:167], v[12:15], v[188:191], v[152:167]
  buffer_load_dwordx4 v[60:63], v1, s[28:31], s59 offen offset:1024
  ds_read_b64_tr_b16 v[188:189], v212 offset:11264
  ds_read_b64_tr_b16 v[190:191], v212 offset:11776
  s_waitcnt vmcnt(11)
  s_waitcnt lgkmcnt(8)
  v_mfma_f32_32x32x16_bf16 v[120:135], v[168:171], v[16:19], v[120:135]
  ds_read_b64_tr_b16 v[168:169], v212 offset:12288
  ds_read_b64_tr_b16 v[170:171], v212 offset:12800
  v_mfma_f32_32x32x16_bf16 v[136:151], v[172:175], v[16:19], v[136:151]
  ds_read_b64_tr_b16 v[172:173], v212 offset:13312
  ds_read_b64_tr_b16 v[174:175], v212 offset:13824
  s_waitcnt lgkmcnt(8)
  v_mfma_f32_32x32x16_bf16 v[152:167], v[16:19], v[176:179], v[152:167]
  buffer_load_dwordx4 v[64:67], v1, s[28:31], s59 offen offset:2048
  ds_read_b64_tr_b16 v[176:177], v212 offset:14336
  ds_read_b64_tr_b16 v[178:179], v212 offset:14848
  s_waitcnt vmcnt(11)
  v_mfma_f32_32x32x16_bf16 v[120:135], v[180:183], v[20:23], v[120:135]
  ds_read_b64_tr_b16 v[180:181], v212 offset:15360
  ds_read_b64_tr_b16 v[182:183], v212 offset:15872
  s_waitcnt lgkmcnt(8)
  v_mfma_f32_32x32x16_bf16 v[136:151], v[184:187], v[20:23], v[136:151]
  ds_read_b64_tr_b16 v[184:185], v212 offset:16384
  ds_read_b64_tr_b16 v[186:187], v212 offset:16896
  v_mfma_f32_32x32x16_bf16 v[152:167], v[20:23], v[188:191], v[152:167]
  buffer_load_dwordx4 v[68:71], v1, s[28:31], s59 offen offset:3072
  ds_read_b64_tr_b16 v[188:189], v212 offset:17408
  ds_read_b64_tr_b16 v[190:191], v212 offset:17920
  s_waitcnt vmcnt(11)
  s_waitcnt lgkmcnt(8)
  v_mfma_f32_32x32x16_bf16 v[120:135], v[168:171], v[24:27], v[120:135]
  ds_read_b64_tr_b16 v[168:169], v212 offset:18432
  ds_read_b64_tr_b16 v[170:171], v212 offset:18944
  v_mfma_f32_32x32x16_bf16 v[136:151], v[172:175], v[24:27], v[136:151]
  ds_read_b64_tr_b16 v[172:173], v212 offset:19456
  ds_read_b64_tr_b16 v[174:175], v212 offset:19968
  s_waitcnt lgkmcnt(8)
  v_mfma_f32_32x32x16_bf16 v[152:167], v[24:27], v[176:179], v[152:167]
  s_add_u32 s59, s59, 4096
  buffer_load_dwordx4 v[72:75], v1, s[28:31], s59 offen offset:0
  ds_read_b64_tr_b16 v[176:177], v212 offset:20480
  ds_read_b64_tr_b16 v[178:179], v212 offset:20992
  s_waitcnt vmcnt(11)
  v_mfma_f32_32x32x16_bf16 v[120:135], v[180:183], v[28:31], v[120:135]
  ds_read_b64_tr_b16 v[180:181], v212 offset:21504
  ds_read_b64_tr_b16 v[182:183], v212 offset:22016
  s_waitcnt lgkmcnt(8)
  v_mfma_f32_32x32x16_bf16 v[136:151], v[184:187], v[28:31], v[136:151]
  ds_read_b64_tr_b16 v[184:185], v212 offset:22528
  ds_read_b64_tr_b16 v[186:187], v212 offset:23040
  v_mfma_f32_32x32x16_bf16 v[152:167], v[28:31], v[188:191], v[152:167]
  buffer_load_dwordx4 v[76:79], v1, s[28:31], s59 offen offset:1024
  ds_read_b64_tr_b16 v[188:189], v212 offset:23552
  ds_read_b64_tr_b16 v[190:191], v212 offset:24064
  s_waitcnt vmcnt(11)
  s_waitcnt lgkmcnt(8)
  v_mfma_f32_32x32x16_bf16 v[120:135], v[168:171], v[32:35], v[120:135]
  ds_read_b64_tr_b16 v[168:169], v212 offset:24576
  ds_read_b64_tr_b16 v[170:171], v212 offset:25088
  v_mfma_f32_32x32x16_bf16 v[136:151], v[172:175], v[32:35], v[136:151]
  ds_read_b64_tr_b16 v[172:173], v212 offset:25600
  ds_read_b64_tr_b16 v[174:175], v212 offset:26112
  s_waitcnt lgkmcnt(8)
  v_mfma_f32_32x32x16_bf16 v[152:167], v[32:35], v[176:179], v[152:167]
  buffer_load_dwordx4 v[80:83], v1, s[28:31], s59 offen offset:2048
  ds_read_b64_tr_b16 v[176:177], v212 offset:26624
  ds_read_b64_tr_b16 v[178:179], v212 offset:27136
  s_waitcnt vmcnt(11)
  v_mfma_f32_32x32x16_bf16 v[120:135], v[180:183], v[36:39], v[120:135]
  ds_read_b64_tr_b16 v[180:181], v212 offset:27648
  ds_read_b64_tr_b16 v[182:183], v212 offset:28160
  s_waitcnt lgkmcnt(8)
  v_mfma_f32_32x32x16_bf16 v[136:151], v[184:187], v[36:39], v[136:151]
  ds_read_b64_tr_b16 v[184:185], v212 offset:28672
  ds_read_b64_tr_b16 v[186:187], v212 offset:29184
  v_mfma_f32_32x32x16_bf16 v[152:167], v[36:39], v[188:191], v[152:167]
  buffer_load_dwordx4 v[84:87], v1, s[28:31], s59 offen offset:3072
  ds_read_b64_tr_b16 v[188:189], v212 offset:29696
  ds_read_b64_tr_b16 v[190:191], v212 offset:30208
  s_waitcnt vmcnt(11)
  s_waitcnt lgkmcnt(8)
  v_mfma_f32_32x32x16_bf16 v[120:135], v[168:171], v[40:43], v[120:135]
  ds_read_b64_tr_b16 v[168:169], v212 offset:30720
  ds_read_b64_tr_b16 v[170:171], v212 offset:31232
  v_mfma_f32_32x32x16_bf16 v[136:151], v[172:175], v[40:43], v[136:151]
  ds_read_b64_tr_b16 v[172:173], v212 offset:31744
  ds_read_b64_tr_b16 v[174:175], v212 offset:32256
  s_waitcnt lgkmcnt(8)
  v_mfma_f32_32x32x16_bf16 v[152:167], v[40:43], v[176:179], v[152:167]
  s_add_u32 s59, s59, 4096
  buffer_load_dwordx4 v[88:91], v1, s[28:31], s59 offen offset:0
  ds_read_b64_tr_b16 v[176:177], v212 offset:32768
  ds_read_b64_tr_b16 v[178:179], v212 offset:33280
  s_waitcnt vmcnt(11)
  v_mfma_f32_32x32x16_bf16 v[120:135], v[180:183], v[44:47], v[120:135]
  ds_read_b64_tr_b16 v[180:181], v212 offset:33792
  ds_read_b64_tr_b16 v[182:183], v212 offset:34304
  s_waitcnt lgkmcnt(8)
  v_mfma_f32_32x32x16_bf16 v[136:151], v[184:187], v[44:47], v[136:151]
  ds_read_b64_tr_b16 v[184:185], v212 offset:34816
  ds_read_b64_tr_b16 v[186:187], v212 offset:35328
  v_mfma_f32_32x32x16_bf16 v[152:167], v[44:47], v[188:191], v[152:167]
  buffer_load_dwordx4 v[92:95], v1, s[28:31], s59 offen offset:1024
  ds_read_b64_tr_b16 v[188:189], v212 offset:35840
  ds_read_b64_tr_b16 v[190:191], v212 offset:36352
  s_waitcnt vmcnt(11)
  s_waitcnt lgkmcnt(8)
  v_mfma_f32_32x32x16_bf16 v[120:135], v[168:171], v[48:51], v[120:135]
  ds_read_b64_tr_b16 v[168:169], v213 offset:0
  ds_read_b64_tr_b16 v[170:171], v213 offset:512
  v_mfma_f32_32x32x16_bf16 v[136:151], v[172:175], v[48:51], v[136:151]
  ds_read_b64_tr_b16 v[172:173], v213 offset:1024
  ds_read_b64_tr_b16 v[174:175], v213 offset:1536
  s_waitcnt lgkmcnt(8)
  v_mfma_f32_32x32x16_bf16 v[152:167], v[48:51], v[176:179], v[152:167]
  buffer_load_dwordx4 v[96:99], v1, s[28:31], s59 offen offset:2048
  ds_read_b64_tr_b16 v[176:177], v213 offset:2048
  ds_read_b64_tr_b16 v[178:179], v213 offset:2560
  s_waitcnt vmcnt(11)
  v_mfma_f32_32x32x16_bf16 v[120:135], v[180:183], v[52:55], v[120:135]
  ds_read_b64_tr_b16 v[180:181], v213 offset:3072
  ds_read_b64_tr_b16 v[182:183], v213 offset:3584
  s_waitcnt lgkmcnt(8)
  v_mfma_f32_32x32x16_bf16 v[136:151], v[184:187], v[52:55], v[136:151]
  ds_read_b64_tr_b16 v[184:185], v213 offset:4096
  ds_read_b64_tr_b16 v[186:187], v213 offset:4608
  v_mfma_f32_32x32x16_bf16 v[152:167], v[52:55], v[188:191], v[152:167]
  buffer_load_dwordx4 v[100:103], v1, s[28:31], s59 offen offset:3072
  ds_read_b64_tr_b16 v[188:189], v213 offset:5120
  ds_read_b64_tr_b16 v[190:191], v213 offset:5632
  s_waitcnt vmcnt(11)
  s_waitcnt lgkmcnt(8)
  v_mfma_f32_32x32x16_bf16 v[120:135], v[168:171], v[56:59], v[120:135]
  ds_read_b64_tr_b16 v[168:169], v213 offset:6144
  ds_read_b64_tr_b16 v[170:171], v213 offset:6656
  v_mfma_f32_32x32x16_bf16 v[136:151], v[172:175], v[56:59], v[136:151]
  ds_read_b64_tr_b16 v[172:173], v213 offset:7168
  ds_read_b64_tr_b16 v[174:175], v213 offset:7680
  s_waitcnt lgkmcnt(8)
  v_mfma_f32_32x32x16_bf16 v[152:167], v[56:59], v[176:179], v[152:167]
  s_add_u32 s59, s59, 4096
  buffer_load_dwordx4 v[104:107], v1, s[28:31], s59 offen offset:0
  ds_read_b64_tr_b16 v[176:177], v213 offset:8192
  ds_read_b64_tr_b16 v[178:179], v213 offset:8704
  s_waitcnt vmcnt(11)
  v_mfma_f32_32x32x16_bf16 v[120:135], v[180:183], v[60:63], v[120:135]
  ds_read_b64_tr_b16 v[180:181], v213 offset:9216
  ds_read_b64_tr_b16 v[182:183], v213 offset:9728
  s_waitcnt lgkmcnt(8)
  v_mfma_f32_32x32x16_bf16 v[136:151], v[184:187], v[60:63], v[136:151]
  ds_read_b64_tr_b16 v[184:185], v213 offset:10240
  ds_read_b64_tr_b16 v[186:187], v213 offset:10752
  v_mfma_f32_32x32x16_bf16 v[152:167], v[60:63], v[188:191], v[152:167]
  buffer_load_dwordx4 v[108:111], v1, s[28:31], s59 offen offset:1024
  ds_read_b64_tr_b16 v[188:189], v213 offset:11264
  ds_read_b64_tr_b16 v[190:191], v213 offset:11776
  s_waitcnt vmcnt(11)
  s_waitcnt lgkmcnt(8)
  v_mfma_f32_32x32x16_bf16 v[120:135], v[168:171], v[64:67], v[120:135]
  ds_read_b64_tr_b16 v[168:169], v213 offset:12288
  ds_read_b64_tr_b16 v[170:171], v213 offset:12800
  v_mfma_f32_32x32x16_bf16 v[136:151], v[172:175], v[64:67], v[136:151]
  ds_read_b64_tr_b16 v[172:173], v213 offset:13312
  ds_read_b64_tr_b16 v[174:175], v213 offset:13824
  s_waitcnt lgkmcnt(8)
  v_mfma_f32_32x32x16_bf16 v[152:167], v[64:67], v[176:179], v[152:167]
  buffer_load_dwordx4 v[112:115], v1, s[28:31], s59 offen offset:2048
  ds_read_b64_tr_b16 v[176:177], v213 offset:14336
  ds_read_b64_tr_b16 v[178:179], v213 offset:14848
  s_waitcnt vmcnt(11)
  v_mfma_f32_32x32x16_bf16 v[120:135], v[180:183], v[68:71], v[120:135]
  ds_read_b64_tr_b16 v[180:181], v213 offset:15360
  ds_read_b64_tr_b16 v[182:183], v213 offset:15872
  s_waitcnt lgkmcnt(8)
  v_mfma_f32_32x32x16_bf16 v[136:151], v[184:187], v[68:71], v[136:151]
  ds_read_b64_tr_b16 v[184:185], v213 offset:16384
  ds_read_b64_tr_b16 v[186:187], v213 offset:16896
  v_mfma_f32_32x32x16_bf16 v[152:167], v[68:71], v[188:191], v[152:167]
  buffer_load_dwordx4 v[116:119], v1, s[28:31], s59 offen offset:3072
  ds_read_b64_tr_b16 v[188:189], v213 offset:17408
  ds_read_b64_tr_b16 v[190:191], v213 offset:17920
  s_waitcnt vmcnt(11)
  s_waitcnt lgkmcnt(8)
  v_mfma_f32_32x32x16_bf16 v[120:135], v[168:171], v[72:75], v[120:135]
  ds_read_b64_tr_b16 v[168:169], v213 offset:18432
  ds_read_b64_tr_b16 v[170:171], v213 offset:18944
  v_mfma_f32_32x32x16_bf16 v[136:151], v[172:175], v[72:75], v[136:151]
  ds_read_b64_tr_b16 v[172:173], v213 offset:19456
  ds_read_b64_tr_b16 v[174:175], v213 offset:19968
  s_waitcnt lgkmcnt(8)
  v_mfma_f32_32x32x16_bf16 v[152:167], v[72:75], v[176:179], v[152:167]
  v_and_b32 v192, 31, v0
  v_lshlrev_b32 v192, 3, v192
  v_lshrrev_b32 v193, 5, v0
  v_mul_u32_u24 v193, 1792, v193
  v_add_u32 v192, v192, v193
  s_mul_i32 s60, s54, 3584
  s_add_u32 s60, s60, s58
  s_add_u32 s60, s60, 30670848
  buffer_load_dwordx2 v[196:197], v192, s[28:31], s60 offen offset:0
  buffer_load_dwordx2 v[198:199], v192, s[28:31], s60 offen offset:256
  buffer_load_dwordx2 v[200:201], v192, s[28:31], s60 offen offset:512
  buffer_load_dwordx2 v[202:203], v192, s[28:31], s60 offen offset:768
  buffer_load_dwordx2 v[204:205], v192, s[28:31], s60 offen offset:1024
  buffer_load_dwordx2 v[206:207], v192, s[28:31], s60 offen offset:1280
  buffer_load_dwordx2 v[208:209], v192, s[28:31], s60 offen offset:1536
  ds_read_b64_tr_b16 v[176:177], v213 offset:20480
  ds_read_b64_tr_b16 v[178:179], v213 offset:20992
  s_waitcnt vmcnt(17)
  v_mfma_f32_32x32x16_bf16 v[120:135], v[180:183], v[76:79], v[120:135]
  ds_read_b64_tr_b16 v[180:181], v213 offset:21504
  ds_read_b64_tr_b16 v[182:183], v213 offset:22016
  s_waitcnt lgkmcnt(8)
  v_mfma_f32_32x32x16_bf16 v[136:151], v[184:187], v[76:79], v[136:151]
  ds_read_b64_tr_b16 v[184:185], v213 offset:22528
  ds_read_b64_tr_b16 v[186:187], v213 offset:23040
  v_mfma_f32_32x32x16_bf16 v[152:167], v[76:79], v[188:191], v[152:167]
  ds_read_b64_tr_b16 v[188:189], v213 offset:23552
  ds_read_b64_tr_b16 v[190:191], v213 offset:24064
  s_waitcnt vmcnt(16)
  s_waitcnt lgkmcnt(8)
  v_mfma_f32_32x32x16_bf16 v[120:135], v[168:171], v[80:83], v[120:135]
  ds_read_b64_tr_b16 v[168:169], v213 offset:24576
  ds_read_b64_tr_b16 v[170:171], v213 offset:25088
  v_mfma_f32_32x32x16_bf16 v[136:151], v[172:175], v[80:83], v[136:151]
  ds_read_b64_tr_b16 v[172:173], v213 offset:25600
  ds_read_b64_tr_b16 v[174:175], v213 offset:26112
  s_waitcnt lgkmcnt(8)
  v_mfma_f32_32x32x16_bf16 v[152:167], v[80:83], v[176:179], v[152:167]
  ds_read_b64_tr_b16 v[176:177], v213 offset:26624
  ds_read_b64_tr_b16 v[178:179], v213 offset:27136
  s_waitcnt vmcnt(15)
  v_mfma_f32_32x32x16_bf16 v[120:135], v[180:183], v[84:87], v[120:135]
  ds_read_b64_tr_b16 v[180:181], v213 offset:27648
  ds_read_b64_tr_b16 v[182:183], v213 offset:28160
  s_waitcnt lgkmcnt(8)
  v_mfma_f32_32x32x16_bf16 v[136:151], v[184:187], v[84:87], v[136:151]
  ds_read_b64_tr_b16 v[184:185], v213 offset:28672
  ds_read_b64_tr_b16 v[186:187], v213 offset:29184
  v_mfma_f32_32x32x16_bf16 v[152:167], v[84:87], v[188:191], v[152:167]
  ds_read_b64_tr_b16 v[188:189], v213 offset:29696
  ds_read_b64_tr_b16 v[190:191], v213 offset:30208
  s_waitcnt vmcnt(14)
  s_waitcnt lgkmcnt(8)
  v_mfma_f32_32x32x16_bf16 v[120:135], v[168:171], v[88:91], v[120:135]
  ds_read_b64_tr_b16 v[168:169], v213 offset:30720
  ds_read_b64_tr_b16 v[170:171], v213 offset:31232
  v_mfma_f32_32x32x16_bf16 v[136:151], v[172:175], v[88:91], v[136:151]
  ds_read_b64_tr_b16 v[172:173], v213 offset:31744
  ds_read_b64_tr_b16 v[174:175], v213 offset:32256
  s_waitcnt lgkmcnt(8)
  v_mfma_f32_32x32x16_bf16 v[152:167], v[88:91], v[176:179], v[152:167]
  ds_read_b64_tr_b16 v[176:177], v213 offset:32768
  ds_read_b64_tr_b16 v[178:179], v213 offset:33280
  s_waitcnt vmcnt(13)
  v_mfma_f32_32x32x16_bf16 v[120:135], v[180:183], v[92:95], v[120:135]
  ds_read_b64_tr_b16 v[180:181], v213 offset:33792
  ds_read_b64_tr_b16 v[182:183], v213 offset:34304
  s_waitcnt lgkmcnt(8)
  v_mfma_f32_32x32x16_bf16 v[136:151], v[184:187], v[92:95], v[136:151]
  ds_read_b64_tr_b16 v[184:185], v213 offset:34816
  ds_read_b64_tr_b16 v[186:187], v213 offset:35328
  v_mfma_f32_32x32x16_bf16 v[152:167], v[92:95], v[188:191], v[152:167]
  ds_read_b64_tr_b16 v[188:189], v213 offset:35840
  ds_read_b64_tr_b16 v[190:191], v213 offset:36352
  s_waitcnt vmcnt(12)
  s_waitcnt lgkmcnt(8)
  v_mfma_f32_32x32x16_bf16 v[120:135], v[168:171], v[96:99], v[120:135]
  ds_read_b64_tr_b16 v[168:169], v213 offset:36864
  ds_read_b64_tr_b16 v[170:171], v213 offset:37376
  v_mfma_f32_32x32x16_bf16 v[136:151], v[172:175], v[96:99], v[136:151]
  ds_read_b64_tr_b16 v[172:173], v213 offset:37888
  ds_read_b64_tr_b16 v[174:175], v213 offset:38400
  s_waitcnt lgkmcnt(8)
  v_mfma_f32_32x32x16_bf16 v[152:167], v[96:99], v[176:179], v[152:167]
  ds_read_b64_tr_b16 v[176:177], v213 offset:38912
  ds_read_b64_tr_b16 v[178:179], v213 offset:39424
  s_waitcnt vmcnt(11)
  v_mfma_f32_32x32x16_bf16 v[120:135], v[180:183], v[100:103], v[120:135]
  ds_read_b64_tr_b16 v[180:181], v213 offset:39936
  ds_read_b64_tr_b16 v[182:183], v213 offset:40448
  s_waitcnt lgkmcnt(8)
  v_mfma_f32_32x32x16_bf16 v[136:151], v[184:187], v[100:103], v[136:151]
  ds_read_b64_tr_b16 v[184:185], v213 offset:40960
  ds_read_b64_tr_b16 v[186:187], v213 offset:41472
  v_mfma_f32_32x32x16_bf16 v[152:167], v[100:103], v[188:191], v[152:167]
  ds_read_b64_tr_b16 v[188:189], v213 offset:41984
  ds_read_b64_tr_b16 v[190:191], v213 offset:42496
  s_waitcnt vmcnt(10)
  s_waitcnt lgkmcnt(8)
  v_mfma_f32_32x32x16_bf16 v[120:135], v[168:171], v[104:107], v[120:135]
  ds_read_b64_tr_b16 v[168:169], v213 offset:43008
  ds_read_b64_tr_b16 v[170:171], v213 offset:43520
  v_mfma_f32_32x32x16_bf16 v[136:151], v[172:175], v[104:107], v[136:151]
  ds_read_b64_tr_b16 v[172:173], v213 offset:44032
  ds_read_b64_tr_b16 v[174:175], v213 offset:44544
  s_waitcnt lgkmcnt(8)
  v_mfma_f32_32x32x16_bf16 v[152:167], v[104:107], v[176:179], v[152:167]
  ds_read_b64_tr_b16 v[176:177], v213 offset:45056
  ds_read_b64_tr_b16 v[178:179], v213 offset:45568
  s_waitcnt vmcnt(9)
  v_mfma_f32_32x32x16_bf16 v[120:135], v[180:183], v[108:111], v[120:135]
  ds_read_b64_tr_b16 v[180:181], v213 offset:46080
  ds_read_b64_tr_b16 v[182:183], v213 offset:46592
  s_waitcnt lgkmcnt(8)
  v_mfma_f32_32x32x16_bf16 v[136:151], v[184:187], v[108:111], v[136:151]
  ds_read_b64_tr_b16 v[184:185], v213 offset:47104
  ds_read_b64_tr_b16 v[186:187], v213 offset:47616
  v_mfma_f32_32x32x16_bf16 v[152:167], v[108:111], v[188:191], v[152:167]
  ds_read_b64_tr_b16 v[188:189], v213 offset:48128
  ds_read_b64_tr_b16 v[190:191], v213 offset:48640
  s_waitcnt vmcnt(8)
  s_waitcnt lgkmcnt(8)
  v_mfma_f32_32x32x16_bf16 v[120:135], v[168:171], v[112:115], v[120:135]
  v_mfma_f32_32x32x16_bf16 v[136:151], v[172:175], v[112:115], v[136:151]
  s_waitcnt lgkmcnt(4)
  v_mfma_f32_32x32x16_bf16 v[152:167], v[112:115], v[176:179], v[152:167]
  s_waitcnt vmcnt(7)
  v_mfma_f32_32x32x16_bf16 v[120:135], v[180:183], v[116:119], v[120:135]
  s_waitcnt lgkmcnt(0)
  v_mfma_f32_32x32x16_bf16 v[136:151], v[184:187], v[116:119], v[136:151]
  v_mfma_f32_32x32x16_bf16 v[152:167], v[116:119], v[188:191], v[152:167]
  s_barrier
  s_waitcnt vmcnt(0)
  v_pk_add_f32 v[196:197], v[196:197], v[198:199]
  v_pk_add_f32 v[200:201], v[200:201], v[202:203]
  v_pk_add_f32 v[204:205], v[204:205], v[206:207]
  v_pk_add_f32 v[196:197], v[196:197], v[208:209]
  v_pk_add_f32 v[200:201], v[200:201], v[204:205]
  v_pk_add_f32 v[196:197], v[196:197], v[200:201]
  v_mov_b32 v214, v196
  v_mov_b32 v215, v197
  v_mov_b32 v12, v214
  v_mov_b32 v13, v214
  s_nop 1
  v_permlane32_swap_b32 v12, v13
  v_add_f32 v8, v12, v13
  v_mov_b32 v12, v215
  v_mov_b32 v13, v215
  s_nop 1
  v_permlane32_swap_b32 v12, v13
  v_add_f32 v9, v12, v13
  v_mul_f32 v8, 0x3b124925, v8
  v_mul_f32 v9, 0x3b124925, v9
  v_fma_f32 v9, -v8, v8, v9
  v_max_f32 v9, 0, v9
  v_add_f32 v9, 0x3727c5ac, v9
  v_rsq_f32 v9, v9
  v_sub_f32 v10, 0, v8
  s_lshl_b32 s72, s42, 8
  s_add_u32 s72, s72, 162816
  v_and_b32 v14, 31, v0
  v_lshlrev_b32 v14, 2, v14
  v_add_u32 v15, s72, v14
  v_mul_f32 v12, v10, v9
  ds_write_b32 v15, v9
  ds_write_b32 v15, v12 offset:128
  v_lshrrev_b32 v16, 5, v0
  v_lshlrev_b32 v16, 4, v16
  v_add_u32 v17, 159744, v16
  ds_read_b128 v[20:23], v17 offset:0
  ds_read_b128 v[24:27], v17 offset:32
  ds_read_b128 v[28:31], v17 offset:64
  ds_read_b128 v[32:35], v17 offset:96
  ds_read_b128 v[36:39], v17 offset:128
  ds_read_b128 v[40:43], v17 offset:160
  ds_read_b128 v[44:47], v17 offset:192
  ds_read_b128 v[48:51], v17 offset:224
  v_add_u32 v14, 160000, v14
  ds_read_b32 v52, v14
  v_add_u32 v16, s72, v16
  ds_read_b128 v[56:59], v16 offset:0
  ds_read_b128 v[60:63], v16 offset:32
  ds_read_b128 v[64:67], v16 offset:64
  ds_read_b128 v[68:71], v16 offset:96
  ds_read_b128 v[72:75], v16 offset:128
  ds_read_b128 v[76:79], v16 offset:160
  ds_read_b128 v[80:83], v16 offset:192
  ds_read_b128 v[84:87], v16 offset:224
  v_mul_f32 v18, 0x3e8b97f6, v9
  v_mov_b32 v54, v9
  s_lshl_b32 s72, s53, 6
  s_add_u32 s72, s72, s54
  s_lshl_b32 s74, s72, 12
  s_add_u32 s74, s74, s46
  s_add_u32 s74, s74, 2097152
  s_lshl_b32 s75, s72, 2
  s_add_u32 s75, s75, s46
  s_add_u32 s75, s75, 31195136
  s_waitcnt lgkmcnt(9)
  v_pk_fma_f32 v[136:137], v[36:37], v[10:11], v[136:137] op_sel_hi:[1,0,1]
  v_pk_fma_f32 v[138:139], v[38:39], v[10:11], v[138:139] op_sel_hi:[1,0,1]
  v_pk_fma_f32 v[140:141], v[40:41], v[10:11], v[140:141] op_sel_hi:[1,0,1]
  v_pk_fma_f32 v[142:143], v[42:43], v[10:11], v[142:143] op_sel_hi:[1,0,1]
  v_pk_fma_f32 v[144:145], v[44:45], v[10:11], v[144:145] op_sel_hi:[1,0,1]
  v_pk_fma_f32 v[146:147], v[46:47], v[10:11], v[146:147] op_sel_hi:[1,0,1]
  v_pk_fma_f32 v[148:149], v[48:49], v[10:11], v[148:149] op_sel_hi:[1,0,1]
  v_pk_fma_f32 v[150:151], v[50:51], v[10:11], v[150:151] op_sel_hi:[1,0,1]
  v_pk_mul_f32 v[136:137], v[136:137], v[54:55] op_sel_hi:[1,0]
  v_pk_mul_f32 v[138:139], v[138:139], v[54:55] op_sel_hi:[1,0]
  v_pk_mul_f32 v[140:141], v[140:141], v[54:55] op_sel_hi:[1,0]
  v_pk_mul_f32 v[142:143], v[142:143], v[54:55] op_sel_hi:[1,0]
  v_pk_mul_f32 v[144:145], v[144:145], v[54:55] op_sel_hi:[1,0]
  v_pk_mul_f32 v[146:147], v[146:147], v[54:55] op_sel_hi:[1,0]
  v_pk_mul_f32 v[148:149], v[148:149], v[54:55] op_sel_hi:[1,0]
  v_pk_mul_f32 v[150:151], v[150:151], v[54:55] op_sel_hi:[1,0]
  v_cndmask_b32_e64 v148, v148, 0, s[48:49]
  v_cndmask_b32_e64 v149, v149, 0, s[48:49]
  v_cndmask_b32_e64 v150, v150, 0, s[48:49]
  v_cndmask_b32_e64 v151, v151, 0, s[48:49]
  v_cvt_pk_bf16_f32 v96, v136, v137
  v_cvt_pk_bf16_f32 v97, v138, v139
  v_cvt_pk_bf16_f32 v98, v140, v141
  v_cvt_pk_bf16_f32 v99, v142, v143
  v_cvt_pk_bf16_f32 v100, v144, v145
  v_cvt_pk_bf16_f32 v101, v146, v147
  v_cvt_pk_bf16_f32 v102, v148, v149
  v_cvt_pk_bf16_f32 v103, v150, v151
  v_mov_b32 v12, 0x3f80
  v_cndmask_b32_e64 v102, v102, v12, s[48:49]
  buffer_store_dwordx4 v[96:99], v1, s[28:31], s74 offen offset:0 sc1
  buffer_store_dwordx4 v[100:103], v1, s[28:31], s74 offen offset:1024 sc1
  s_waitcnt lgkmcnt(0)
  v_pk_mul_f32 v[72:73], v[72:73], v[52:53] op_sel_hi:[1,0]
  v_pk_mul_f32 v[74:75], v[74:75], v[52:53] op_sel_hi:[1,0]
  v_pk_mul_f32 v[76:77], v[76:77], v[52:53] op_sel_hi:[1,0]
  v_pk_mul_f32 v[78:79], v[78:79], v[52:53] op_sel_hi:[1,0]
  v_pk_mul_f32 v[80:81], v[80:81], v[52:53] op_sel_hi:[1,0]
  v_pk_mul_f32 v[82:83], v[82:83], v[52:53] op_sel_hi:[1,0]
  v_pk_mul_f32 v[84:85], v[84:85], v[52:53] op_sel_hi:[1,0]
  v_pk_mul_f32 v[86:87], v[86:87], v[52:53] op_sel_hi:[1,0]
  v_pk_fma_f32 v[152:153], v[152:153], v[56:57], v[72:73]
  v_pk_fma_f32 v[154:155], v[154:155], v[58:59], v[74:75]
  v_pk_fma_f32 v[156:157], v[156:157], v[60:61], v[76:77]
  v_pk_fma_f32 v[158:159], v[158:159], v[62:63], v[78:79]
  v_pk_fma_f32 v[160:161], v[160:161], v[64:65], v[80:81]
  v_pk_fma_f32 v[162:163], v[162:163], v[66:67], v[82:83]
  v_pk_fma_f32 v[164:165], v[164:165], v[68:69], v[84:85]
  v_pk_fma_f32 v[166:167], v[166:167], v[70:71], v[86:87]
  v_cvt_pk_bf16_f32 v104, v152, v153
  v_cvt_pk_bf16_f32 v105, v154, v155
  v_cvt_pk_bf16_f32 v106, v156, v157
  v_cvt_pk_bf16_f32 v107, v158, v159
  v_cvt_pk_bf16_f32 v108, v160, v161
  v_cvt_pk_bf16_f32 v109, v162, v163
  v_cvt_pk_bf16_f32 v110, v164, v165
  v_cvt_pk_bf16_f32 v111, v166, v167
  v_and_b32 v12, 31, v0
  v_cmp_eq_u32 vcc, 28, v12
  v_mov_b32 v13, 0x3f803f80
  s_nop 0
  v_cndmask_b32 v12, 0, v13, vcc
  v_cndmask_b32_e64 v104, v104, v12, s[50:51]
  v_cndmask_b32_e64 v105, v105, v12, s[50:51]
  v_cndmask_b32_e64 v106, v106, v12, s[50:51]
  v_cndmask_b32_e64 v107, v107, v12, s[50:51]
  v_cndmask_b32_e64 v108, v108, v12, s[50:51]
  v_cndmask_b32_e64 v109, v109, v12, s[50:51]
  v_cndmask_b32_e64 v110, v110, v12, s[50:51]
  v_cndmask_b32_e64 v111, v111, v12, s[50:51]
  buffer_store_dwordx4 v[104:107], v1, s[28:31], s74 offen offset:2048 sc1
  buffer_store_dwordx4 v[108:111], v1, s[28:31], s74 offen offset:3072 sc1
  v_pk_mul_f32 v[112:113], v[136:137], v[136:137]
  v_pk_fma_f32 v[112:113], v[138:139], v[138:139], v[112:113]
  v_pk_fma_f32 v[112:113], v[140:141], v[140:141], v[112:113]
  v_pk_fma_f32 v[112:113], v[142:143], v[142:143], v[112:113]
  v_pk_fma_f32 v[112:113], v[144:145], v[144:145], v[112:113]
  v_pk_fma_f32 v[112:113], v[146:147], v[146:147], v[112:113]
  v_pk_fma_f32 v[112:113], v[148:149], v[148:149], v[112:113]
  v_pk_fma_f32 v[112:113], v[150:151], v[150:151], v[112:113]
  v_add_f32 v112, v112, v113
  v_mov_b32 v12, v112
  v_mov_b32 v13, v112
  s_nop 1
  v_permlane32_swap_b32 v12, v13
  v_add_f32 v112, v12, v13
  s_nop 1
  v_max_f32_dpp v112, v112, v112 row_ror:8 row_mask:0xf bank_mask:0xf
  s_nop 1
  v_max_f32_dpp v112, v112, v112 row_ror:4 row_mask:0xf bank_mask:0xf
  s_nop 1
  v_max_f32_dpp v112, v112, v112 row_ror:2 row_mask:0xf bank_mask:0xf
  s_nop 1
  v_max_f32_dpp v112, v112, v112 row_ror:1 row_mask:0xf bank_mask:0xf
  v_mov_b32 v12, v112
  v_mov_b32 v13, v112
  s_nop 1
  v_permlane16_swap_b32 v12, v13
  v_max_f32 v114, v12, v13
  v_mov_b32 v12, 0
  buffer_store_dword v114, v12, s[28:31], s75 offen sc1
  v_pk_fma_f32 v[120:121], v[20:21], v[10:11], v[120:121] op_sel_hi:[1,0,1]
  v_pk_fma_f32 v[122:123], v[22:23], v[10:11], v[122:123] op_sel_hi:[1,0,1]
  v_pk_fma_f32 v[124:125], v[24:25], v[10:11], v[124:125] op_sel_hi:[1,0,1]
  v_pk_fma_f32 v[126:127], v[26:27], v[10:11], v[126:127] op_sel_hi:[1,0,1]
  v_pk_fma_f32 v[128:129], v[28:29], v[10:11], v[128:129] op_sel_hi:[1,0,1]
  v_pk_fma_f32 v[130:131], v[30:31], v[10:11], v[130:131] op_sel_hi:[1,0,1]
  v_pk_fma_f32 v[132:133], v[32:33], v[10:11], v[132:133] op_sel_hi:[1,0,1]
  v_pk_fma_f32 v[134:135], v[34:35], v[10:11], v[134:135] op_sel_hi:[1,0,1]
  v_pk_mul_f32 v[120:121], v[120:121], v[18:19] op_sel_hi:[1,0]
  v_pk_mul_f32 v[122:123], v[122:123], v[18:19] op_sel_hi:[1,0]
  v_pk_mul_f32 v[124:125], v[124:125], v[18:19] op_sel_hi:[1,0]
  v_pk_mul_f32 v[126:127], v[126:127], v[18:19] op_sel_hi:[1,0]
  v_pk_mul_f32 v[128:129], v[128:129], v[18:19] op_sel_hi:[1,0]
  v_pk_mul_f32 v[130:131], v[130:131], v[18:19] op_sel_hi:[1,0]
  v_pk_mul_f32 v[132:133], v[132:133], v[18:19] op_sel_hi:[1,0]
  v_pk_mul_f32 v[134:135], v[134:135], v[18:19] op_sel_hi:[1,0]
  v_cndmask_b32_e64 v132, v132, 0, s[48:49]
  v_cndmask_b32_e64 v133, v133, 0, s[48:49]
  v_cndmask_b32_e64 v134, v134, 0, s[48:49]
  v_cndmask_b32_e64 v135, v135, 0, s[48:49]
  v_cvt_pk_bf16_f32 v88, v120, v121
  v_cvt_pk_bf16_f32 v89, v122, v123
  v_cvt_pk_bf16_f32 v90, v124, v125
  v_cvt_pk_bf16_f32 v91, v126, v127
  v_cvt_pk_bf16_f32 v92, v128, v129
  v_cvt_pk_bf16_f32 v93, v130, v131
  v_cvt_pk_bf16_f32 v94, v132, v133
  v_cvt_pk_bf16_f32 v95, v134, v135
  v_pk_mul_f32 v[112:113], v[120:121], v[120:121]
  v_pk_fma_f32 v[112:113], v[122:123], v[122:123], v[112:113]
  v_pk_fma_f32 v[112:113], v[124:125], v[124:125], v[112:113]
  v_pk_fma_f32 v[112:113], v[126:127], v[126:127], v[112:113]
  v_pk_fma_f32 v[112:113], v[128:129], v[128:129], v[112:113]
  v_pk_fma_f32 v[112:113], v[130:131], v[130:131], v[112:113]
  v_pk_fma_f32 v[112:113], v[132:133], v[132:133], v[112:113]
  v_pk_fma_f32 v[112:113], v[134:135], v[134:135], v[112:113]
  v_add_f32 v112, v112, v113
  v_mov_b32 v12, v112
  v_mov_b32 v13, v112
  s_nop 1
  v_permlane32_swap_b32 v12, v13
  v_add_f32 v112, v12, v13
  v_sqrt_f32 v112, v112
  s_nop 0
  v_cndmask_b32_e64 v95, v95, v112, s[48:49]
  s_lshl_b32 s73, s42, 11
  s_add_u32 s73, s73, 151552
  v_add_u32 v13, s73, v1
  ds_write_b128 v13, v[88:91] offset:0
  ds_write_b128 v13, v[92:95] offset:1024
  s_cmp_ge_u32 s44, 28
  s_cbranch_scc1 L_nowo2_97
  s_mov_b32 s36, s8
  s_mov_b32 s37, s9
  s_mov_b32 s38, 401408
  s_mov_b32 s39, 0x20000
  v_lshrrev_b32 v4, 2, v0
  v_mul_u32_u24 v4, 896, v4
  v_and_b32 v5, 3, v0
  v_lshl_add_u32 v4, v5, 4, v4
  s_mul_i32 s68, s44, 37
  s_lshr_b32 s68, s68, 8
  s_mul_i32 s68, s68, 7
  s_sub_u32 s68, s44, s68
  s_lshl_b32 s68, s68, 7
  s_add_u32 s69, s42, 0
L_wst_99:
  s_min_u32 s70, s69, 27
  s_mul_i32 s70, s70, 14336
  s_add_u32 s70, s70, s68
  s_mul_i32 s71, s69, 1024
  s_add_u32 m0, s71, 0
  s_add_u32 s72, s70, 0
  buffer_load_dwordx4 v4, s[36:39], s72 offen lds
  s_add_u32 m0, s71, 29696
  s_add_u32 s72, s70, 64
  buffer_load_dwordx4 v4, s[36:39], s72 offen lds
  s_add_u32 s69, s69, 4
  s_cmp_lt_u32 s69, 16
  s_cbranch_scc1 L_wst_99
L_wstd_100:
  s_waitcnt vmcnt(8)
  s_branch L_nowo2d_98
L_nowo2_97:
  s_waitcnt vmcnt(0)
L_nowo2d_98:
  s_waitcnt lgkmcnt(0)
  s_barrier
  s_lshl_b32 s60, s53, 7
  s_lshl_b32 s77, s52, 3
  s_add_u32 s60, s60, s77
  s_add_u32 s60, s60, s46
  s_add_u32 s60, s60, 31457280
  s_cmp_lg_u32 s42, 0
  s_cbranch_scc1 L_pub_101
  v_mov_b32 v192, s40
  v_mov_b32 v193, s41
  v_mov_b32 v194, 0
  s_mov_b64 exec, 1
  buffer_store_dwordx2 v[192:193], v194, s[28:31], s60 offen sc1
  s_mov_b64 exec, -1
L_pub_101:
  s_branch L_layer
L_fin:
L_end:
  s_endpgm
L_fallback:
  s_barrier
  s_mov_b32 s59, 1
  v_mov_b32 v218, 160196
  v_mov_b32 v219, 0
  ds_write_b32 v218, v219
  v_cndmask_b32_e64 v14, v14, 0, s[48:49]
  v_mov_b32 v40, 0xff800000
  v_cndmask_b32_e64 v22, v22, 0, s[48:49]
  v_mov_b32 v41, 0xff800000
  v_cndmask_b32_e64 v30, v30, 0, s[48:49]
  v_mov_b32 v42, 0xff800000
  v_cndmask_b32_e64 v38, v38, 0, s[48:49]
  v_mov_b32 v43, 0xff800000
  s_lshl_b32 s55, s52, 6
  s_lshl_b32 s60, s42, 4
  s_add_u32 s55, s55, s60
  s_lshl_b32 s55, s55, 12
  s_add_u32 s55, s55, s46
  s_add_u32 s55, s55, 2097152
  s_mov_b32 s56, 0
L_fbmax_102:
  buffer_load_dwordx4 v[152:155], v1, s[28:31], s55 offen offset:0
  buffer_load_dwordx4 v[156:159], v1, s[28:31], s55 offen offset:1024
  s_waitcnt vmcnt(0)
  v_mfma_f32_32x32x16_bf16 v[104:119], v[152:155], v[8:11], 0
  v_mfma_f32_32x32x16_bf16 v[104:119], v[156:159], v[12:15], v[104:119]
  s_nop 15
  v_max3_f32 v40, v40, v104, v105
  v_max3_f32 v40, v40, v106, v107
  v_max3_f32 v40, v40, v108, v109
  v_max3_f32 v40, v40, v110, v111
  v_max3_f32 v40, v40, v112, v113
  v_max3_f32 v40, v40, v114, v115
  v_max3_f32 v40, v40, v116, v117
  v_max3_f32 v40, v40, v118, v119
  s_nop 7
  v_mfma_f32_32x32x16_bf16 v[104:119], v[152:155], v[16:19], 0
  v_mfma_f32_32x32x16_bf16 v[104:119], v[156:159], v[20:23], v[104:119]
  s_nop 15
  v_max3_f32 v41, v41, v104, v105
  v_max3_f32 v41, v41, v106, v107
  v_max3_f32 v41, v41, v108, v109
  v_max3_f32 v41, v41, v110, v111
  v_max3_f32 v41, v41, v112, v113
  v_max3_f32 v41, v41, v114, v115
  v_max3_f32 v41, v41, v116, v117
  v_max3_f32 v41, v41, v118, v119
  s_nop 7
  v_mfma_f32_32x32x16_bf16 v[104:119], v[152:155], v[24:27], 0
  v_mfma_f32_32x32x16_bf16 v[104:119], v[156:159], v[28:31], v[104:119]
  s_nop 15
  v_max3_f32 v42, v42, v104, v105
  v_max3_f32 v42, v42, v106, v107
  v_max3_f32 v42, v42, v108, v109
  v_max3_f32 v42, v42, v110, v111
  v_max3_f32 v42, v42, v112, v113
  v_max3_f32 v42, v42, v114, v115
  v_max3_f32 v42, v42, v116, v117
  v_max3_f32 v42, v42, v118, v119
  s_nop 7
  v_mfma_f32_32x32x16_bf16 v[104:119], v[152:155], v[32:35], 0
  v_mfma_f32_32x32x16_bf16 v[104:119], v[156:159], v[36:39], v[104:119]
  s_nop 15
  v_max3_f32 v43, v43, v104, v105
  v_max3_f32 v43, v43, v106, v107
  v_max3_f32 v43, v43, v108, v109
  v_max3_f32 v43, v43, v110, v111
  v_max3_f32 v43, v43, v112, v113
  v_max3_f32 v43, v43, v114, v115
  v_max3_f32 v43, v43, v116, v117
  v_max3_f32 v43, v43, v118, v119
  s_nop 7
  s_add_u32 s55, s55, 4096
  s_add_u32 s56, s56, 1
  s_cmp_lt_u32 s56, 16
  s_cbranch_scc1 L_fbmax_102
  v_lshlrev_b32 v216, 2, v0
  v_mov_b32 v218, v40
  v_mov_b32 v219, v40
  s_nop 1
  v_permlane32_swap_b32 v218, v219
  s_nop 1
  v_max_f32 v40, v218, v219
  s_add_u32 s60, s42, 0
  s_and_b32 s60, s60, 3
  s_lshl_b32 s60, s60, 10
  s_lshl_b32 s61, s42, 8
  s_add_u32 s60, s60, s61
  s_add_u32 s60, s60, 61440
  v_add_u32 v218, s60, v216
  ds_write_b32 v218, v40
  v_mov_b32 v218, v41
  v_mov_b32 v219, v41
  s_nop 1
  v_permlane32_swap_b32 v218, v219
  s_nop 1
  v_max_f32 v41, v218, v219
  s_add_u32 s60, s42, 1
  s_and_b32 s60, s60, 3
  s_lshl_b32 s60, s60, 10
  s_lshl_b32 s61, s42, 8
  s_add_u32 s60, s60, s61
  s_add_u32 s60, s60, 61440
  v_add_u32 v218, s60, v216
  ds_write_b32 v218, v41
  v_mov_b32 v218, v42
  v_mov_b32 v219, v42
  s_nop 1
  v_permlane32_swap_b32 v218, v219
  s_nop 1
  v_max_f32 v42, v218, v219
  s_add_u32 s60, s42, 2
  s_and_b32 s60, s60, 3
  s_lshl_b32 s60, s60, 10
  s_lshl_b32 s61, s42, 8
  s_add_u32 s60, s60, s61
  s_add_u32 s60, s60, 61440
  v_add_u32 v218, s60, v216
  ds_write_b32 v218, v42
  v_mov_b32 v218, v43
  v_mov_b32 v219, v43
  s_nop 1
  v_permlane32_swap_b32 v218, v219
  s_nop 1
  v_max_f32 v43, v218, v219
  s_add_u32 s60, s42, 3
  s_and_b32 s60, s60, 3
  s_lshl_b32 s60, s60, 10
  s_lshl_b32 s61, s42, 8
  s_add_u32 s60, s60, s61
  s_add_u32 s60, s60, 61440
  v_add_u32 v218, s60, v216
  ds_write_b32 v218, v43
  s_waitcnt lgkmcnt(0)
  s_barrier
  s_add_u32 s60, s42, 0
  s_and_b32 s60, s60, 3
  s_lshl_b32 s60, s60, 10
  s_add_u32 s60, s60, 61440
  v_add_u32 v218, s60, v216
  ds_read_b32 v104, v218 offset:0
  ds_read_b32 v105, v218 offset:256
  ds_read_b32 v106, v218 offset:512
  ds_read_b32 v107, v218 offset:768
  s_waitcnt lgkmcnt(0)
  v_max3_f32 v40, v104, v105, v106
  v_max_f32 v40, v40, v107
  v_sub_f32 v218, 0, v40
  v_cvt_pk_bf16_f32 v218, v218, 0
  s_nop 1
  v_cndmask_b32_e64 v14, v14, v218, s[48:49]
  s_add_u32 s60, s42, 1
  s_and_b32 s60, s60, 3
  s_lshl_b32 s60, s60, 10
  s_add_u32 s60, s60, 61440
  v_add_u32 v218, s60, v216
  ds_read_b32 v104, v218 offset:0
  ds_read_b32 v105, v218 offset:256
  ds_read_b32 v106, v218 offset:512
  ds_read_b32 v107, v218 offset:768
  s_waitcnt lgkmcnt(0)
  v_max3_f32 v41, v104, v105, v106
  v_max_f32 v41, v41, v107
  v_sub_f32 v218, 0, v41
  v_cvt_pk_bf16_f32 v218, v218, 0
  s_nop 1
  v_cndmask_b32_e64 v22, v22, v218, s[48:49]
  s_add_u32 s60, s42, 2
  s_and_b32 s60, s60, 3
  s_lshl_b32 s60, s60, 10
  s_add_u32 s60, s60, 61440
  v_add_u32 v218, s60, v216
  ds_read_b32 v104, v218 offset:0
  ds_read_b32 v105, v218 offset:256
  ds_read_b32 v106, v218 offset:512
  ds_read_b32 v107, v218 offset:768
  s_waitcnt lgkmcnt(0)
  v_max3_f32 v42, v104, v105, v106
  v_max_f32 v42, v42, v107
  v_sub_f32 v218, 0, v42
  v_cvt_pk_bf16_f32 v218, v218, 0
  s_nop 1
  v_cndmask_b32_e64 v30, v30, v218, s[48:49]
  s_add_u32 s60, s42, 3
  s_and_b32 s60, s60, 3
  s_lshl_b32 s60, s60, 10
  s_add_u32 s60, s60, 61440
  v_add_u32 v218, s60, v216
  ds_read_b32 v104, v218 offset:0
  ds_read_b32 v105, v218 offset:256
  ds_read_b32 v106, v218 offset:512
  ds_read_b32 v107, v218 offset:768
  s_waitcnt lgkmcnt(0)
  v_max3_f32 v43, v104, v105, v106
  v_max_f32 v43, v43, v107
  v_sub_f32 v218, 0, v43
  v_cvt_pk_bf16_f32 v218, v218, 0
  s_nop 1
  v_cndmask_b32_e64 v38, v38, v218, s[48:49]
  s_barrier
  v_mov_b32 v40, 0
  v_mov_b32 v41, 0
  v_mov_b32 v42, 0
  v_mov_b32 v43, 0
  v_mov_b32 v44, 0
  v_mov_b32 v45, 0
  v_mov_b32 v46, 0
  v_mov_b32 v47, 0
  v_mov_b32 v48, 0
  v_mov_b32 v49, 0
  v_mov_b32 v50, 0
  v_mov_b32 v51, 0
  v_mov_b32 v52, 0
  v_mov_b32 v53, 0
  v_mov_b32 v54, 0
  v_mov_b32 v55, 0
  v_mov_b32 v56, 0
  v_mov_b32 v57, 0
  v_mov_b32 v58, 0
  v_mov_b32 v59, 0
  v_mov_b32 v60, 0
  v_mov_b32 v61, 0
  v_mov_b32 v62, 0
  v_mov_b32 v63, 0
  v_mov_b32 v64, 0
  v_mov_b32 v65, 0
  v_mov_b32 v66, 0
  v_mov_b32 v67, 0
  v_mov_b32 v68, 0
  v_mov_b32 v69, 0
  v_mov_b32 v70, 0
  v_mov_b32 v71, 0
  v_mov_b32 v72, 0
  v_mov_b32 v73, 0
  v_mov_b32 v74, 0
  v_mov_b32 v75, 0
  v_mov_b32 v76, 0
  v_mov_b32 v77, 0
  v_mov_b32 v78, 0
  v_mov_b32 v79, 0
  v_mov_b32 v80, 0
  v_mov_b32 v81, 0
  v_mov_b32 v82, 0
  v_mov_b32 v83, 0
  v_mov_b32 v84, 0
  v_mov_b32 v85, 0
  v_mov_b32 v86, 0
  v_mov_b32 v87, 0
  v_mov_b32 v88, 0
  v_mov_b32 v89, 0
  v_mov_b32 v90, 0
  v_mov_b32 v91, 0
  v_mov_b32 v92, 0
  v_mov_b32 v93, 0
  v_mov_b32 v94, 0
  v_mov_b32 v95, 0
  v_mov_b32 v96, 0
  v_mov_b32 v97, 0
  v_mov_b32 v98, 0
  v_mov_b32 v99, 0
  v_mov_b32 v100, 0
  v_mov_b32 v101, 0
  v_mov_b32 v102, 0
  v_mov_b32 v103, 0
  v_mov_b32 v144, 0
  v_mov_b32 v208, 0
  v_mov_b32 v145, 0
  v_mov_b32 v209, 0
  v_mov_b32 v146, 0
  v_mov_b32 v210, 0
  v_mov_b32 v147, 0
  v_mov_b32 v211, 0
  v_mov_b32 v148, 0
  v_mov_b32 v212, 0
  v_mov_b32 v149, 0
  v_mov_b32 v213, 0
  v_mov_b32 v150, 0
  v_mov_b32 v214, 0
  v_mov_b32 v151, 0
  v_mov_b32 v215, 0
  s_lshl_b32 s55, s52, 6
  s_lshl_b32 s60, s42, 4
  s_add_u32 s55, s55, s60
  s_lshl_b32 s55, s55, 12
  s_add_u32 s55, s55, s46
  s_add_u32 s55, s55, 2097152
  buffer_load_dwordx4 v[152:155], v1, s[28:31], s55 offen offset:0
  buffer_load_dwordx4 v[156:159], v1, s[28:31], s55 offen offset:1024
  buffer_load_dwordx4 v[160:163], v1, s[28:31], s55 offen offset:2048
  buffer_load_dwordx4 v[164:167], v1, s[28:31], s55 offen offset:3072
  s_add_u32 s55, s55, 4096
  buffer_load_dwordx4 v[168:171], v1, s[28:31], s55 offen offset:0
  buffer_load_dwordx4 v[172:175], v1, s[28:31], s55 offen offset:1024
  buffer_load_dwordx4 v[176:179], v1, s[28:31], s55 offen offset:2048
  buffer_load_dwordx4 v[180:183], v1, s[28:31], s55 offen offset:3072
  s_add_u32 s55, s55, 4096
  buffer_load_dwordx4 v[184:187], v1, s[28:31], s55 offen offset:0
  buffer_load_dwordx4 v[188:191], v1, s[28:31], s55 offen offset:1024
  buffer_load_dwordx4 v[192:195], v1, s[28:31], s55 offen offset:2048
  buffer_load_dwordx4 v[196:199], v1, s[28:31], s55 offen offset:3072
  s_add_u32 s55, s55, 4096
  s_add_u32 s66, s42, 12
  s_mul_i32 s58, s66, 57344
  s_add_u32 s58, s58, s68
  s_lshl_b32 s66, s66, 12
  s_add_u32 s66, s66, 61440
  s_waitcnt vmcnt(8)
  v_mfma_f32_32x32x16_bf16 v[104:119], v[152:155], v[8:11], 0
  v_mfma_f32_32x32x16_bf16 v[104:119], v[156:159], v[12:15], v[104:119]
  s_nop 3
  s_branch L_attn1_18
L_code_end:
.section .rodata,"a"
.p2align 6
.amdhsa_kernel interleave_layers__mha_block__mixer_gmlp__prompt_kernel
  .amdhsa_next_free_vgpr 512
  .amdhsa_next_free_sgpr 102
  .amdhsa_accum_offset 256
  .amdhsa_group_segment_fixed_size 0
  .amdhsa_kernarg_size 88
  .amdhsa_user_sgpr_count 2
  .amdhsa_user_sgpr_kernarg_segment_ptr 1
  .amdhsa_system_sgpr_workgroup_id_x 1
.end_amdhsa_kernel
```
